```python
import torch

def _softmax(x, axis=-1):
    return torch.softmax(x, dim=axis)
def _gelu(x):
    return torch.nn.functional.gelu(x, approximate="tanh")
def _silu(x):
    return torch.nn.functional.silu(x)
def _sigmoid(x):
    return torch.sigmoid(x)
def _layernorm(x, axis=-1, eps=1e-5):
    m = x.mean(dim=axis, keepdim=True)
    v = x.var(dim=axis, keepdim=True, unbiased=False)
    return (x - m) / torch.sqrt(v + eps)
def _scatter_add(tgt, idx, src, axis=0):
    return tgt.clone().index_add_(axis, idx, src)
def _segment_sum(src, seg, n):
    out = torch.zeros((n,) + src.shape[1:], dtype=src.dtype)
    return out.index_add_(0, seg, src)
def _pad(x, pw):
    flat = tuple(v for pair in reversed(pw) for v in pair)
    return torch.nn.functional.pad(x, flat)

kernel_name = 'recurrent_scan__mha_block_cached__moe_arch_mod__prompt'

def setup_inputs():

    _w = (lambda a: (lambda t: t.to(torch.bfloat16) if t.is_floating_point() else t)(torch.as_tensor(a)))
    def _A_setup():
        B, Sq, D = 1, 2048, 640
        H, Sk, Dh = 32, 2048, 128
        return {
            "x": _w((lambda *s: torch.randn(*s, dtype=torch.bfloat16) * 0.05)(B, Sq, D)),
            "k_cache": _w((lambda *s: torch.randn(*s, dtype=torch.bfloat16) * 1.6)(B, H, Sk, Dh)),
            "v_cache": _w((lambda *s: torch.randn(*s, dtype=torch.bfloat16) * 0.2)(B, H, Sk, Dh)),
            "wq": _w((lambda *s: torch.randn(*s, dtype=torch.bfloat16) * 1.6)(D, H * Dh) * (D ** -0.5)),
            "wo": _w((lambda *s: torch.randn(*s, dtype=torch.bfloat16) * 0.2)(H * Dh, D) * ((H * Dh) ** -0.5)),
        }
    _A_in = _A_setup()

    def _B_setup():
        B, S, D, F, C = 1, 2048, 640, 1728, 1
        return {
            "x": _w((lambda *s: torch.randn(*s, dtype=torch.bfloat16) * 0.05)(B, S, D)),
            "w_r": _w((lambda *s: torch.randn(*s, dtype=torch.bfloat16) * 0.2)(D)),
            "w_gate": _w((lambda *s: torch.randn(*s, dtype=torch.bfloat16) * 0.1)(D, F)),
            "w_up": _w((lambda *s: torch.randn(*s, dtype=torch.bfloat16) * 0.1)(D, F)),
            "w_down": _w((lambda *s: torch.randn(*s, dtype=torch.bfloat16) * 0.1)(F, D)),
        }
    _B_in = _B_setup()

    return {
        "A_x": _A_in["x"],
        "A_k_cache": _A_in["k_cache"],
        "A_v_cache": _A_in["v_cache"],
        "A_wq": _A_in["wq"],
        "A_wo": _A_in["wo"],
        "B_x": _B_in["x"],
        "B_w_r": _B_in["w_r"],
        "B_w_gate": _B_in["w_gate"],
        "B_w_up": _B_in["w_up"],
        "B_w_down": _B_in["w_down"],
    }

def reference(A_x, A_k_cache, A_v_cache, A_wq, A_wo, B_x, B_w_r, B_w_gate, B_w_up, B_w_down):
    def _A_ref(x, k_cache, v_cache, wq, wo):
        B, Sq, D = x.shape
        H, Dh = 32, 128
        q = (lambda x, *d: x.permute(*d))((x @ wq).reshape(B, Sq, H, Dh), 0, 2, 1, 3)
        scores = torch.einsum("bhqd,bhkd->bhqk", q, k_cache) * (Dh ** -0.5)
        p = _softmax(scores, axis=-1)
        o = torch.einsum("bhqk,bhkd->bhqd", p, v_cache)
        return (lambda x, *d: x.permute(*d))(o, 0, 2, 1, 3).reshape(B, Sq, H * Dh) @ wo

    def _B_ref(x, w_r, w_gate, w_up, w_down):
        B, S, D = x.shape
        C = 1
        r = x @ w_r
        idx = torch.argsort(-r, axis=-1)[:, :C]
        idx_e = (lambda x, n, axis: torch.repeat_interleave(x, n, dim=axis))(idx.reshape(B, C, 1), D, axis=2)
        x_sel = (lambda x, i, axis: torch.take_along_dim(x, i, dim=axis))(x, idx_e, axis=1)
        g = _silu(x_sel @ w_gate)
        u = x_sel @ w_up
        y = (g * u) @ w_down
        r_sel = _sigmoid((lambda x, i, axis: torch.take_along_dim(x, i, dim=axis))(r, idx, axis=1))
        y = y * r_sel.reshape(B, C, 1)
        b_off = (torch.arange(B) * S).reshape(B, 1)
        flat_idx = (idx + b_off).reshape(B * C)
        zero = (x * 0.0).reshape(B * S, D)
        upd = _scatter_add(zero, flat_idx, y.reshape(B * C, D), axis=0)
        return x + upd.reshape(B, S, D)

    x = A_x
    xn = _layernorm(x, axis=-1)
    s = _A_ref(xn, A_k_cache, A_v_cache, A_wq, A_wo)
    g = _silu(_B_ref(xn, B_w_r, B_w_gate, B_w_up, B_w_down))
    return x + s * g
```

```asm
; @launch grid=(256,1,1) block=(256,1,1) lds=163840
.amdgcn_target "amdgcn-amd-amdhsa--gfx950"
.text
.macro M d,a,b,c
v_mfma_f32_16x16x32_bf16 \d,\a,\b,\c
.endm
.macro MS d,a,b,c
v_smfmac_f32_16x16x64_bf16 \d,\a,\b,\c
.endm
.globl recurrent_scan__mha_block_cached__moe_arch_mod__prompt_kernel
.p2align 8
.type recurrent_scan__mha_block_cached__moe_arch_mod__prompt_kernel,@function
recurrent_scan__mha_block_cached__moe_arch_mod__prompt_kernel:
s_mov_b32 s81,0
s_cmp_lt_u32 s2,256
s_cbranch_scc1 L_go
s_endpgm
L_go:
s_load_dwordx8 s[64:71],s[0:1],0
s_load_dwordx2 s[74:75],s[0:1],48
s_load_dwordx2 s[72:73],s[0:1],32
s_load_dwordx4 s[76:79],s[0:1],88
s_load_dwordx4 s[4:7],s[0:1],56
s_load_dwordx2 s[94:95],s[0:1],72
s_load_dwordx2 s[56:57],s[0:1],80
s_getpc_b64 s[84:85]
s_lshr_b32 s50,s2,3
s_lshl_b32 s50,s50,12
v_lshrrev_b32 v5,6,v0
v_and_b32 v7,7,v0
v_lshl_add_u32 v5,v5,3,v7
v_lshl_add_u32 v5,v5,7,s50
v_min_u32 v5,70000,v5
global_load_dword v253,v5,s[84:85]
v_lshrrev_b32 v1,6,v0
v_and_b32 v242,63,v0
v_readfirstlane_b32 s40,v1
s_and_b32 s50,s2,7
s_lshr_b32 s51,s2,3
s_mul_i32 s3,s50,27
s_add_u32 s3,s3,s51
s_and_b32 s42,s51,7
s_lshr_b32 s51,s51,3
s_lshl_b32 s50,s50,2
s_add_u32 s41,s50,s51
s_lshl_b32 s48,s40,12
v_and_b32 v1,15,v0
v_bfe_u32 v2,v0,4,2
v_bfe_u32 v3,v0,2,2
v_and_b32 v4,3,v0
v_bfe_u32 v5,v0,3,3
v_mul_u32_u24 v5,1280,v5
v_and_b32 v6,7,v0
v_xor_b32 v6,v6,v2
v_lshl_add_u32 v243,v6,4,v5
v_xor_b32 v6,4,v6
v_lshl_add_u32 v244,v6,4,v5
s_lshl_b32 s50,s42,2
s_add_u32 s50,s50,s40
s_mul_i32 s45,s50,81920
s_lshl_b32 s55,s50,6
s_lshl_b32 s83,s50,2
s_lshl_b32 s50,s50,7
s_lshl_b32 s51,s41,2
s_add_u32 s50,s50,s51
s_lshl_b32 s49,s50,12
s_lshl_b32 s82,s50,5
s_add_u32 s82,s82,25427968
s_add_u32 s84,s45,0
s_add_u32 s85,s45,9216
s_add_u32 s86,s45,18432
s_add_u32 s87,s45,27648
s_add_u32 s88,s45,40960
s_add_u32 s89,s45,50176
s_add_u32 s90,s45,59392
s_add_u32 s91,s45,68608
v_lshlrev_b32 v5,2,v2
v_xor_b32 v5,v5,v1
v_lshlrev_b32 v5,4,v5
v_lshl_add_u32 v168,v2,13,v5
v_add_u32 v169,31744,v168
v_add_u32 v170,63488,v168
v_add_u32 v171,95232,v168
s_lshl_b32 s46,s41,8
s_lshl_b32 s50,s40,17
s_add_u32 s46,s46,s50
v_lshlrev_b32 v6,4,v0
s_waitcnt lgkmcnt(0)
s_mov_b32 s20,s70
s_mov_b32 s21,s71
s_mov_b32 s22,5242880
s_mov_b32 s23,0x00020000
s_mov_b32 s28,s74
s_mov_b32 s29,s75
s_mov_b32 s30,1280
s_mov_b32 s31,0x00020000
s_add_u32 m0,s48,32768
s_nop 0
buffer_load_dwordx4 v168,s[20:23],s46 offen offset:0 nt lds
buffer_load_dwordx4 v169,s[20:23],s46 offen offset:1024 nt lds
buffer_load_dwordx4 v170,s[20:23],s46 offen offset:2048 nt lds
buffer_load_dwordx4 v171,s[20:23],s46 offen offset:3072 nt lds
s_add_u32 s46,s46,524288
s_lshl_b32 s50,s40,10
s_add_u32 m0,s50,157696
s_nop 0
buffer_load_dwordx4 v6,s[28:31],0 offen lds
s_mov_b32 s8,s64
s_mov_b32 s9,s65
s_mov_b32 s10,2621440
s_mov_b32 s11,0x00020000
s_mov_b32 s12,s66
s_mov_b32 s13,s67
s_mov_b32 s14,16777216
s_mov_b32 s15,0x00020000
s_mov_b32 s16,s68
s_mov_b32 s17,s69
s_mov_b32 s18,16777216
s_mov_b32 s19,0x00020000
s_mov_b32 s58,s84
s_mov_b32 s59,s85
s_mov_b32 s60,s86
s_mov_b32 s61,s87
s_mov_b32 s62,s88
s_mov_b32 s63,s89
s_mov_b32 s64,s90
s_mov_b32 s65,s91
s_lshl_b32 s68,s40,13
s_mov_b32 s50,114688
s_cmp_lt_u32 s40,2
s_cmov_b32 s50,81920
s_add_u32 s69,s68,s50
s_add_u32 m0,s68,0
s_nop 0
buffer_load_dwordx4 v243,s[8:11],s58 offen offset:0 lds
buffer_load_dwordx4 v244,s[8:11],s59 offen offset:1024 lds
buffer_load_dwordx4 v243,s[8:11],s60 offen offset:2048 lds
buffer_load_dwordx4 v244,s[8:11],s61 offen offset:3072 lds
s_add_u32 m0,s68,4096
s_nop 0
buffer_load_dwordx4 v243,s[8:11],s62 offen offset:0 lds
buffer_load_dwordx4 v244,s[8:11],s63 offen offset:1024 lds
buffer_load_dwordx4 v243,s[8:11],s64 offen offset:2048 lds
buffer_load_dwordx4 v244,s[8:11],s65 offen offset:3072 lds
v_add_u32 v243,128,v243
v_add_u32 v244,128,v244
s_mov_b32 s24,s72
s_mov_b32 s25,s73
s_mov_b32 s26,5242880
s_mov_b32 s27,0x00020000
s_mov_b32 s32,s78
s_mov_b32 s33,s79
s_mov_b32 s34,41943040
s_mov_b32 s35,0x00020000
s_mov_b32 s36,s76
s_mov_b32 s37,s77
s_mov_b32 s38,256
s_mov_b32 s39,0x00020000
s_add_u32 m0,s69,0
s_nop 0
buffer_load_dwordx4 v243,s[8:11],s58 offen offset:0 lds
buffer_load_dwordx4 v244,s[8:11],s59 offen offset:1024 lds
buffer_load_dwordx4 v243,s[8:11],s60 offen offset:2048 lds
buffer_load_dwordx4 v244,s[8:11],s61 offen offset:3072 lds
s_add_u32 m0,s69,4096
s_nop 0
buffer_load_dwordx4 v243,s[8:11],s62 offen offset:0 lds
buffer_load_dwordx4 v244,s[8:11],s63 offen offset:1024 lds
buffer_load_dwordx4 v243,s[8:11],s64 offen offset:2048 lds
buffer_load_dwordx4 v244,s[8:11],s65 offen offset:3072 lds
v_add_u32 v243,128,v243
v_add_u32 v244,128,v244
s_add_u32 m0,s48,98304
s_nop 0
buffer_load_dwordx4 v168,s[20:23],s46 offen offset:0 nt lds
buffer_load_dwordx4 v169,s[20:23],s46 offen offset:1024 nt lds
buffer_load_dwordx4 v170,s[20:23],s46 offen offset:2048 nt lds
buffer_load_dwordx4 v171,s[20:23],s46 offen offset:3072 nt lds
s_add_u32 s46,s46,524288
s_bitcmp1_b32 s40,0
s_cselect_b32 s4,s6,s4
s_cselect_b32 s5,s7,s5
s_mov_b32 s6,2211840
s_mov_b32 s7,0x00020000
s_mov_b32 s92,25165824
s_cmp_lg_u32 s41,0
s_cmov_b32 s92,41943040
s_cmov_b32 s83,4096
s_lshl_b32 s93,s40,7
s_add_u32 s93,s93,163328
s_lshl_b32 s45,s2,4
s_add_u32 s45,s45,25296896
s_cmp_ge_u32 s2,160
s_cmov_b32 s45,41943040
s_cmp_lg_u32 s40,0
s_cmov_b32 s45,41943040
s_mul_i32 s80,s3,2560
s_mul_i32 s50,s40,640
s_add_u32 s80,s80,s50
s_add_u32 s80,s80,26214400
s_cmp_ge_u32 s2,216
s_cmov_b32 s80,41943040
s_cmp_lg_u32 s81,0
s_cmov_b32 s92,41943040
v_lshrrev_b32 v5,1,v1
v_xor_b32 v5,v5,v2
v_lshlrev_b32 v5,4,v5
v_lshl_add_u32 v5,v1,7,v5
v_xor_b32 v6,64,v5
v_add_u32 v172,s68,v5
v_add_u32 v173,s68,v6
v_add_u32 v174,s69,v5
v_add_u32 v175,s69,v6
v_lshl_add_u32 v5,v2,3,v3
v_lshlrev_b32 v5,8,v5
v_add_u32 v5,32768,v5
v_lshlrev_b32 v6,2,v3
s_add_u32 s50,s40,0
s_and_b32 s50,s50,3
s_lshl_b32 s50,s50,2
v_or_b32 v7,s50,v4
v_xor_b32 v7,v7,v6
v_lshl_add_u32 v164,v7,4,v5
s_add_u32 s50,s40,1
s_and_b32 s50,s50,3
s_lshl_b32 s50,s50,2
v_or_b32 v7,s50,v4
v_xor_b32 v7,v7,v6
v_lshl_add_u32 v165,v7,4,v5
s_add_u32 s50,s40,2
s_and_b32 s50,s50,3
s_lshl_b32 s50,s50,2
v_or_b32 v7,s50,v4
v_xor_b32 v7,v7,v6
v_lshl_add_u32 v166,v7,4,v5
s_add_u32 s50,s40,3
s_and_b32 s50,s50,3
s_lshl_b32 s50,s50,2
v_or_b32 v7,s50,v4
v_xor_b32 v7,v7,v6
v_lshl_add_u32 v167,v7,4,v5
v_mov_b32 v8,0x3f803f80
v_mov_b32 v9,0x3f803f80
v_min_u32 v5,159,v0
v_lshlrev_b32 v5,3,v5
v_add_u32 v5,161792,v5
ds_write_b64 v5,v[8:9]
v_cmp_gt_u32 vcc,2,v1
v_and_b32 v7,1,v0
v_mul_u32_u24 v255,0xaaaa,v7
v_cndmask_b32 v160,0,v8,vcc
v_add_u32 v255,0x4444,v255
v_mov_b32 v161,v160
v_mov_b32 v162,v160
v_mov_b32 v163,v160
v_mov_b32 v5,161792
v_lshlrev_b32 v6,2,v7
v_add_u32 v6,157696,v6
v_cmp_le_u32 vcc,2,v4
s_lshl_b32 s43,s41,19
s_mov_b32 s44,s43
s_add_u32 s14,s43,0x80000
v_cndmask_b32 v5,v5,v6,vcc
v_lshl_add_u32 v216,v2,5,v5
v_mov_b32 v192,0
v_mov_b32 v193,0
v_mov_b32 v194,0
v_mov_b32 v195,0
v_mov_b32 v196,0
v_mov_b32 v197,0
v_mov_b32 v198,0
v_mov_b32 v199,0
v_mov_b32 v200,0
v_mov_b32 v201,0
v_mov_b32 v202,0
v_mov_b32 v203,0
v_mov_b32 v204,0
v_mov_b32 v205,0
v_mov_b32 v206,0
v_mov_b32 v207,0
v_mov_b32 v152,0
v_mov_b32 v153,0
v_mov_b32 v154,0
v_mov_b32 v155,0
v_mov_b32 v156,0
v_mov_b32 v157,0
v_mov_b32 v158,0
v_mov_b32 v159,0
s_mul_i32 s52,s40,5120
s_add_u32 s52,s52,131072
s_and_b32 s50,s2,1
s_lshl_b32 s50,s50,2
s_add_u32 s50,s50,s40
s_lshr_b32 s51,s2,1
s_mul_i32 s53,s50,160
s_mul_i32 s54,s51,40960
s_add_u32 s53,s53,s54
s_lshl_b32 s50,s50,7
s_add_u32 s50,s50,s51
s_mul_i32 s54,s50,5120
s_add_u32 s54,s54,16777216
s_waitcnt vmcnt(20) lgkmcnt(0)
s_barrier
ds_read2_b32 v[208:209],v216 offset0:0 offset1:2
ds_read2_b32 v[210:211],v216 offset0:4 offset1:6
ds_read_b64_tr_b16 v[128:129],v164 offset:0
ds_read_b64_tr_b16 v[130:131],v164 offset:1024
ds_read_b64_tr_b16 v[132:133],v164 offset:8192
ds_read_b64_tr_b16 v[134:135],v164 offset:9216
ds_read_b64_tr_b16 v[136:137],v164 offset:8
ds_read_b64_tr_b16 v[138:139],v164 offset:1032
ds_read_b64_tr_b16 v[140:141],v164 offset:8200
ds_read_b64_tr_b16 v[142:143],v164 offset:9224
s_waitcnt vmcnt(18)
ds_read_b128 a[0:3],v172 offset:0
ds_read_b128 a[4:7],v173 offset:0
s_waitcnt vmcnt(16)
ds_read_b128 a[8:11],v172 offset:2048
ds_read_b128 a[12:15],v173 offset:2048
s_waitcnt lgkmcnt(12)
s_waitcnt lgkmcnt(2)
MS v[192:195],v[208:211],a[0:7],v255
s_add_u32 m0,s68,0
M v[176:179],a[0:3],a[0:3],0
buffer_load_dwordx4 v243,s[8:11],s58 offen offset:0 lds
s_waitcnt vmcnt(15)
ds_read_b128 a[16:19],v172 offset:4096
ds_read_b128 a[20:23],v173 offset:4096
M v[176:179],a[4:7],a[4:7],v[176:179]
buffer_load_dwordx4 v244,s[8:11],s59 offen offset:1024 lds
s_waitcnt lgkmcnt(2)
MS v[196:199],v[208:211],a[8:15],v255
M v[180:183],a[8:11],a[8:11],0
buffer_load_dwordx4 v243,s[8:11],s60 offen offset:2048 lds
s_waitcnt vmcnt(15)
ds_read_b128 a[24:27],v172 offset:6144
ds_read_b128 a[28:31],v173 offset:6144
M v[180:183],a[12:15],a[12:15],v[180:183]
buffer_load_dwordx4 v244,s[8:11],s61 offen offset:3072 lds
s_add_u32 m0,s68,4096
s_waitcnt lgkmcnt(2)
MS v[200:203],v[208:211],a[16:23],v255
M v[184:187],a[16:19],a[16:19],0
buffer_load_dwordx4 v243,s[8:11],s62 offen offset:0 lds
M v[184:187],a[20:23],a[20:23],v[184:187]
buffer_load_dwordx4 v244,s[8:11],s63 offen offset:1024 lds
s_waitcnt lgkmcnt(0)
MS v[204:207],v[208:211],a[24:31],v255
M v[188:191],a[24:27],a[24:27],0
buffer_load_dwordx4 v243,s[8:11],s64 offen offset:2048 lds
M v[188:191],a[28:31],a[28:31],v[188:191]
buffer_load_dwordx4 v244,s[8:11],s65 offen offset:3072 lds
v_add_u32 v243,128,v243
v_add_u32 v244,128,v244
MS v[152:155],v[160:163],v[128:135],v255
ds_read_b64_tr_b16 v[144:145],v165 offset:0
M v[0:3],v[128:131],a[0:3],0
ds_read_b64_tr_b16 v[146:147],v165 offset:1024
M v[0:3],v[132:135],a[4:7],v[0:3]
ds_read_b64_tr_b16 v[148:149],v165 offset:8192
M v[32:35],v[132:135],a[12:15],0
ds_read_b64_tr_b16 v[150:151],v165 offset:9216
M v[32:35],v[128:131],a[8:11],v[32:35]
M v[64:67],v[128:131],a[16:19],0
s_add_u32 m0,s48,114688
M v[64:67],v[132:135],a[20:23],v[64:67]
buffer_load_dwordx4 v168,s[20:23],s46 offen offset:0 nt lds
M v[96:99],v[132:135],a[28:31],0
buffer_load_dwordx4 v169,s[20:23],s46 offen offset:1024 nt lds
M v[96:99],v[128:131],a[24:27],v[96:99]
buffer_load_dwordx4 v170,s[20:23],s46 offen offset:2048 nt lds
MS v[156:159],v[160:163],v[136:143],v255
ds_read_b64_tr_b16 v[128:129],v165 offset:8
M v[4:7],v[136:139],a[0:3],0
ds_read_b64_tr_b16 v[130:131],v165 offset:1032
M v[4:7],v[140:143],a[4:7],v[4:7]
ds_read_b64_tr_b16 v[132:133],v165 offset:8200
M v[36:39],v[140:143],a[12:15],0
ds_read_b64_tr_b16 v[134:135],v165 offset:9224
M v[36:39],v[136:139],a[8:11],v[36:39]
M v[68:71],v[136:139],a[16:19],0
buffer_load_dwordx4 v171,s[20:23],s46 offen offset:3072 nt lds
M v[68:71],v[140:143],a[20:23],v[68:71]
M v[100:103],v[140:143],a[28:31],0
M v[100:103],v[136:139],a[24:27],v[100:103]
s_waitcnt lgkmcnt(4)
M v[8:11],v[144:147],a[0:3],0
ds_read_b64_tr_b16 v[136:137],v166 offset:0
M v[8:11],v[148:151],a[4:7],v[8:11]
ds_read_b64_tr_b16 v[138:139],v166 offset:1024
s_add_u32 s46,s46,524288
M v[40:43],v[148:151],a[12:15],0
ds_read_b64_tr_b16 v[140:141],v166 offset:8192
M v[40:43],v[144:147],a[8:11],v[40:43]
ds_read_b64_tr_b16 v[142:143],v166 offset:9216
s_waitcnt vmcnt(16)
M v[72:75],v[144:147],a[16:19],0
ds_read_b128 a[32:35],v174 offset:0
M v[72:75],v[148:151],a[20:23],v[72:75]
ds_read_b128 a[36:39],v175 offset:0
M v[104:107],v[148:151],a[28:31],0
ds_read_b128 a[40:43],v174 offset:2048
M v[104:107],v[144:147],a[24:27],v[104:107]
ds_read_b128 a[44:47],v175 offset:2048
s_waitcnt lgkmcnt(8)
M v[12:15],v[128:131],a[0:3],0
ds_read_b64_tr_b16 v[144:145],v166 offset:8
M v[12:15],v[132:135],a[4:7],v[12:15]
ds_read_b64_tr_b16 v[146:147],v166 offset:1032
M v[44:47],v[132:135],a[12:15],0
ds_read_b64_tr_b16 v[148:149],v166 offset:8200
M v[44:47],v[128:131],a[8:11],v[44:47]
ds_read_b64_tr_b16 v[150:151],v166 offset:9224
M v[76:79],v[128:131],a[16:19],0
ds_read_b128 a[48:51],v174 offset:4096
M v[76:79],v[132:135],a[20:23],v[76:79]
ds_read_b128 a[52:55],v175 offset:4096
M v[108:111],v[132:135],a[28:31],0
ds_read_b128 a[56:59],v174 offset:6144
M v[108:111],v[128:131],a[24:27],v[108:111]
ds_read_b128 a[60:63],v175 offset:6144
s_waitcnt lgkmcnt(12)
M v[16:19],v[136:139],a[0:3],0
ds_read_b64_tr_b16 v[128:129],v167 offset:0
M v[16:19],v[140:143],a[4:7],v[16:19]
ds_read_b64_tr_b16 v[130:131],v167 offset:1024
M v[48:51],v[140:143],a[12:15],0
ds_read_b64_tr_b16 v[132:133],v167 offset:8192
M v[48:51],v[136:139],a[8:11],v[48:51]
ds_read_b64_tr_b16 v[134:135],v167 offset:9216
s_add_u32 m0,s69,0
s_waitcnt lgkmcnt(4)
M v[80:83],v[136:139],a[16:19],0
buffer_load_dwordx4 v243,s[8:11],s58 offen offset:0 lds
M v[80:83],v[140:143],a[20:23],v[80:83]
buffer_load_dwordx4 v244,s[8:11],s59 offen offset:1024 lds
M v[112:115],v[140:143],a[28:31],0
buffer_load_dwordx4 v243,s[8:11],s60 offen offset:2048 lds
M v[112:115],v[136:139],a[24:27],v[112:115]
buffer_load_dwordx4 v244,s[8:11],s61 offen offset:3072 lds
M v[20:23],v[144:147],a[0:3],0
ds_read_b64_tr_b16 v[136:137],v167 offset:8
M v[20:23],v[148:151],a[4:7],v[20:23]
ds_read_b64_tr_b16 v[138:139],v167 offset:1032
M v[52:55],v[148:151],a[12:15],0
ds_read_b64_tr_b16 v[140:141],v167 offset:8200
M v[52:55],v[144:147],a[8:11],v[52:55]
ds_read_b64_tr_b16 v[142:143],v167 offset:9224
M v[84:87],v[144:147],a[16:19],0
v_add_u32 v164,0x10000,v164
s_add_u32 m0,s69,4096
M v[84:87],v[148:151],a[20:23],v[84:87]
buffer_load_dwordx4 v243,s[8:11],s62 offen offset:0 lds
M v[116:119],v[148:151],a[28:31],0
buffer_load_dwordx4 v244,s[8:11],s63 offen offset:1024 lds
M v[116:119],v[144:147],a[24:27],v[116:119]
buffer_load_dwordx4 v243,s[8:11],s64 offen offset:2048 lds
s_waitcnt lgkmcnt(4)
s_waitcnt vmcnt(19)
M v[24:27],v[128:131],a[0:3],0
s_barrier
M v[24:27],v[132:135],a[4:7],v[24:27]
ds_read_b64_tr_b16 v[144:145],v164 offset:0
M v[56:59],v[132:135],a[12:15],0
ds_read_b64_tr_b16 v[146:147],v164 offset:1024
M v[56:59],v[128:131],a[8:11],v[56:59]
ds_read_b64_tr_b16 v[148:149],v164 offset:8192
M v[88:91],v[128:131],a[16:19],0
ds_read_b64_tr_b16 v[150:151],v164 offset:9216
M v[88:91],v[132:135],a[20:23],v[88:91]
M v[120:123],v[132:135],a[28:31],0
buffer_load_dwordx4 v244,s[8:11],s65 offen offset:3072 lds
v_add_u32 v243,128,v243
v_add_u32 v244,128,v244
M v[120:123],v[128:131],a[24:27],v[120:123]
s_waitcnt lgkmcnt(4)
M v[28:31],v[136:139],a[0:3],0
ds_read_b64_tr_b16 v[128:129],v164 offset:8
M v[28:31],v[140:143],a[4:7],v[28:31]
ds_read_b64_tr_b16 v[130:131],v164 offset:1032
v_add_u32 v165,0x10000,v165
M v[60:63],v[140:143],a[12:15],0
ds_read_b64_tr_b16 v[132:133],v164 offset:8200
v_add_u32 v166,0x10000,v166
M v[60:63],v[136:139],a[8:11],v[60:63]
ds_read_b64_tr_b16 v[134:135],v164 offset:9224
M v[92:95],v[136:139],a[16:19],0
M v[92:95],v[140:143],a[20:23],v[92:95]
ds_read2_b32 v[208:209],v216 offset0:32 offset1:34
M v[124:127],v[140:143],a[28:31],0
ds_read2_b32 v[210:211],v216 offset0:36 offset1:38
M v[124:127],v[136:139],a[24:27],v[124:127]
s_waitcnt lgkmcnt(0)
MS v[192:195],v[208:211],a[32:39],v255
M v[176:179],a[32:35],a[32:35],v[176:179]
M v[176:179],a[36:39],a[36:39],v[176:179]
MS v[196:199],v[208:211],a[40:47],v255
M v[180:183],a[40:43],a[40:43],v[180:183]
M v[180:183],a[44:47],a[44:47],v[180:183]
MS v[200:203],v[208:211],a[48:55],v255
M v[184:187],a[48:51],a[48:51],v[184:187]
M v[184:187],a[52:55],a[52:55],v[184:187]
s_add_u32 m0,s48,65536
MS v[204:207],v[208:211],a[56:63],v255
buffer_load_dwordx4 v168,s[20:23],s46 offen offset:0 nt lds
M v[188:191],a[56:59],a[56:59],v[188:191]
M v[188:191],a[60:63],a[60:63],v[188:191]
buffer_load_dwordx4 v169,s[20:23],s46 offen offset:1024 nt lds
MS v[152:155],v[160:163],v[144:151],v255
ds_read_b64_tr_b16 v[136:137],v165 offset:0
v_lshlrev_b32 v223,2,v242
M v[0:3],v[144:147],a[32:35],v[0:3]
ds_read_b64_tr_b16 v[138:139],v165 offset:1024
v_add_u32 v223,157696,v223
M v[0:3],v[148:151],a[36:39],v[0:3]
ds_read_b64_tr_b16 v[140:141],v165 offset:8192
s_nop 0
M v[32:35],v[148:151],a[44:47],v[32:35]
ds_read_b64_tr_b16 v[142:143],v165 offset:9216
ds_read_b32 v218,v223 offset:0
M v[32:35],v[144:147],a[40:43],v[32:35]
s_nop 0
ds_read_b32 v219,v223 offset:256
M v[64:67],v[144:147],a[48:51],v[64:67]
buffer_load_dwordx4 v170,s[20:23],s46 offen offset:2048 nt lds
M v[64:67],v[148:151],a[52:55],v[64:67]
s_nop 0
ds_read_b32 v220,v223 offset:512
M v[96:99],v[148:151],a[60:63],v[96:99]
buffer_load_dwordx4 v171,s[20:23],s46 offen offset:3072 nt lds
M v[96:99],v[144:147],a[56:59],v[96:99]
s_nop 0
MS v[156:159],v[160:163],v[128:135],v255
ds_read_b64_tr_b16 v[144:145],v165 offset:8
ds_read_b32 v221,v223 offset:768
M v[4:7],v[128:131],a[32:35],v[4:7]
ds_read_b64_tr_b16 v[146:147],v165 offset:1032
s_nop 0
M v[4:7],v[132:135],a[36:39],v[4:7]
ds_read_b64_tr_b16 v[148:149],v165 offset:8200
v_add_u32 v167,0x10000,v167
M v[36:39],v[132:135],a[44:47],v[36:39]
ds_read_b64_tr_b16 v[150:151],v165 offset:9224
ds_read_b32 v222,v223 offset:1024
M v[36:39],v[128:131],a[40:43],v[36:39]
s_nop 0
v_mov_b32 v217,0
M v[68:71],v[128:131],a[48:51],v[68:71]
s_waitcnt lgkmcnt(0)
v_and_b32 v223,0xffff0000,v218
M v[68:71],v[132:135],a[52:55],v[68:71]
v_lshlrev_b32 v218,16,v218
v_add_f32 v217,v217,v223
M v[100:103],v[132:135],a[60:63],v[100:103]
v_add_f32 v217,v217,v218
v_and_b32 v223,0xffff0000,v219
M v[100:103],v[128:131],a[56:59],v[100:103]
v_lshlrev_b32 v219,16,v219
M v[8:11],v[136:139],a[32:35],v[8:11]
ds_read_b64_tr_b16 v[128:129],v166 offset:0
v_add_f32 v217,v217,v223
M v[8:11],v[140:143],a[36:39],v[8:11]
ds_read_b64_tr_b16 v[130:131],v166 offset:1024
s_add_u32 s46,s46,524288
M v[40:43],v[140:143],a[44:47],v[40:43]
ds_read_b64_tr_b16 v[132:133],v166 offset:8192
v_add_f32 v217,v217,v219
M v[40:43],v[136:139],a[40:43],v[40:43]
ds_read_b64_tr_b16 v[134:135],v166 offset:9216
s_waitcnt vmcnt(16)
M v[72:75],v[136:139],a[48:51],v[72:75]
ds_read_b128 a[64:67],v172 offset:0
v_and_b32 v223,0xffff0000,v220
M v[72:75],v[140:143],a[52:55],v[72:75]
ds_read_b128 a[68:71],v173 offset:0
v_lshlrev_b32 v220,16,v220
M v[104:107],v[140:143],a[60:63],v[104:107]
ds_read_b128 a[72:75],v172 offset:2048
v_add_f32 v217,v217,v223
M v[104:107],v[136:139],a[56:59],v[104:107]
ds_read_b128 a[76:79],v173 offset:2048
M v[12:15],v[144:147],a[32:35],v[12:15]
ds_read_b64_tr_b16 v[136:137],v166 offset:8
v_add_f32 v217,v217,v220
M v[12:15],v[148:151],a[36:39],v[12:15]
ds_read_b64_tr_b16 v[138:139],v166 offset:1032
v_and_b32 v223,0xffff0000,v221
M v[44:47],v[148:151],a[44:47],v[44:47]
ds_read_b64_tr_b16 v[140:141],v166 offset:8200
v_lshlrev_b32 v221,16,v221
M v[44:47],v[144:147],a[40:43],v[44:47]
ds_read_b64_tr_b16 v[142:143],v166 offset:9224
v_add_f32 v217,v217,v223
M v[76:79],v[144:147],a[48:51],v[76:79]
ds_read_b128 a[80:83],v172 offset:4096
v_add_f32 v217,v217,v221
M v[76:79],v[148:151],a[52:55],v[76:79]
ds_read_b128 a[84:87],v173 offset:4096
v_and_b32 v223,0xffff0000,v222
M v[108:111],v[148:151],a[60:63],v[108:111]
ds_read_b128 a[88:91],v172 offset:6144
v_lshlrev_b32 v222,16,v222
M v[108:111],v[144:147],a[56:59],v[108:111]
ds_read_b128 a[92:95],v173 offset:6144
s_waitcnt lgkmcnt(12)
M v[16:19],v[128:131],a[32:35],v[16:19]
ds_read_b64_tr_b16 v[144:145],v167 offset:0
v_add_f32 v217,v217,v223
M v[16:19],v[132:135],a[36:39],v[16:19]
ds_read_b64_tr_b16 v[146:147],v167 offset:1024
v_add_f32 v217,v217,v222
M v[48:51],v[132:135],a[44:47],v[48:51]
ds_read_b64_tr_b16 v[148:149],v167 offset:8192
s_nop 1
M v[48:51],v[128:131],a[40:43],v[48:51]
ds_read_b64_tr_b16 v[150:151],v167 offset:9216
s_add_u32 m0,s68,0
s_waitcnt lgkmcnt(4)
M v[80:83],v[128:131],a[48:51],v[80:83]
buffer_load_dwordx4 v243,s[8:11],s58 offen offset:0 lds
M v[80:83],v[132:135],a[52:55],v[80:83]
buffer_load_dwordx4 v244,s[8:11],s59 offen offset:1024 lds
M v[112:115],v[132:135],a[60:63],v[112:115]
buffer_load_dwordx4 v243,s[8:11],s60 offen offset:2048 lds
M v[112:115],v[128:131],a[56:59],v[112:115]
buffer_load_dwordx4 v244,s[8:11],s61 offen offset:3072 lds
M v[20:23],v[136:139],a[32:35],v[20:23]
ds_read_b64_tr_b16 v[128:129],v167 offset:8
M v[20:23],v[140:143],a[36:39],v[20:23]
ds_read_b64_tr_b16 v[130:131],v167 offset:1032
v_add_f32_dpp v217,v217,v217 row_ror:8 row_mask:0xf bank_mask:0xf
M v[52:55],v[140:143],a[44:47],v[52:55]
ds_read_b64_tr_b16 v[132:133],v167 offset:8200
s_nop 1
M v[52:55],v[136:139],a[40:43],v[52:55]
ds_read_b64_tr_b16 v[134:135],v167 offset:9224
M v[84:87],v[136:139],a[48:51],v[84:87]
v_add_u32 v164,0x4000,v164
s_add_u32 m0,s68,4096
M v[84:87],v[140:143],a[52:55],v[84:87]
buffer_load_dwordx4 v243,s[8:11],s62 offen offset:0 lds
M v[116:119],v[140:143],a[60:63],v[116:119]
buffer_load_dwordx4 v244,s[8:11],s63 offen offset:1024 lds
M v[116:119],v[136:139],a[56:59],v[116:119]
buffer_load_dwordx4 v243,s[8:11],s64 offen offset:2048 lds
s_waitcnt lgkmcnt(4)
s_waitcnt vmcnt(19)
M v[24:27],v[144:147],a[32:35],v[24:27]
s_barrier
M v[24:27],v[148:151],a[36:39],v[24:27]
ds_read_b64_tr_b16 v[136:137],v164 offset:0
v_add_f32_dpp v217,v217,v217 row_ror:4 row_mask:0xf bank_mask:0xf
M v[56:59],v[148:151],a[44:47],v[56:59]
ds_read_b64_tr_b16 v[138:139],v164 offset:1024
s_nop 1
M v[56:59],v[144:147],a[40:43],v[56:59]
ds_read_b64_tr_b16 v[140:141],v164 offset:8192
v_add_f32_dpp v217,v217,v217 row_ror:2 row_mask:0xf bank_mask:0xf
M v[88:91],v[144:147],a[48:51],v[88:91]
ds_read_b64_tr_b16 v[142:143],v164 offset:9216
s_nop 1
M v[88:91],v[148:151],a[52:55],v[88:91]
v_add_f32_dpp v217,v217,v217 row_ror:1 row_mask:0xf bank_mask:0xf
M v[120:123],v[148:151],a[60:63],v[120:123]
buffer_load_dwordx4 v244,s[8:11],s65 offen offset:3072 lds
v_add_u32 v243,128,v243
v_add_u32 v244,128,v244
M v[120:123],v[144:147],a[56:59],v[120:123]
s_waitcnt lgkmcnt(4)
M v[28:31],v[128:131],a[32:35],v[28:31]
ds_read_b64_tr_b16 v[144:145],v164 offset:8
v_mov_b32 v223,v217
M v[28:31],v[132:135],a[36:39],v[28:31]
ds_read_b64_tr_b16 v[146:147],v164 offset:1032
v_add_u32 v165,0x4000,v165
M v[60:63],v[132:135],a[44:47],v[60:63]
ds_read_b64_tr_b16 v[148:149],v164 offset:8200
v_add_u32 v166,0x4000,v166
M v[60:63],v[128:131],a[40:43],v[60:63]
ds_read_b64_tr_b16 v[150:151],v164 offset:9224
s_nop 1
M v[92:95],v[128:131],a[48:51],v[92:95]
v_permlane32_swap_b32 v217,v223
v_add_f32 v217,v217,v223
M v[92:95],v[132:135],a[52:55],v[92:95]
ds_read2_b32 v[208:209],v216 offset0:64 offset1:66
v_mov_b32 v223,v217
M v[124:127],v[132:135],a[60:63],v[124:127]
ds_read2_b32 v[210:211],v216 offset0:68 offset1:70
s_nop 1
M v[124:127],v[128:131],a[56:59],v[124:127]
v_permlane16_swap_b32 v217,v223
v_add_f32 v217,v217,v223
s_waitcnt lgkmcnt(0)
MS v[192:195],v[208:211],a[64:71],v255
s_waitcnt vmcnt(12)
M v[176:179],a[64:67],a[64:67],v[176:179]
ds_read_b128 a[96:99],v174 offset:0
M v[176:179],a[68:71],a[68:71],v[176:179]
ds_read_b128 a[100:103],v175 offset:0
MS v[196:199],v[208:211],a[72:79],v255
ds_read_b128 a[104:107],v174 offset:2048
M v[180:183],a[72:75],a[72:75],v[180:183]
ds_read_b128 a[108:111],v175 offset:2048
M v[180:183],a[76:79],a[76:79],v[180:183]
ds_read_b128 a[112:115],v174 offset:4096
MS v[200:203],v[208:211],a[80:87],v255
ds_read_b128 a[116:119],v175 offset:4096
M v[184:187],a[80:83],a[80:83],v[184:187]
ds_read_b128 a[120:123],v174 offset:6144
M v[184:187],a[84:87],a[84:87],v[184:187]
ds_read_b128 a[124:127],v175 offset:6144
s_add_u32 m0,s48,32768
MS v[204:207],v[208:211],a[88:95],v255
buffer_load_dwordx4 v168,s[20:23],s46 offen offset:0 nt lds
M v[188:191],a[88:91],a[88:91],v[188:191]
M v[188:191],a[92:95],a[92:95],v[188:191]
buffer_load_dwordx4 v169,s[20:23],s46 offen offset:1024 nt lds
MS v[152:155],v[160:163],v[136:143],v255
ds_read_b64_tr_b16 v[128:129],v165 offset:0
M v[0:3],v[136:139],a[64:67],v[0:3]
ds_read_b64_tr_b16 v[130:131],v165 offset:1024
M v[0:3],v[140:143],a[68:71],v[0:3]
ds_read_b64_tr_b16 v[132:133],v165 offset:8192
M v[32:35],v[140:143],a[76:79],v[32:35]
ds_read_b64_tr_b16 v[134:135],v165 offset:9216
M v[32:35],v[136:139],a[72:75],v[32:35]
M v[64:67],v[136:139],a[80:83],v[64:67]
buffer_load_dwordx4 v170,s[20:23],s46 offen offset:2048 nt lds
M v[64:67],v[140:143],a[84:87],v[64:67]
M v[96:99],v[140:143],a[92:95],v[96:99]
buffer_load_dwordx4 v171,s[20:23],s46 offen offset:3072 nt lds
M v[96:99],v[136:139],a[88:91],v[96:99]
MS v[156:159],v[160:163],v[144:151],v255
ds_read_b64_tr_b16 v[136:137],v165 offset:8
M v[4:7],v[144:147],a[64:67],v[4:7]
ds_read_b64_tr_b16 v[138:139],v165 offset:1032
M v[4:7],v[148:151],a[68:71],v[4:7]
ds_read_b64_tr_b16 v[140:141],v165 offset:8200
v_add_u32 v167,0x4000,v167
M v[36:39],v[148:151],a[76:79],v[36:39]
ds_read_b64_tr_b16 v[142:143],v165 offset:9224
M v[36:39],v[144:147],a[72:75],v[36:39]
M v[68:71],v[144:147],a[80:83],v[68:71]
M v[68:71],v[148:151],a[84:87],v[68:71]
M v[100:103],v[148:151],a[92:95],v[100:103]
M v[100:103],v[144:147],a[88:91],v[100:103]
s_waitcnt lgkmcnt(4)
M v[8:11],v[128:131],a[64:67],v[8:11]
ds_read_b64_tr_b16 v[144:145],v166 offset:0
M v[8:11],v[132:135],a[68:71],v[8:11]
ds_read_b64_tr_b16 v[146:147],v166 offset:1024
s_add_u32 s46,s46,524288
M v[40:43],v[132:135],a[76:79],v[40:43]
ds_read_b64_tr_b16 v[148:149],v166 offset:8192
M v[40:43],v[128:131],a[72:75],v[40:43]
ds_read_b64_tr_b16 v[150:151],v166 offset:9216
M v[72:75],v[128:131],a[80:83],v[72:75]
s_add_u32 m0,s69,0
M v[72:75],v[132:135],a[84:87],v[72:75]
buffer_load_dwordx4 v243,s[8:11],s58 offen offset:0 lds
M v[104:107],v[132:135],a[92:95],v[104:107]
M v[104:107],v[128:131],a[88:91],v[104:107]
buffer_load_dwordx4 v244,s[8:11],s59 offen offset:1024 lds
s_waitcnt lgkmcnt(4)
M v[12:15],v[136:139],a[64:67],v[12:15]
ds_read_b64_tr_b16 v[128:129],v166 offset:8
M v[12:15],v[140:143],a[68:71],v[12:15]
ds_read_b64_tr_b16 v[130:131],v166 offset:1032
M v[44:47],v[140:143],a[76:79],v[44:47]
ds_read_b64_tr_b16 v[132:133],v166 offset:8200
M v[44:47],v[136:139],a[72:75],v[44:47]
ds_read_b64_tr_b16 v[134:135],v166 offset:9224
M v[76:79],v[136:139],a[80:83],v[76:79]
M v[76:79],v[140:143],a[84:87],v[76:79]
buffer_load_dwordx4 v243,s[8:11],s60 offen offset:2048 lds
M v[108:111],v[140:143],a[92:95],v[108:111]
M v[108:111],v[136:139],a[88:91],v[108:111]
buffer_load_dwordx4 v244,s[8:11],s61 offen offset:3072 lds
s_waitcnt lgkmcnt(4)
M v[16:19],v[144:147],a[64:67],v[16:19]
ds_read_b64_tr_b16 v[136:137],v167 offset:0
M v[16:19],v[148:151],a[68:71],v[16:19]
ds_read_b64_tr_b16 v[138:139],v167 offset:1024
M v[48:51],v[148:151],a[76:79],v[48:51]
ds_read_b64_tr_b16 v[140:141],v167 offset:8192
M v[48:51],v[144:147],a[72:75],v[48:51]
ds_read_b64_tr_b16 v[142:143],v167 offset:9216
M v[80:83],v[144:147],a[80:83],v[80:83]
s_add_u32 m0,s69,4096
M v[80:83],v[148:151],a[84:87],v[80:83]
buffer_load_dwordx4 v243,s[8:11],s62 offen offset:0 lds
M v[112:115],v[148:151],a[92:95],v[112:115]
M v[112:115],v[144:147],a[88:91],v[112:115]
buffer_load_dwordx4 v244,s[8:11],s63 offen offset:1024 lds
s_waitcnt lgkmcnt(4)
M v[20:23],v[128:131],a[64:67],v[20:23]
ds_read_b64_tr_b16 v[144:145],v167 offset:8
M v[20:23],v[132:135],a[68:71],v[20:23]
ds_read_b64_tr_b16 v[146:147],v167 offset:1032
M v[52:55],v[132:135],a[76:79],v[52:55]
ds_read_b64_tr_b16 v[148:149],v167 offset:8200
M v[52:55],v[128:131],a[72:75],v[52:55]
ds_read_b64_tr_b16 v[150:151],v167 offset:9224
M v[84:87],v[128:131],a[80:83],v[84:87]
v_add_u32 v164,0xffff4000,v164
M v[84:87],v[132:135],a[84:87],v[84:87]
buffer_load_dwordx4 v243,s[8:11],s64 offen offset:2048 lds
M v[116:119],v[132:135],a[92:95],v[116:119]
M v[116:119],v[128:131],a[88:91],v[116:119]
buffer_load_dwordx4 v244,s[8:11],s65 offen offset:3072 lds
v_add_u32 v243,128,v243
v_add_u32 v244,128,v244
s_waitcnt lgkmcnt(4)
s_waitcnt vmcnt(20)
M v[24:27],v[136:139],a[64:67],v[24:27]
s_barrier
M v[24:27],v[140:143],a[68:71],v[24:27]
ds_read_b64_tr_b16 v[128:129],v164 offset:0
M v[56:59],v[140:143],a[76:79],v[56:59]
ds_read_b64_tr_b16 v[130:131],v164 offset:1024
M v[56:59],v[136:139],a[72:75],v[56:59]
ds_read_b64_tr_b16 v[132:133],v164 offset:8192
M v[88:91],v[136:139],a[80:83],v[88:91]
ds_read_b64_tr_b16 v[134:135],v164 offset:9216
M v[88:91],v[140:143],a[84:87],v[88:91]
M v[120:123],v[140:143],a[92:95],v[120:123]
M v[120:123],v[136:139],a[88:91],v[120:123]
s_waitcnt lgkmcnt(4)
M v[28:31],v[144:147],a[64:67],v[28:31]
ds_read_b64_tr_b16 v[136:137],v164 offset:8
M v[28:31],v[148:151],a[68:71],v[28:31]
ds_read_b64_tr_b16 v[138:139],v164 offset:1032
v_add_u32 v165,0xffff4000,v165
M v[60:63],v[148:151],a[76:79],v[60:63]
ds_read_b64_tr_b16 v[140:141],v164 offset:8200
v_add_u32 v166,0xffff4000,v166
M v[60:63],v[144:147],a[72:75],v[60:63]
ds_read_b64_tr_b16 v[142:143],v164 offset:9224
M v[92:95],v[144:147],a[80:83],v[92:95]
M v[92:95],v[148:151],a[84:87],v[92:95]
ds_read2_b32 v[208:209],v216 offset0:96 offset1:98
M v[124:127],v[148:151],a[92:95],v[124:127]
ds_read2_b32 v[210:211],v216 offset0:100 offset1:102
M v[124:127],v[144:147],a[88:91],v[124:127]
s_waitcnt lgkmcnt(0)
MS v[192:195],v[208:211],a[96:103],v255
s_waitcnt vmcnt(12)
M v[176:179],a[96:99],a[96:99],v[176:179]
ds_read_b128 a[0:3],v172 offset:0
M v[176:179],a[100:103],a[100:103],v[176:179]
ds_read_b128 a[4:7],v173 offset:0
MS v[196:199],v[208:211],a[104:111],v255
ds_read_b128 a[8:11],v172 offset:2048
M v[180:183],a[104:107],a[104:107],v[180:183]
ds_read_b128 a[12:15],v173 offset:2048
M v[180:183],a[108:111],a[108:111],v[180:183]
ds_read_b128 a[16:19],v172 offset:4096
MS v[200:203],v[208:211],a[112:119],v255
ds_read_b128 a[20:23],v173 offset:4096
M v[184:187],a[112:115],a[112:115],v[184:187]
ds_read_b128 a[24:27],v172 offset:6144
M v[184:187],a[116:119],a[116:119],v[184:187]
ds_read_b128 a[28:31],v173 offset:6144
s_add_u32 m0,s48,98304
MS v[204:207],v[208:211],a[120:127],v255
buffer_load_dwordx4 v168,s[20:23],s46 offen offset:0 nt lds
M v[188:191],a[120:123],a[120:123],v[188:191]
M v[188:191],a[124:127],a[124:127],v[188:191]
buffer_load_dwordx4 v169,s[20:23],s46 offen offset:1024 nt lds
MS v[152:155],v[160:163],v[128:135],v255
ds_read_b64_tr_b16 v[144:145],v165 offset:0
v_and_b32 v251,15,v242
M v[0:3],v[128:131],a[96:99],v[0:3]
ds_read_b64_tr_b16 v[146:147],v165 offset:1024
v_lshrrev_b32 v252,4,v242
M v[0:3],v[132:135],a[100:103],v[0:3]
ds_read_b64_tr_b16 v[148:149],v165 offset:8192
M v[32:35],v[132:135],a[108:111],v[32:35]
ds_read_b64_tr_b16 v[150:151],v165 offset:9216
M v[32:35],v[128:131],a[104:107],v[32:35]
s_add_u32 s50,s40,0
s_and_b32 s50,s50,3
s_lshl_b32 s50,s50,2
v_or_b32 v253,s50,v252
M v[64:67],v[128:131],a[112:115],v[64:67]
buffer_load_dwordx4 v170,s[20:23],s46 offen offset:2048 nt lds
M v[64:67],v[132:135],a[116:119],v[64:67]
v_xor_b32 v253,v253,v251
v_lshlrev_b32 v253,4,v253
M v[96:99],v[132:135],a[124:127],v[96:99]
buffer_load_dwordx4 v171,s[20:23],s46 offen offset:3072 nt lds
M v[96:99],v[128:131],a[120:123],v[96:99]
v_lshl_add_u32 v224,v251,8,v253
MS v[156:159],v[160:163],v[136:143],v255
ds_read_b64_tr_b16 v[128:129],v165 offset:8
M v[4:7],v[136:139],a[96:99],v[4:7]
ds_read_b64_tr_b16 v[130:131],v165 offset:1032
M v[4:7],v[140:143],a[100:103],v[4:7]
ds_read_b64_tr_b16 v[132:133],v165 offset:8200
v_add_u32 v167,0xffff4000,v167
M v[36:39],v[140:143],a[108:111],v[36:39]
ds_read_b64_tr_b16 v[134:135],v165 offset:9224
M v[36:39],v[136:139],a[104:107],v[36:39]
s_add_u32 s50,s40,1
s_and_b32 s50,s50,3
s_lshl_b32 s50,s50,2
v_or_b32 v253,s50,v252
M v[68:71],v[136:139],a[112:115],v[68:71]
v_xor_b32 v253,v253,v251
v_lshlrev_b32 v253,4,v253
M v[68:71],v[140:143],a[116:119],v[68:71]
v_lshl_add_u32 v225,v251,8,v253
M v[100:103],v[140:143],a[124:127],v[100:103]
s_add_u32 s50,s40,2
s_and_b32 s50,s50,3
s_lshl_b32 s50,s50,2
v_or_b32 v253,s50,v252
M v[100:103],v[136:139],a[120:123],v[100:103]
v_xor_b32 v253,v253,v251
s_waitcnt lgkmcnt(4)
M v[8:11],v[144:147],a[96:99],v[8:11]
ds_read_b64_tr_b16 v[136:137],v166 offset:0
v_lshlrev_b32 v253,4,v253
M v[8:11],v[148:151],a[100:103],v[8:11]
ds_read_b64_tr_b16 v[138:139],v166 offset:1024
s_add_u32 s46,s46,524288
M v[40:43],v[148:151],a[108:111],v[40:43]
ds_read_b64_tr_b16 v[140:141],v166 offset:8192
v_lshl_add_u32 v226,v251,8,v253
M v[40:43],v[144:147],a[104:107],v[40:43]
ds_read_b64_tr_b16 v[142:143],v166 offset:9216
M v[72:75],v[144:147],a[112:115],v[72:75]
s_add_u32 m0,s68,0
M v[72:75],v[148:151],a[116:119],v[72:75]
buffer_load_dwordx4 v243,s[8:11],s58 offen offset:0 lds
M v[104:107],v[148:151],a[124:127],v[104:107]
s_add_u32 s50,s40,3
s_and_b32 s50,s50,3
s_lshl_b32 s50,s50,2
v_or_b32 v253,s50,v252
M v[104:107],v[144:147],a[120:123],v[104:107]
buffer_load_dwordx4 v244,s[8:11],s59 offen offset:1024 lds
s_waitcnt lgkmcnt(4)
M v[12:15],v[128:131],a[96:99],v[12:15]
ds_read_b64_tr_b16 v[144:145],v166 offset:8
M v[12:15],v[132:135],a[100:103],v[12:15]
ds_read_b64_tr_b16 v[146:147],v166 offset:1032
M v[44:47],v[132:135],a[108:111],v[44:47]
ds_read_b64_tr_b16 v[148:149],v166 offset:8200
v_xor_b32 v253,v253,v251
M v[44:47],v[128:131],a[104:107],v[44:47]
ds_read_b64_tr_b16 v[150:151],v166 offset:9224
v_lshlrev_b32 v253,4,v253
M v[76:79],v[128:131],a[112:115],v[76:79]
v_lshl_add_u32 v227,v251,8,v253
v_lshlrev_b32 v253,8,v252
M v[76:79],v[132:135],a[116:119],v[76:79]
buffer_load_dwordx4 v243,s[8:11],s60 offen offset:2048 lds
M v[108:111],v[132:135],a[124:127],v[108:111]
v_add_u32 v253,s48,v253
M v[108:111],v[128:131],a[120:123],v[108:111]
buffer_load_dwordx4 v244,s[8:11],s61 offen offset:3072 lds
s_waitcnt lgkmcnt(4)
M v[16:19],v[136:139],a[96:99],v[16:19]
ds_read_b64_tr_b16 v[128:129],v167 offset:0
M v[16:19],v[140:143],a[100:103],v[16:19]
ds_read_b64_tr_b16 v[130:131],v167 offset:1024
v_xor_b32 v236,v251,v252
M v[48:51],v[140:143],a[108:111],v[48:51]
ds_read_b64_tr_b16 v[132:133],v167 offset:8192
v_lshl_add_u32 v236,v236,4,v253
M v[48:51],v[136:139],a[104:107],v[48:51]
ds_read_b64_tr_b16 v[134:135],v167 offset:9216
v_xor_b32 v237,64,v236
M v[80:83],v[136:139],a[112:115],v[80:83]
v_xor_b32 v238,128,v236
s_add_u32 m0,s68,4096
M v[80:83],v[140:143],a[116:119],v[80:83]
buffer_load_dwordx4 v243,s[8:11],s62 offen offset:0 lds
M v[112:115],v[140:143],a[124:127],v[112:115]
v_xor_b32 v239,192,v236
v_lshlrev_b32 v252,1,v252
M v[112:115],v[136:139],a[120:123],v[112:115]
buffer_load_dwordx4 v244,s[8:11],s63 offen offset:1024 lds
s_waitcnt lgkmcnt(4)
M v[20:23],v[144:147],a[96:99],v[20:23]
ds_read_b64_tr_b16 v[136:137],v167 offset:8
M v[20:23],v[148:151],a[100:103],v[20:23]
ds_read_b64_tr_b16 v[138:139],v167 offset:1032
v_xor_b32 v252,v252,v251
M v[52:55],v[148:151],a[108:111],v[52:55]
ds_read_b64_tr_b16 v[140:141],v167 offset:8200
v_lshl_add_u32 v240,v252,4,v253
M v[52:55],v[144:147],a[104:107],v[52:55]
ds_read_b64_tr_b16 v[142:143],v167 offset:9224
v_xor_b32 v241,128,v240
M v[84:87],v[144:147],a[112:115],v[84:87]
v_lshrrev_b32 v251,2,v242
v_add_u32 v164,0xffff8000,v164
M v[84:87],v[148:151],a[116:119],v[84:87]
buffer_load_dwordx4 v243,s[8:11],s64 offen offset:2048 lds
M v[116:119],v[148:151],a[124:127],v[116:119]
M v[116:119],v[144:147],a[120:123],v[116:119]
buffer_load_dwordx4 v244,s[8:11],s65 offen offset:3072 lds
v_add_u32 v243,128,v243
v_add_u32 v244,128,v244
s_waitcnt lgkmcnt(4)
s_waitcnt vmcnt(20)
M v[24:27],v[128:131],a[96:99],v[24:27]
s_barrier
M v[24:27],v[132:135],a[100:103],v[24:27]
ds_read_b64_tr_b16 v[144:145],v164 offset:0
M v[56:59],v[132:135],a[108:111],v[56:59]
ds_read_b64_tr_b16 v[146:147],v164 offset:1024
v_and_b32 v252,7,v251
M v[56:59],v[128:131],a[104:107],v[56:59]
ds_read_b64_tr_b16 v[148:149],v164 offset:8192
v_lshlrev_b32 v252,1,v252
M v[88:91],v[128:131],a[112:115],v[88:91]
ds_read_b64_tr_b16 v[150:151],v164 offset:9216
v_bfe_u32 v253,v242,1,1
M v[88:91],v[132:135],a[116:119],v[88:91]
v_xor_b32 v252,v252,v253
v_lshlrev_b32 v252,4,v252
M v[120:123],v[132:135],a[124:127],v[120:123]
v_lshl_add_u32 v252,v251,8,v252
v_and_b32 v253,1,v242
M v[120:123],v[128:131],a[120:123],v[120:123]
v_lshl_add_u32 v252,v253,3,v252
s_waitcnt lgkmcnt(4)
M v[28:31],v[136:139],a[96:99],v[28:31]
ds_read_b64_tr_b16 v[128:129],v164 offset:8
v_add_u32 v228,0x10000,v252
M v[28:31],v[140:143],a[100:103],v[28:31]
ds_read_b64_tr_b16 v[130:131],v164 offset:1032
v_add_u32 v165,0xffff8000,v165
M v[60:63],v[140:143],a[108:111],v[60:63]
ds_read_b64_tr_b16 v[132:133],v164 offset:8200
v_add_u32 v166,0xffff8000,v166
M v[60:63],v[136:139],a[104:107],v[60:63]
ds_read_b64_tr_b16 v[134:135],v164 offset:9224
v_xor_b32 v229,32,v228
M v[92:95],v[136:139],a[112:115],v[92:95]
v_xor_b32 v230,64,v228
v_xor_b32 v231,96,v228
M v[92:95],v[140:143],a[116:119],v[92:95]
ds_read2_b32 v[208:209],v216 offset0:128 offset1:130
v_xor_b32 v232,128,v228
M v[124:127],v[140:143],a[124:127],v[124:127]
ds_read2_b32 v[210:211],v216 offset0:132 offset1:134
v_xor_b32 v233,160,v228
M v[124:127],v[136:139],a[120:123],v[124:127]
v_xor_b32 v234,192,v228
v_xor_b32 v235,224,v228
s_waitcnt lgkmcnt(0)
MS v[192:195],v[208:211],a[0:7],v255
s_waitcnt vmcnt(12)
M v[176:179],a[0:3],a[0:3],v[176:179]
ds_read_b128 a[32:35],v174 offset:0
M v[176:179],a[4:7],a[4:7],v[176:179]
ds_read_b128 a[36:39],v175 offset:0
MS v[196:199],v[208:211],a[8:15],v255
ds_read_b128 a[40:43],v174 offset:2048
M v[180:183],a[8:11],a[8:11],v[180:183]
ds_read_b128 a[44:47],v175 offset:2048
M v[180:183],a[12:15],a[12:15],v[180:183]
ds_read_b128 a[48:51],v174 offset:4096
MS v[200:203],v[208:211],a[16:23],v255
ds_read_b128 a[52:55],v175 offset:4096
M v[184:187],a[16:19],a[16:19],v[184:187]
ds_read_b128 a[56:59],v174 offset:6144
M v[184:187],a[20:23],a[20:23],v[184:187]
ds_read_b128 a[60:63],v175 offset:6144
s_add_u32 m0,s48,114688
MS v[204:207],v[208:211],a[24:31],v255
buffer_load_dwordx4 v168,s[20:23],s46 offen offset:0 nt lds
M v[188:191],a[24:27],a[24:27],v[188:191]
M v[188:191],a[28:31],a[28:31],v[188:191]
buffer_load_dwordx4 v169,s[20:23],s46 offen offset:1024 nt lds
MS v[152:155],v[160:163],v[144:151],v255
ds_read_b64_tr_b16 v[136:137],v165 offset:0
M v[0:3],v[144:147],a[0:3],v[0:3]
ds_read_b64_tr_b16 v[138:139],v165 offset:1024
M v[0:3],v[148:151],a[4:7],v[0:3]
ds_read_b64_tr_b16 v[140:141],v165 offset:8192
M v[32:35],v[148:151],a[12:15],v[32:35]
ds_read_b64_tr_b16 v[142:143],v165 offset:9216
M v[32:35],v[144:147],a[8:11],v[32:35]
M v[64:67],v[144:147],a[16:19],v[64:67]
buffer_load_dwordx4 v170,s[20:23],s46 offen offset:2048 nt lds
M v[64:67],v[148:151],a[20:23],v[64:67]
M v[96:99],v[148:151],a[28:31],v[96:99]
buffer_load_dwordx4 v171,s[20:23],s46 offen offset:3072 nt lds
M v[96:99],v[144:147],a[24:27],v[96:99]
MS v[156:159],v[160:163],v[128:135],v255
ds_read_b64_tr_b16 v[144:145],v165 offset:8
M v[4:7],v[128:131],a[0:3],v[4:7]
ds_read_b64_tr_b16 v[146:147],v165 offset:1032
M v[4:7],v[132:135],a[4:7],v[4:7]
ds_read_b64_tr_b16 v[148:149],v165 offset:8200
v_add_u32 v167,0xffff8000,v167
M v[36:39],v[132:135],a[12:15],v[36:39]
ds_read_b64_tr_b16 v[150:151],v165 offset:9224
M v[36:39],v[128:131],a[8:11],v[36:39]
M v[68:71],v[128:131],a[16:19],v[68:71]
M v[68:71],v[132:135],a[20:23],v[68:71]
M v[100:103],v[132:135],a[28:31],v[100:103]
M v[100:103],v[128:131],a[24:27],v[100:103]
s_waitcnt lgkmcnt(4)
M v[8:11],v[136:139],a[0:3],v[8:11]
ds_read_b64_tr_b16 v[128:129],v166 offset:0
M v[8:11],v[140:143],a[4:7],v[8:11]
ds_read_b64_tr_b16 v[130:131],v166 offset:1024
s_add_u32 s46,s46,524288
M v[40:43],v[140:143],a[12:15],v[40:43]
ds_read_b64_tr_b16 v[132:133],v166 offset:8192
M v[40:43],v[136:139],a[8:11],v[40:43]
ds_read_b64_tr_b16 v[134:135],v166 offset:9216
M v[72:75],v[136:139],a[16:19],v[72:75]
s_add_u32 m0,s69,0
M v[72:75],v[140:143],a[20:23],v[72:75]
buffer_load_dwordx4 v243,s[8:11],s58 offen offset:0 lds
M v[104:107],v[140:143],a[28:31],v[104:107]
M v[104:107],v[136:139],a[24:27],v[104:107]
buffer_load_dwordx4 v244,s[8:11],s59 offen offset:1024 lds
s_waitcnt lgkmcnt(4)
M v[12:15],v[144:147],a[0:3],v[12:15]
ds_read_b64_tr_b16 v[136:137],v166 offset:8
M v[12:15],v[148:151],a[4:7],v[12:15]
ds_read_b64_tr_b16 v[138:139],v166 offset:1032
M v[44:47],v[148:151],a[12:15],v[44:47]
ds_read_b64_tr_b16 v[140:141],v166 offset:8200
M v[44:47],v[144:147],a[8:11],v[44:47]
ds_read_b64_tr_b16 v[142:143],v166 offset:9224
M v[76:79],v[144:147],a[16:19],v[76:79]
M v[76:79],v[148:151],a[20:23],v[76:79]
buffer_load_dwordx4 v243,s[8:11],s60 offen offset:2048 lds
M v[108:111],v[148:151],a[28:31],v[108:111]
M v[108:111],v[144:147],a[24:27],v[108:111]
buffer_load_dwordx4 v244,s[8:11],s61 offen offset:3072 lds
s_waitcnt lgkmcnt(4)
M v[16:19],v[128:131],a[0:3],v[16:19]
ds_read_b64_tr_b16 v[144:145],v167 offset:0
M v[16:19],v[132:135],a[4:7],v[16:19]
ds_read_b64_tr_b16 v[146:147],v167 offset:1024
M v[48:51],v[132:135],a[12:15],v[48:51]
ds_read_b64_tr_b16 v[148:149],v167 offset:8192
M v[48:51],v[128:131],a[8:11],v[48:51]
ds_read_b64_tr_b16 v[150:151],v167 offset:9216
M v[80:83],v[128:131],a[16:19],v[80:83]
s_add_u32 m0,s69,4096
M v[80:83],v[132:135],a[20:23],v[80:83]
buffer_load_dwordx4 v243,s[8:11],s62 offen offset:0 lds
M v[112:115],v[132:135],a[28:31],v[112:115]
M v[112:115],v[128:131],a[24:27],v[112:115]
buffer_load_dwordx4 v244,s[8:11],s63 offen offset:1024 lds
s_waitcnt lgkmcnt(4)
M v[20:23],v[136:139],a[0:3],v[20:23]
ds_read_b64_tr_b16 v[128:129],v167 offset:8
M v[20:23],v[140:143],a[4:7],v[20:23]
ds_read_b64_tr_b16 v[130:131],v167 offset:1032
M v[52:55],v[140:143],a[12:15],v[52:55]
ds_read_b64_tr_b16 v[132:133],v167 offset:8200
M v[52:55],v[136:139],a[8:11],v[52:55]
ds_read_b64_tr_b16 v[134:135],v167 offset:9224
M v[84:87],v[136:139],a[16:19],v[84:87]
v_add_u32 v164,0x10000,v164
M v[84:87],v[140:143],a[20:23],v[84:87]
buffer_load_dwordx4 v243,s[8:11],s64 offen offset:2048 lds
M v[116:119],v[140:143],a[28:31],v[116:119]
M v[116:119],v[136:139],a[24:27],v[116:119]
buffer_load_dwordx4 v244,s[8:11],s65 offen offset:3072 lds
v_add_u32 v243,128,v243
v_add_u32 v244,128,v244
s_waitcnt lgkmcnt(4)
s_waitcnt vmcnt(20)
M v[24:27],v[144:147],a[0:3],v[24:27]
s_barrier
M v[24:27],v[148:151],a[4:7],v[24:27]
ds_read_b64_tr_b16 v[136:137],v164 offset:0
M v[56:59],v[148:151],a[12:15],v[56:59]
ds_read_b64_tr_b16 v[138:139],v164 offset:1024
M v[56:59],v[144:147],a[8:11],v[56:59]
ds_read_b64_tr_b16 v[140:141],v164 offset:8192
M v[88:91],v[144:147],a[16:19],v[88:91]
ds_read_b64_tr_b16 v[142:143],v164 offset:9216
M v[88:91],v[148:151],a[20:23],v[88:91]
M v[120:123],v[148:151],a[28:31],v[120:123]
M v[120:123],v[144:147],a[24:27],v[120:123]
s_waitcnt lgkmcnt(4)
M v[28:31],v[128:131],a[0:3],v[28:31]
ds_read_b64_tr_b16 v[144:145],v164 offset:8
M v[28:31],v[132:135],a[4:7],v[28:31]
ds_read_b64_tr_b16 v[146:147],v164 offset:1032
v_add_u32 v165,0x10000,v165
M v[60:63],v[132:135],a[12:15],v[60:63]
ds_read_b64_tr_b16 v[148:149],v164 offset:8200
v_add_u32 v166,0x10000,v166
M v[60:63],v[128:131],a[8:11],v[60:63]
ds_read_b64_tr_b16 v[150:151],v164 offset:9224
M v[92:95],v[128:131],a[16:19],v[92:95]
M v[92:95],v[132:135],a[20:23],v[92:95]
ds_read2_b32 v[208:209],v216 offset0:160 offset1:162
M v[124:127],v[132:135],a[28:31],v[124:127]
ds_read2_b32 v[210:211],v216 offset0:164 offset1:166
M v[124:127],v[128:131],a[24:27],v[124:127]
s_waitcnt lgkmcnt(0)
MS v[192:195],v[208:211],a[32:39],v255
s_waitcnt vmcnt(12)
M v[176:179],a[32:35],a[32:35],v[176:179]
ds_read_b128 a[64:67],v172 offset:0
M v[176:179],a[36:39],a[36:39],v[176:179]
ds_read_b128 a[68:71],v173 offset:0
MS v[196:199],v[208:211],a[40:47],v255
ds_read_b128 a[72:75],v172 offset:2048
M v[180:183],a[40:43],a[40:43],v[180:183]
ds_read_b128 a[76:79],v173 offset:2048
M v[180:183],a[44:47],a[44:47],v[180:183]
ds_read_b128 a[80:83],v172 offset:4096
MS v[200:203],v[208:211],a[48:55],v255
ds_read_b128 a[84:87],v173 offset:4096
M v[184:187],a[48:51],a[48:51],v[184:187]
ds_read_b128 a[88:91],v172 offset:6144
M v[184:187],a[52:55],a[52:55],v[184:187]
ds_read_b128 a[92:95],v173 offset:6144
s_add_u32 m0,s48,65536
MS v[204:207],v[208:211],a[56:63],v255
buffer_load_dwordx4 v168,s[20:23],s46 offen offset:0 nt lds
M v[188:191],a[56:59],a[56:59],v[188:191]
M v[188:191],a[60:63],a[60:63],v[188:191]
buffer_load_dwordx4 v169,s[20:23],s46 offen offset:1024 nt lds
MS v[152:155],v[160:163],v[136:143],v255
ds_read_b64_tr_b16 v[128:129],v165 offset:0
M v[0:3],v[136:139],a[32:35],v[0:3]
ds_read_b64_tr_b16 v[130:131],v165 offset:1024
M v[0:3],v[140:143],a[36:39],v[0:3]
ds_read_b64_tr_b16 v[132:133],v165 offset:8192
M v[32:35],v[140:143],a[44:47],v[32:35]
ds_read_b64_tr_b16 v[134:135],v165 offset:9216
M v[32:35],v[136:139],a[40:43],v[32:35]
M v[64:67],v[136:139],a[48:51],v[64:67]
buffer_load_dwordx4 v170,s[20:23],s46 offen offset:2048 nt lds
M v[64:67],v[140:143],a[52:55],v[64:67]
M v[96:99],v[140:143],a[60:63],v[96:99]
buffer_load_dwordx4 v171,s[20:23],s46 offen offset:3072 nt lds
M v[96:99],v[136:139],a[56:59],v[96:99]
MS v[156:159],v[160:163],v[144:151],v255
ds_read_b64_tr_b16 v[136:137],v165 offset:8
M v[4:7],v[144:147],a[32:35],v[4:7]
ds_read_b64_tr_b16 v[138:139],v165 offset:1032
M v[4:7],v[148:151],a[36:39],v[4:7]
ds_read_b64_tr_b16 v[140:141],v165 offset:8200
v_add_u32 v167,0x10000,v167
M v[36:39],v[148:151],a[44:47],v[36:39]
ds_read_b64_tr_b16 v[142:143],v165 offset:9224
M v[36:39],v[144:147],a[40:43],v[36:39]
M v[68:71],v[144:147],a[48:51],v[68:71]
M v[68:71],v[148:151],a[52:55],v[68:71]
M v[100:103],v[148:151],a[60:63],v[100:103]
M v[100:103],v[144:147],a[56:59],v[100:103]
s_waitcnt lgkmcnt(4)
M v[8:11],v[128:131],a[32:35],v[8:11]
ds_read_b64_tr_b16 v[144:145],v166 offset:0
M v[8:11],v[132:135],a[36:39],v[8:11]
ds_read_b64_tr_b16 v[146:147],v166 offset:1024
s_add_u32 s46,s46,524288
M v[40:43],v[132:135],a[44:47],v[40:43]
ds_read_b64_tr_b16 v[148:149],v166 offset:8192
M v[40:43],v[128:131],a[40:43],v[40:43]
ds_read_b64_tr_b16 v[150:151],v166 offset:9216
M v[72:75],v[128:131],a[48:51],v[72:75]
s_add_u32 m0,s68,0
M v[72:75],v[132:135],a[52:55],v[72:75]
buffer_load_dwordx4 v243,s[8:11],s58 offen offset:0 lds
M v[104:107],v[132:135],a[60:63],v[104:107]
M v[104:107],v[128:131],a[56:59],v[104:107]
buffer_load_dwordx4 v244,s[8:11],s59 offen offset:1024 lds
s_waitcnt lgkmcnt(4)
M v[12:15],v[136:139],a[32:35],v[12:15]
ds_read_b64_tr_b16 v[128:129],v166 offset:8
M v[12:15],v[140:143],a[36:39],v[12:15]
ds_read_b64_tr_b16 v[130:131],v166 offset:1032
M v[44:47],v[140:143],a[44:47],v[44:47]
ds_read_b64_tr_b16 v[132:133],v166 offset:8200
M v[44:47],v[136:139],a[40:43],v[44:47]
ds_read_b64_tr_b16 v[134:135],v166 offset:9224
M v[76:79],v[136:139],a[48:51],v[76:79]
M v[76:79],v[140:143],a[52:55],v[76:79]
buffer_load_dwordx4 v243,s[8:11],s60 offen offset:2048 lds
M v[108:111],v[140:143],a[60:63],v[108:111]
M v[108:111],v[136:139],a[56:59],v[108:111]
buffer_load_dwordx4 v244,s[8:11],s61 offen offset:3072 lds
s_waitcnt lgkmcnt(4)
M v[16:19],v[144:147],a[32:35],v[16:19]
ds_read_b64_tr_b16 v[136:137],v167 offset:0
M v[16:19],v[148:151],a[36:39],v[16:19]
ds_read_b64_tr_b16 v[138:139],v167 offset:1024
M v[48:51],v[148:151],a[44:47],v[48:51]
ds_read_b64_tr_b16 v[140:141],v167 offset:8192
M v[48:51],v[144:147],a[40:43],v[48:51]
ds_read_b64_tr_b16 v[142:143],v167 offset:9216
M v[80:83],v[144:147],a[48:51],v[80:83]
s_add_u32 m0,s68,4096
M v[80:83],v[148:151],a[52:55],v[80:83]
buffer_load_dwordx4 v243,s[8:11],s62 offen offset:0 lds
M v[112:115],v[148:151],a[60:63],v[112:115]
M v[112:115],v[144:147],a[56:59],v[112:115]
buffer_load_dwordx4 v244,s[8:11],s63 offen offset:1024 lds
s_waitcnt lgkmcnt(4)
M v[20:23],v[128:131],a[32:35],v[20:23]
ds_read_b64_tr_b16 v[144:145],v167 offset:8
M v[20:23],v[132:135],a[36:39],v[20:23]
ds_read_b64_tr_b16 v[146:147],v167 offset:1032
M v[52:55],v[132:135],a[44:47],v[52:55]
ds_read_b64_tr_b16 v[148:149],v167 offset:8200
M v[52:55],v[128:131],a[40:43],v[52:55]
ds_read_b64_tr_b16 v[150:151],v167 offset:9224
M v[84:87],v[128:131],a[48:51],v[84:87]
v_add_u32 v164,0x4000,v164
M v[84:87],v[132:135],a[52:55],v[84:87]
buffer_load_dwordx4 v243,s[8:11],s64 offen offset:2048 lds
M v[116:119],v[132:135],a[60:63],v[116:119]
M v[116:119],v[128:131],a[56:59],v[116:119]
buffer_load_dwordx4 v244,s[8:11],s65 offen offset:3072 lds
v_add_u32 v243,128,v243
v_add_u32 v244,128,v244
s_waitcnt lgkmcnt(4)
s_waitcnt vmcnt(20)
M v[24:27],v[136:139],a[32:35],v[24:27]
s_barrier
M v[24:27],v[140:143],a[36:39],v[24:27]
ds_read_b64_tr_b16 v[128:129],v164 offset:0
M v[56:59],v[140:143],a[44:47],v[56:59]
ds_read_b64_tr_b16 v[130:131],v164 offset:1024
M v[56:59],v[136:139],a[40:43],v[56:59]
ds_read_b64_tr_b16 v[132:133],v164 offset:8192
M v[88:91],v[136:139],a[48:51],v[88:91]
ds_read_b64_tr_b16 v[134:135],v164 offset:9216
M v[88:91],v[140:143],a[52:55],v[88:91]
M v[120:123],v[140:143],a[60:63],v[120:123]
M v[120:123],v[136:139],a[56:59],v[120:123]
s_waitcnt lgkmcnt(4)
M v[28:31],v[144:147],a[32:35],v[28:31]
ds_read_b64_tr_b16 v[136:137],v164 offset:8
M v[28:31],v[148:151],a[36:39],v[28:31]
ds_read_b64_tr_b16 v[138:139],v164 offset:1032
v_add_u32 v165,0x4000,v165
M v[60:63],v[148:151],a[44:47],v[60:63]
ds_read_b64_tr_b16 v[140:141],v164 offset:8200
v_add_u32 v166,0x4000,v166
M v[60:63],v[144:147],a[40:43],v[60:63]
ds_read_b64_tr_b16 v[142:143],v164 offset:9224
M v[92:95],v[144:147],a[48:51],v[92:95]
M v[92:95],v[148:151],a[52:55],v[92:95]
ds_read2_b32 v[208:209],v216 offset0:192 offset1:194
M v[124:127],v[148:151],a[60:63],v[124:127]
ds_read2_b32 v[210:211],v216 offset0:196 offset1:198
M v[124:127],v[144:147],a[56:59],v[124:127]
s_waitcnt lgkmcnt(0)
MS v[192:195],v[208:211],a[64:71],v255
s_waitcnt vmcnt(12)
M v[176:179],a[64:67],a[64:67],v[176:179]
ds_read_b128 a[96:99],v174 offset:0
M v[176:179],a[68:71],a[68:71],v[176:179]
ds_read_b128 a[100:103],v175 offset:0
MS v[196:199],v[208:211],a[72:79],v255
ds_read_b128 a[104:107],v174 offset:2048
M v[180:183],a[72:75],a[72:75],v[180:183]
ds_read_b128 a[108:111],v175 offset:2048
M v[180:183],a[76:79],a[76:79],v[180:183]
ds_read_b128 a[112:115],v174 offset:4096
MS v[200:203],v[208:211],a[80:87],v255
ds_read_b128 a[116:119],v175 offset:4096
M v[184:187],a[80:83],a[80:83],v[184:187]
ds_read_b128 a[120:123],v174 offset:6144
M v[184:187],a[84:87],a[84:87],v[184:187]
ds_read_b128 a[124:127],v175 offset:6144
s_add_u32 m0,s48,32768
MS v[204:207],v[208:211],a[88:95],v255
buffer_load_dwordx4 v168,s[20:23],s46 offen offset:0 nt lds
M v[188:191],a[88:91],a[88:91],v[188:191]
M v[188:191],a[92:95],a[92:95],v[188:191]
buffer_load_dwordx4 v169,s[20:23],s46 offen offset:1024 nt lds
MS v[152:155],v[160:163],v[128:135],v255
ds_read_b64_tr_b16 v[144:145],v165 offset:0
M v[0:3],v[128:131],a[64:67],v[0:3]
ds_read_b64_tr_b16 v[146:147],v165 offset:1024
M v[0:3],v[132:135],a[68:71],v[0:3]
ds_read_b64_tr_b16 v[148:149],v165 offset:8192
M v[32:35],v[132:135],a[76:79],v[32:35]
ds_read_b64_tr_b16 v[150:151],v165 offset:9216
M v[32:35],v[128:131],a[72:75],v[32:35]
M v[64:67],v[128:131],a[80:83],v[64:67]
buffer_load_dwordx4 v170,s[20:23],s46 offen offset:2048 nt lds
M v[64:67],v[132:135],a[84:87],v[64:67]
M v[96:99],v[132:135],a[92:95],v[96:99]
buffer_load_dwordx4 v171,s[20:23],s46 offen offset:3072 nt lds
M v[96:99],v[128:131],a[88:91],v[96:99]
MS v[156:159],v[160:163],v[136:143],v255
ds_read_b64_tr_b16 v[128:129],v165 offset:8
M v[4:7],v[136:139],a[64:67],v[4:7]
ds_read_b64_tr_b16 v[130:131],v165 offset:1032
M v[4:7],v[140:143],a[68:71],v[4:7]
ds_read_b64_tr_b16 v[132:133],v165 offset:8200
v_add_u32 v167,0x4000,v167
M v[36:39],v[140:143],a[76:79],v[36:39]
ds_read_b64_tr_b16 v[134:135],v165 offset:9224
M v[36:39],v[136:139],a[72:75],v[36:39]
M v[68:71],v[136:139],a[80:83],v[68:71]
M v[68:71],v[140:143],a[84:87],v[68:71]
M v[100:103],v[140:143],a[92:95],v[100:103]
M v[100:103],v[136:139],a[88:91],v[100:103]
s_waitcnt lgkmcnt(4)
M v[8:11],v[144:147],a[64:67],v[8:11]
ds_read_b64_tr_b16 v[136:137],v166 offset:0
M v[8:11],v[148:151],a[68:71],v[8:11]
ds_read_b64_tr_b16 v[138:139],v166 offset:1024
s_add_u32 s46,s46,524288
M v[40:43],v[148:151],a[76:79],v[40:43]
ds_read_b64_tr_b16 v[140:141],v166 offset:8192
M v[40:43],v[144:147],a[72:75],v[40:43]
ds_read_b64_tr_b16 v[142:143],v166 offset:9216
M v[72:75],v[144:147],a[80:83],v[72:75]
s_add_u32 m0,s69,0
M v[72:75],v[148:151],a[84:87],v[72:75]
buffer_load_dwordx4 v243,s[8:11],s58 offen offset:0 lds
M v[104:107],v[148:151],a[92:95],v[104:107]
M v[104:107],v[144:147],a[88:91],v[104:107]
buffer_load_dwordx4 v244,s[8:11],s59 offen offset:1024 lds
s_waitcnt lgkmcnt(4)
M v[12:15],v[128:131],a[64:67],v[12:15]
ds_read_b64_tr_b16 v[144:145],v166 offset:8
M v[12:15],v[132:135],a[68:71],v[12:15]
ds_read_b64_tr_b16 v[146:147],v166 offset:1032
M v[44:47],v[132:135],a[76:79],v[44:47]
ds_read_b64_tr_b16 v[148:149],v166 offset:8200
M v[44:47],v[128:131],a[72:75],v[44:47]
ds_read_b64_tr_b16 v[150:151],v166 offset:9224
M v[76:79],v[128:131],a[80:83],v[76:79]
M v[76:79],v[132:135],a[84:87],v[76:79]
buffer_load_dwordx4 v243,s[8:11],s60 offen offset:2048 lds
M v[108:111],v[132:135],a[92:95],v[108:111]
M v[108:111],v[128:131],a[88:91],v[108:111]
buffer_load_dwordx4 v244,s[8:11],s61 offen offset:3072 lds
s_waitcnt lgkmcnt(4)
M v[16:19],v[136:139],a[64:67],v[16:19]
ds_read_b64_tr_b16 v[128:129],v167 offset:0
M v[16:19],v[140:143],a[68:71],v[16:19]
ds_read_b64_tr_b16 v[130:131],v167 offset:1024
M v[48:51],v[140:143],a[76:79],v[48:51]
ds_read_b64_tr_b16 v[132:133],v167 offset:8192
M v[48:51],v[136:139],a[72:75],v[48:51]
ds_read_b64_tr_b16 v[134:135],v167 offset:9216
M v[80:83],v[136:139],a[80:83],v[80:83]
s_add_u32 m0,s69,4096
M v[80:83],v[140:143],a[84:87],v[80:83]
buffer_load_dwordx4 v243,s[8:11],s62 offen offset:0 lds
M v[112:115],v[140:143],a[92:95],v[112:115]
M v[112:115],v[136:139],a[88:91],v[112:115]
buffer_load_dwordx4 v244,s[8:11],s63 offen offset:1024 lds
s_waitcnt lgkmcnt(4)
M v[20:23],v[144:147],a[64:67],v[20:23]
ds_read_b64_tr_b16 v[136:137],v167 offset:8
M v[20:23],v[148:151],a[68:71],v[20:23]
ds_read_b64_tr_b16 v[138:139],v167 offset:1032
M v[52:55],v[148:151],a[76:79],v[52:55]
ds_read_b64_tr_b16 v[140:141],v167 offset:8200
M v[52:55],v[144:147],a[72:75],v[52:55]
ds_read_b64_tr_b16 v[142:143],v167 offset:9224
M v[84:87],v[144:147],a[80:83],v[84:87]
v_add_u32 v164,0xffff4000,v164
M v[84:87],v[148:151],a[84:87],v[84:87]
buffer_load_dwordx4 v243,s[8:11],s64 offen offset:2048 lds
M v[116:119],v[148:151],a[92:95],v[116:119]
M v[116:119],v[144:147],a[88:91],v[116:119]
buffer_load_dwordx4 v244,s[8:11],s65 offen offset:3072 lds
v_add_u32 v243,128,v243
v_add_u32 v244,128,v244
s_waitcnt lgkmcnt(4)
s_waitcnt vmcnt(20)
M v[24:27],v[128:131],a[64:67],v[24:27]
s_barrier
M v[24:27],v[132:135],a[68:71],v[24:27]
ds_read_b64_tr_b16 v[144:145],v164 offset:0
M v[56:59],v[132:135],a[76:79],v[56:59]
ds_read_b64_tr_b16 v[146:147],v164 offset:1024
M v[56:59],v[128:131],a[72:75],v[56:59]
ds_read_b64_tr_b16 v[148:149],v164 offset:8192
M v[88:91],v[128:131],a[80:83],v[88:91]
ds_read_b64_tr_b16 v[150:151],v164 offset:9216
M v[88:91],v[132:135],a[84:87],v[88:91]
M v[120:123],v[132:135],a[92:95],v[120:123]
M v[120:123],v[128:131],a[88:91],v[120:123]
s_waitcnt lgkmcnt(4)
M v[28:31],v[136:139],a[64:67],v[28:31]
ds_read_b64_tr_b16 v[128:129],v164 offset:8
M v[28:31],v[140:143],a[68:71],v[28:31]
ds_read_b64_tr_b16 v[130:131],v164 offset:1032
v_add_u32 v165,0xffff4000,v165
M v[60:63],v[140:143],a[76:79],v[60:63]
ds_read_b64_tr_b16 v[132:133],v164 offset:8200
v_add_u32 v166,0xffff4000,v166
M v[60:63],v[136:139],a[72:75],v[60:63]
ds_read_b64_tr_b16 v[134:135],v164 offset:9224
M v[92:95],v[136:139],a[80:83],v[92:95]
M v[92:95],v[140:143],a[84:87],v[92:95]
ds_read2_b32 v[208:209],v216 offset0:224 offset1:226
M v[124:127],v[140:143],a[92:95],v[124:127]
ds_read2_b32 v[210:211],v216 offset0:228 offset1:230
M v[124:127],v[136:139],a[88:91],v[124:127]
s_waitcnt lgkmcnt(0)
MS v[192:195],v[208:211],a[96:103],v255
s_waitcnt vmcnt(12)
M v[176:179],a[96:99],a[96:99],v[176:179]
ds_read_b128 a[0:3],v172 offset:0
M v[176:179],a[100:103],a[100:103],v[176:179]
ds_read_b128 a[4:7],v173 offset:0
MS v[196:199],v[208:211],a[104:111],v255
ds_read_b128 a[8:11],v172 offset:2048
M v[180:183],a[104:107],a[104:107],v[180:183]
ds_read_b128 a[12:15],v173 offset:2048
M v[180:183],a[108:111],a[108:111],v[180:183]
ds_read_b128 a[16:19],v172 offset:4096
MS v[200:203],v[208:211],a[112:119],v255
ds_read_b128 a[20:23],v173 offset:4096
M v[184:187],a[112:115],a[112:115],v[184:187]
ds_read_b128 a[24:27],v172 offset:6144
M v[184:187],a[116:119],a[116:119],v[184:187]
ds_read_b128 a[28:31],v173 offset:6144
s_add_u32 m0,s48,98304
MS v[204:207],v[208:211],a[120:127],v255
buffer_load_dwordx4 v168,s[20:23],s46 offen offset:0 nt lds
M v[188:191],a[120:123],a[120:123],v[188:191]
M v[188:191],a[124:127],a[124:127],v[188:191]
buffer_load_dwordx4 v169,s[20:23],s46 offen offset:1024 nt lds
MS v[152:155],v[160:163],v[144:151],v255
ds_read_b64_tr_b16 v[136:137],v165 offset:0
M v[0:3],v[144:147],a[96:99],v[0:3]
ds_read_b64_tr_b16 v[138:139],v165 offset:1024
s_mov_b32 s28,s94
M v[0:3],v[148:151],a[100:103],v[0:3]
ds_read_b64_tr_b16 v[140:141],v165 offset:8192
M v[32:35],v[148:151],a[108:111],v[32:35]
ds_read_b64_tr_b16 v[142:143],v165 offset:9216
s_mov_b32 s29,s95
M v[32:35],v[144:147],a[104:107],v[32:35]
s_mov_b32 s30,2211840
M v[64:67],v[144:147],a[112:115],v[64:67]
buffer_load_dwordx4 v170,s[20:23],s46 offen offset:2048 nt lds
M v[64:67],v[148:151],a[116:119],v[64:67]
M v[96:99],v[148:151],a[124:127],v[96:99]
buffer_load_dwordx4 v171,s[20:23],s46 offen offset:3072 nt lds
M v[96:99],v[144:147],a[120:123],v[96:99]
s_mov_b32 s31,0x00020000
MS v[156:159],v[160:163],v[128:135],v255
ds_read_b64_tr_b16 v[144:145],v165 offset:8
M v[4:7],v[128:131],a[96:99],v[4:7]
ds_read_b64_tr_b16 v[146:147],v165 offset:1032
M v[4:7],v[132:135],a[100:103],v[4:7]
ds_read_b64_tr_b16 v[148:149],v165 offset:8200
v_add_u32 v167,0xffff4000,v167
M v[36:39],v[132:135],a[108:111],v[36:39]
ds_read_b64_tr_b16 v[150:151],v165 offset:9224
M v[36:39],v[128:131],a[104:107],v[36:39]
M v[68:71],v[128:131],a[112:115],v[68:71]
M v[68:71],v[132:135],a[116:119],v[68:71]
s_lshr_b32 s50,s40,1
s_mul_i32 s58,s50,276480
s_mul_i32 s59,s50,5120
s_and_b32 s50,s40,1
s_mul_i32 s50,s50,10240
s_add_u32 s59,s59,s50
M v[100:103],v[132:135],a[124:127],v[100:103]
M v[100:103],v[128:131],a[120:123],v[100:103]
s_waitcnt lgkmcnt(4)
M v[8:11],v[136:139],a[96:99],v[8:11]
ds_read_b64_tr_b16 v[128:129],v166 offset:0
M v[8:11],v[140:143],a[100:103],v[8:11]
ds_read_b64_tr_b16 v[130:131],v166 offset:1024
s_add_u32 s46,s46,524288
M v[40:43],v[140:143],a[108:111],v[40:43]
ds_read_b64_tr_b16 v[132:133],v166 offset:8192
M v[40:43],v[136:139],a[104:107],v[40:43]
ds_read_b64_tr_b16 v[134:135],v166 offset:9216
M v[72:75],v[136:139],a[112:115],v[72:75]
s_add_u32 m0,s48,49152
M v[72:75],v[140:143],a[116:119],v[72:75]
buffer_load_dwordx4 v236,s[12:15],s43 offen offset:0 nt lds
M v[104:107],v[140:143],a[124:127],v[104:107]
M v[104:107],v[136:139],a[120:123],v[104:107]
buffer_load_dwordx4 v237,s[12:15],s43 offen offset:1024 nt lds
s_waitcnt lgkmcnt(4)
M v[12:15],v[144:147],a[96:99],v[12:15]
ds_read_b64_tr_b16 v[136:137],v166 offset:8
M v[12:15],v[148:151],a[100:103],v[12:15]
ds_read_b64_tr_b16 v[138:139],v166 offset:1032
M v[44:47],v[148:151],a[108:111],v[44:47]
ds_read_b64_tr_b16 v[140:141],v166 offset:8200
M v[44:47],v[144:147],a[104:107],v[44:47]
ds_read_b64_tr_b16 v[142:143],v166 offset:9224
M v[76:79],v[144:147],a[112:115],v[76:79]
M v[76:79],v[148:151],a[116:119],v[76:79]
buffer_load_dwordx4 v238,s[12:15],s43 offen offset:2048 nt lds
M v[108:111],v[148:151],a[124:127],v[108:111]
M v[108:111],v[144:147],a[120:123],v[108:111]
buffer_load_dwordx4 v239,s[12:15],s43 offen offset:3072 nt lds
s_add_u32 s43,s43,16384
s_waitcnt lgkmcnt(4)
M v[16:19],v[128:131],a[96:99],v[16:19]
ds_read_b64_tr_b16 v[144:145],v167 offset:0
M v[16:19],v[132:135],a[100:103],v[16:19]
ds_read_b64_tr_b16 v[146:147],v167 offset:1024
M v[48:51],v[132:135],a[108:111],v[48:51]
ds_read_b64_tr_b16 v[148:149],v167 offset:8192
M v[48:51],v[128:131],a[104:107],v[48:51]
ds_read_b64_tr_b16 v[150:151],v167 offset:9216
M v[80:83],v[128:131],a[112:115],v[80:83]
s_and_b32 s50,s3,3
s_mul_i32 s50,s50,552960
s_add_u32 s58,s58,s50
s_lshr_b32 s50,s3,2
s_lshl_b32 s50,s50,6
s_add_u32 s58,s58,s50
s_cmp_ge_u32 s2,216
s_cmov_b32 s58,41943040
M v[80:83],v[132:135],a[116:119],v[80:83]
M v[112:115],v[132:135],a[124:127],v[112:115]
M v[112:115],v[128:131],a[120:123],v[112:115]
s_waitcnt lgkmcnt(4)
M v[20:23],v[136:139],a[96:99],v[20:23]
ds_read_b64_tr_b16 v[128:129],v167 offset:8
M v[20:23],v[140:143],a[100:103],v[20:23]
ds_read_b64_tr_b16 v[130:131],v167 offset:1032
M v[52:55],v[140:143],a[108:111],v[52:55]
ds_read_b64_tr_b16 v[132:133],v167 offset:8200
M v[52:55],v[136:139],a[104:107],v[52:55]
ds_read_b64_tr_b16 v[134:135],v167 offset:9224
M v[84:87],v[136:139],a[112:115],v[84:87]
v_add_u32 v164,0xffff8000,v164
M v[84:87],v[140:143],a[116:119],v[84:87]
s_lshl_b32 s62,s3,8
s_add_u32 s62,s62,25690112
s_cmp_ge_u32 s2,216
s_cmov_b32 s62,41943040
M v[116:119],v[140:143],a[124:127],v[116:119]
M v[116:119],v[136:139],a[120:123],v[116:119]
s_waitcnt lgkmcnt(4)
s_waitcnt vmcnt(16)
M v[24:27],v[144:147],a[96:99],v[24:27]
s_barrier
M v[24:27],v[148:151],a[100:103],v[24:27]
ds_read_b64_tr_b16 v[136:137],v164 offset:0
M v[56:59],v[148:151],a[108:111],v[56:59]
ds_read_b64_tr_b16 v[138:139],v164 offset:1024
M v[56:59],v[144:147],a[104:107],v[56:59]
ds_read_b64_tr_b16 v[140:141],v164 offset:8192
M v[88:91],v[144:147],a[112:115],v[88:91]
ds_read_b64_tr_b16 v[142:143],v164 offset:9216
M v[88:91],v[148:151],a[116:119],v[88:91]
s_mul_i32 s64,s3,10240
s_cmp_ge_u32 s2,216
s_cmov_b32 s64,41943040
M v[120:123],v[148:151],a[124:127],v[120:123]
M v[120:123],v[144:147],a[120:123],v[120:123]
s_waitcnt lgkmcnt(4)
M v[28:31],v[128:131],a[96:99],v[28:31]
ds_read_b64_tr_b16 v[144:145],v164 offset:8
v_add_u32 v216,1024,v216
M v[28:31],v[132:135],a[100:103],v[28:31]
ds_read_b64_tr_b16 v[146:147],v164 offset:1032
v_add_u32 v165,0xffff8000,v165
M v[60:63],v[132:135],a[108:111],v[60:63]
ds_read_b64_tr_b16 v[148:149],v164 offset:8200
v_add_u32 v166,0xffff8000,v166
M v[60:63],v[128:131],a[104:107],v[60:63]
ds_read_b64_tr_b16 v[150:151],v164 offset:9224
M v[92:95],v[128:131],a[112:115],v[92:95]
s_bfe_u32 s60,s2,0x10003
s_cmp_lg_u32 s40,0
s_cmov_b32 s60,7
M v[92:95],v[132:135],a[116:119],v[92:95]
ds_read2_b32 v[208:209],v216 offset0:0 offset1:2
M v[124:127],v[132:135],a[124:127],v[124:127]
ds_read2_b32 v[210:211],v216 offset0:4 offset1:6
M v[124:127],v[128:131],a[120:123],v[124:127]
s_add_u32 s63,s45,917504
s_waitcnt lgkmcnt(0)
MS v[192:195],v[208:211],a[0:7],v255
s_waitcnt vmcnt(8)
M v[176:179],a[0:3],a[0:3],v[176:179]
ds_read_b128 a[32:35],v174 offset:0
M v[176:179],a[4:7],a[4:7],v[176:179]
ds_read_b128 a[36:39],v175 offset:0
MS v[196:199],v[208:211],a[8:15],v255
ds_read_b128 a[40:43],v174 offset:2048
M v[180:183],a[8:11],a[8:11],v[180:183]
ds_read_b128 a[44:47],v175 offset:2048
M v[180:183],a[12:15],a[12:15],v[180:183]
ds_read_b128 a[48:51],v174 offset:4096
MS v[200:203],v[208:211],a[16:23],v255
ds_read_b128 a[52:55],v175 offset:4096
M v[184:187],a[16:19],a[16:19],v[184:187]
ds_read_b128 a[56:59],v174 offset:6144
M v[184:187],a[20:23],a[20:23],v[184:187]
ds_read_b128 a[60:63],v175 offset:6144
MS v[204:207],v[208:211],a[24:31],v255
M v[188:191],a[24:27],a[24:27],v[188:191]
M v[188:191],a[28:31],a[28:31],v[188:191]
MS v[152:155],v[160:163],v[136:143],v255
ds_read_b64_tr_b16 v[128:129],v165 offset:0
M v[0:3],v[136:139],a[0:3],v[0:3]
ds_read_b64_tr_b16 v[130:131],v165 offset:1024
v_lshlrev_b32 v254,2,v242
M v[0:3],v[140:143],a[4:7],v[0:3]
ds_read_b64_tr_b16 v[132:133],v165 offset:8192
M v[32:35],v[140:143],a[12:15],v[32:35]
ds_read_b64_tr_b16 v[134:135],v165 offset:9216
v_cmp_gt_u32 vcc,16,v242
M v[32:35],v[136:139],a[8:11],v[32:35]
v_add_u32 v254,s93,v254
M v[64:67],v[136:139],a[16:19],v[64:67]
v_mov_b32 v253,163200
v_cndmask_b32 v254,v253,v254,vcc
M v[64:67],v[140:143],a[20:23],v[64:67]
v_lshrrev_b32 v253,4,v242
M v[96:99],v[140:143],a[28:31],v[96:99]
v_lshlrev_b32 v253,4,v253
v_mov_b32 v252,0
M v[96:99],v[136:139],a[24:27],v[96:99]
MS v[156:159],v[160:163],v[144:151],v255
ds_read_b64_tr_b16 v[136:137],v165 offset:8
M v[4:7],v[144:147],a[0:3],v[4:7]
ds_read_b64_tr_b16 v[138:139],v165 offset:1032
M v[4:7],v[148:151],a[4:7],v[4:7]
ds_read_b64_tr_b16 v[140:141],v165 offset:8200
v_add_u32 v167,0xffff8000,v167
M v[36:39],v[148:151],a[12:15],v[36:39]
ds_read_b64_tr_b16 v[142:143],v165 offset:9224
M v[36:39],v[144:147],a[8:11],v[36:39]
M v[68:71],v[144:147],a[16:19],v[68:71]
s_add_u32 s50,s40,0
s_and_b32 s50,s50,3
s_lshl_b32 s50,s50,7
s_add_u32 s50,s50,163328
v_add_u32 v168,s50,v253
M v[68:71],v[148:151],a[20:23],v[68:71]
M v[100:103],v[148:151],a[28:31],v[100:103]
s_add_u32 s50,s40,1
s_and_b32 s50,s50,3
s_lshl_b32 s50,s50,7
s_add_u32 s50,s50,163328
v_add_u32 v169,s50,v253
M v[100:103],v[144:147],a[24:27],v[100:103]
s_waitcnt lgkmcnt(4)
M v[8:11],v[128:131],a[0:3],v[8:11]
ds_read_b64_tr_b16 v[144:145],v166 offset:0
M v[8:11],v[132:135],a[4:7],v[8:11]
ds_read_b64_tr_b16 v[146:147],v166 offset:1024
M v[40:43],v[132:135],a[12:15],v[40:43]
ds_read_b64_tr_b16 v[148:149],v166 offset:8192
M v[40:43],v[128:131],a[8:11],v[40:43]
ds_read_b64_tr_b16 v[150:151],v166 offset:9216
M v[72:75],v[128:131],a[16:19],v[72:75]
s_add_u32 m0,s48,0
M v[72:75],v[132:135],a[20:23],v[72:75]
buffer_load_dwordx4 v236,s[12:15],s43 offen offset:0 nt lds
M v[104:107],v[132:135],a[28:31],v[104:107]
M v[104:107],v[128:131],a[24:27],v[104:107]
buffer_load_dwordx4 v237,s[12:15],s43 offen offset:1024 nt lds
s_waitcnt lgkmcnt(4)
M v[12:15],v[136:139],a[0:3],v[12:15]
ds_read_b64_tr_b16 v[128:129],v166 offset:8
M v[12:15],v[140:143],a[4:7],v[12:15]
ds_read_b64_tr_b16 v[130:131],v166 offset:1032
M v[44:47],v[140:143],a[12:15],v[44:47]
ds_read_b64_tr_b16 v[132:133],v166 offset:8200
M v[44:47],v[136:139],a[8:11],v[44:47]
ds_read_b64_tr_b16 v[134:135],v166 offset:9224
M v[76:79],v[136:139],a[16:19],v[76:79]
M v[76:79],v[140:143],a[20:23],v[76:79]
buffer_load_dwordx4 v238,s[12:15],s43 offen offset:2048 nt lds
M v[108:111],v[140:143],a[28:31],v[108:111]
M v[108:111],v[136:139],a[24:27],v[108:111]
buffer_load_dwordx4 v239,s[12:15],s43 offen offset:3072 nt lds
s_add_u32 s43,s43,16384
s_waitcnt lgkmcnt(4)
M v[16:19],v[144:147],a[0:3],v[16:19]
ds_read_b64_tr_b16 v[136:137],v167 offset:0
M v[16:19],v[148:151],a[4:7],v[16:19]
ds_read_b64_tr_b16 v[138:139],v167 offset:1024
M v[48:51],v[148:151],a[12:15],v[48:51]
ds_read_b64_tr_b16 v[140:141],v167 offset:8192
M v[48:51],v[144:147],a[8:11],v[48:51]
ds_read_b64_tr_b16 v[142:143],v167 offset:9216
M v[80:83],v[144:147],a[16:19],v[80:83]
s_add_u32 m0,s48,16384
M v[80:83],v[148:151],a[20:23],v[80:83]
buffer_load_dwordx4 v236,s[12:15],s43 offen offset:0 nt lds
M v[112:115],v[148:151],a[28:31],v[112:115]
s_add_u32 s50,s40,2
s_and_b32 s50,s50,3
s_lshl_b32 s50,s50,7
s_add_u32 s50,s50,163328
v_add_u32 v170,s50,v253
M v[112:115],v[144:147],a[24:27],v[112:115]
buffer_load_dwordx4 v237,s[12:15],s43 offen offset:1024 nt lds
s_waitcnt lgkmcnt(4)
M v[20:23],v[128:131],a[0:3],v[20:23]
ds_read_b64_tr_b16 v[144:145],v167 offset:8
M v[20:23],v[132:135],a[4:7],v[20:23]
ds_read_b64_tr_b16 v[146:147],v167 offset:1032
M v[52:55],v[132:135],a[12:15],v[52:55]
ds_read_b64_tr_b16 v[148:149],v167 offset:8200
M v[52:55],v[128:131],a[8:11],v[52:55]
ds_read_b64_tr_b16 v[150:151],v167 offset:9224
M v[84:87],v[128:131],a[16:19],v[84:87]
v_add_u32 v164,0x10000,v164
M v[84:87],v[132:135],a[20:23],v[84:87]
buffer_load_dwordx4 v238,s[12:15],s43 offen offset:2048 nt lds
M v[116:119],v[132:135],a[28:31],v[116:119]
M v[116:119],v[128:131],a[24:27],v[116:119]
buffer_load_dwordx4 v239,s[12:15],s43 offen offset:3072 nt lds
s_add_u32 s43,s43,16384
s_waitcnt lgkmcnt(4)
s_waitcnt vmcnt(12)
M v[24:27],v[136:139],a[0:3],v[24:27]
s_barrier
M v[24:27],v[140:143],a[4:7],v[24:27]
ds_read_b64_tr_b16 v[128:129],v164 offset:0
M v[56:59],v[140:143],a[12:15],v[56:59]
ds_read_b64_tr_b16 v[130:131],v164 offset:1024
M v[56:59],v[136:139],a[8:11],v[56:59]
ds_read_b64_tr_b16 v[132:133],v164 offset:8192
M v[88:91],v[136:139],a[16:19],v[88:91]
ds_read_b64_tr_b16 v[134:135],v164 offset:9216
M v[88:91],v[140:143],a[20:23],v[88:91]
M v[120:123],v[140:143],a[28:31],v[120:123]
M v[120:123],v[136:139],a[24:27],v[120:123]
s_waitcnt lgkmcnt(4)
M v[28:31],v[144:147],a[0:3],v[28:31]
ds_read_b64_tr_b16 v[136:137],v164 offset:8
M v[28:31],v[148:151],a[4:7],v[28:31]
ds_read_b64_tr_b16 v[138:139],v164 offset:1032
v_add_u32 v165,0x10000,v165
M v[60:63],v[148:151],a[12:15],v[60:63]
ds_read_b64_tr_b16 v[140:141],v164 offset:8200
v_add_u32 v166,0x10000,v166
M v[60:63],v[144:147],a[8:11],v[60:63]
ds_read_b64_tr_b16 v[142:143],v164 offset:9224
M v[92:95],v[144:147],a[16:19],v[92:95]
s_add_u32 s50,s40,3
s_and_b32 s50,s50,3
s_lshl_b32 s50,s50,7
s_add_u32 s50,s50,163328
v_add_u32 v171,s50,v253
M v[92:95],v[148:151],a[20:23],v[92:95]
ds_read2_b32 v[208:209],v216 offset0:32 offset1:34
M v[124:127],v[148:151],a[28:31],v[124:127]
ds_read2_b32 v[210:211],v216 offset0:36 offset1:38
M v[124:127],v[144:147],a[24:27],v[124:127]
s_waitcnt lgkmcnt(0)
MS v[192:195],v[208:211],a[32:39],v255
M v[176:179],a[32:35],a[32:35],v[176:179]
M v[176:179],a[36:39],a[36:39],v[176:179]
MS v[196:199],v[208:211],a[40:47],v255
M v[180:183],a[40:43],a[40:43],v[180:183]
M v[180:183],a[44:47],a[44:47],v[180:183]
MS v[200:203],v[208:211],a[48:55],v255
M v[184:187],a[48:51],a[48:51],v[184:187]
M v[184:187],a[52:55],a[52:55],v[184:187]
MS v[204:207],v[208:211],a[56:63],v255
M v[188:191],a[56:59],a[56:59],v[188:191]
M v[188:191],a[60:63],a[60:63],v[188:191]
MS v[152:155],v[160:163],v[128:135],v255
ds_read_b64_tr_b16 v[144:145],v165 offset:0
M v[0:3],v[128:131],a[32:35],v[0:3]
ds_read_b64_tr_b16 v[146:147],v165 offset:1024
M v[0:3],v[132:135],a[36:39],v[0:3]
ds_read_b64_tr_b16 v[148:149],v165 offset:8192
M v[32:35],v[132:135],a[44:47],v[32:35]
ds_read_b64_tr_b16 v[150:151],v165 offset:9216
M v[32:35],v[128:131],a[40:43],v[32:35]
v_and_b32 v218,3,v242
v_cmp_eq_u32 s[84:85],1,v218
M v[64:67],v[128:131],a[48:51],v[64:67]
v_cmp_eq_u32 s[86:87],2,v218
v_cmp_eq_u32 s[88:89],3,v218
v_and_b32 v218,15,v242
M v[64:67],v[132:135],a[52:55],v[64:67]
v_lshrrev_b32 v219,2,v218
v_lshl_add_u32 v218,v219,4,v218
v_lshlrev_b32 v218,2,v218
M v[96:99],v[132:135],a[60:63],v[96:99]
v_cndmask_b32 v176,v176,v177,s[84:85]
v_cndmask_b32 v176,v176,v178,s[86:87]
v_cndmask_b32 v176,v176,v179,s[88:89]
M v[96:99],v[128:131],a[56:59],v[96:99]
ds_bpermute_b32 v177,v218,v176
MS v[156:159],v[160:163],v[136:143],v255
ds_read_b64_tr_b16 v[128:129],v165 offset:8
v_cndmask_b32 v180,v180,v181,s[84:85]
M v[4:7],v[136:139],a[32:35],v[4:7]
ds_read_b64_tr_b16 v[130:131],v165 offset:1032
v_cndmask_b32 v180,v180,v182,s[86:87]
M v[4:7],v[140:143],a[36:39],v[4:7]
ds_read_b64_tr_b16 v[132:133],v165 offset:8200
v_add_u32 v167,0x10000,v167
M v[36:39],v[140:143],a[44:47],v[36:39]
ds_read_b64_tr_b16 v[134:135],v165 offset:9224
v_cndmask_b32 v180,v180,v183,s[88:89]
M v[36:39],v[136:139],a[40:43],v[36:39]
ds_bpermute_b32 v181,v218,v180
v_cndmask_b32 v184,v184,v185,s[84:85]
M v[68:71],v[136:139],a[48:51],v[68:71]
v_cndmask_b32 v184,v184,v186,s[86:87]
v_cndmask_b32 v184,v184,v187,s[88:89]
M v[68:71],v[140:143],a[52:55],v[68:71]
ds_bpermute_b32 v185,v218,v184
v_cndmask_b32 v188,v188,v189,s[84:85]
M v[100:103],v[140:143],a[60:63],v[100:103]
v_cndmask_b32 v188,v188,v190,s[86:87]
v_cndmask_b32 v188,v188,v191,s[88:89]
M v[100:103],v[136:139],a[56:59],v[100:103]
ds_bpermute_b32 v189,v218,v188
s_waitcnt lgkmcnt(8)
M v[8:11],v[144:147],a[32:35],v[8:11]
ds_read_b64_tr_b16 v[136:137],v166 offset:0
v_add_f32 v178,v192,v193
M v[8:11],v[148:151],a[36:39],v[8:11]
ds_read_b64_tr_b16 v[138:139],v166 offset:1024
v_mul_f32 v178,0x3acccccd,v178
M v[40:43],v[148:151],a[44:47],v[40:43]
ds_read_b64_tr_b16 v[140:141],v166 offset:8192
s_waitcnt lgkmcnt(10)
M v[40:43],v[144:147],a[40:43],v[40:43]
ds_read_b64_tr_b16 v[142:143],v166 offset:9216
v_mul_f32 v177,0x3acccccd,v177
v_fma_f32 v177,-v178,v178,v177
M v[72:75],v[144:147],a[48:51],v[72:75]
v_max_f32 v177,0,v177
s_add_u32 m0,s48,81920
M v[72:75],v[148:151],a[52:55],v[72:75]
buffer_load_dwordx4 v240,s[16:19],s44 offen offset:0 nt lds
M v[104:107],v[148:151],a[60:63],v[104:107]
v_cvt_pk_bf16_f32 v178,v178,v177
v_and_b32 v177,0xffff0000,v178
v_add_f32 v177,0x3727c5ac,v177
M v[104:107],v[144:147],a[56:59],v[104:107]
buffer_load_dwordx4 v241,s[16:19],s44 offen offset:1024 nt lds
s_waitcnt lgkmcnt(7)
M v[12:15],v[128:131],a[32:35],v[12:15]
ds_read_b64_tr_b16 v[144:145],v166 offset:8
v_cvt_pk_bf16_f32 v177,v177,v177
M v[12:15],v[132:135],a[36:39],v[12:15]
ds_read_b64_tr_b16 v[146:147],v166 offset:1032
v_lshlrev_b32 v177,16,v177
M v[44:47],v[132:135],a[44:47],v[44:47]
ds_read_b64_tr_b16 v[148:149],v166 offset:8200
v_sqrt_f32 v177,v177
M v[44:47],v[128:131],a[40:43],v[44:47]
ds_read_b64_tr_b16 v[150:151],v166 offset:9224
v_lshlrev_b32 v219,16,v178
M v[76:79],v[128:131],a[48:51],v[76:79]
v_cvt_pk_bf16_f32 v177,v177,v177
v_lshlrev_b32 v177,16,v177
M v[76:79],v[132:135],a[52:55],v[76:79]
buffer_load_dwordx4 v240,s[16:19],s44 offen offset:2048 nt lds
M v[108:111],v[132:135],a[60:63],v[108:111]
v_rcp_f32 v179,v177
M v[108:111],v[128:131],a[56:59],v[108:111]
buffer_load_dwordx4 v241,s[16:19],s44 offen offset:3072 nt lds
s_add_u32 s44,s44,16384
s_waitcnt lgkmcnt(4)
M v[16:19],v[136:139],a[32:35],v[16:19]
ds_read_b64_tr_b16 v[128:129],v167 offset:0
v_sub_f32 v247,0,v219
M v[16:19],v[140:143],a[36:39],v[16:19]
ds_read_b64_tr_b16 v[130:131],v167 offset:1024
v_mul_f32 v243,0x3e0293ee,v179
M v[48:51],v[140:143],a[44:47],v[48:51]
ds_read_b64_tr_b16 v[132:133],v167 offset:8192
v_add_f32 v182,v196,v197
v_mul_f32 v182,0x3acccccd,v182
M v[48:51],v[136:139],a[40:43],v[48:51]
ds_read_b64_tr_b16 v[134:135],v167 offset:9216
M v[80:83],v[136:139],a[48:51],v[80:83]
v_mul_f32 v181,0x3acccccd,v181
v_add_f32 v152,v152,v153
v_add_f32 v156,v156,v157
M v[80:83],v[140:143],a[52:55],v[80:83]
ds_write_b32 v254,v152 offset:0
v_fma_f32 v181,-v182,v182,v181
M v[112:115],v[140:143],a[60:63],v[112:115]
v_max_f32 v181,0,v181
v_cvt_pk_bf16_f32 v182,v182,v181
v_and_b32 v181,0xffff0000,v182
M v[112:115],v[136:139],a[56:59],v[112:115]
ds_write_b32 v254,v156 offset:64
s_waitcnt lgkmcnt(6)
M v[20:23],v[144:147],a[32:35],v[20:23]
ds_read_b64_tr_b16 v[136:137],v167 offset:8
v_add_f32 v181,0x3727c5ac,v181
M v[20:23],v[148:151],a[36:39],v[20:23]
ds_read_b64_tr_b16 v[138:139],v167 offset:1032
v_cvt_pk_bf16_f32 v181,v181,v181
v_lshlrev_b32 v181,16,v181
M v[52:55],v[148:151],a[44:47],v[52:55]
ds_read_b64_tr_b16 v[140:141],v167 offset:8200
v_sqrt_f32 v181,v181
M v[52:55],v[144:147],a[40:43],v[52:55]
ds_read_b64_tr_b16 v[142:143],v167 offset:9224
v_lshlrev_b32 v219,16,v182
M v[84:87],v[144:147],a[48:51],v[84:87]
v_cvt_pk_bf16_f32 v181,v181,v181
v_lshlrev_b32 v181,16,v181
M v[84:87],v[148:151],a[52:55],v[84:87]
v_rcp_f32 v183,v181
M v[116:119],v[148:151],a[60:63],v[116:119]
v_sub_f32 v248,0,v219
v_mul_f32 v244,0x3e0293ee,v183
v_add_f32 v186,v200,v201
M v[116:119],v[144:147],a[56:59],v[116:119]
v_mul_f32 v186,0x3acccccd,v186
s_waitcnt lgkmcnt(6)
M v[24:27],v[128:131],a[32:35],v[24:27]
v_mul_f32 v185,0x3acccccd,v185
v_fma_f32 v185,-v186,v186,v185
M v[24:27],v[132:135],a[36:39],v[24:27]
v_max_f32 v185,0,v185
v_cvt_pk_bf16_f32 v186,v186,v185
M v[56:59],v[132:135],a[44:47],v[56:59]
v_and_b32 v185,0xffff0000,v186
v_add_f32 v185,0x3727c5ac,v185
M v[56:59],v[128:131],a[40:43],v[56:59]
v_cvt_pk_bf16_f32 v185,v185,v185
v_lshlrev_b32 v185,16,v185
M v[88:91],v[128:131],a[48:51],v[88:91]
v_sqrt_f32 v185,v185
v_lshlrev_b32 v219,16,v186
M v[88:91],v[132:135],a[52:55],v[88:91]
v_cvt_pk_bf16_f32 v185,v185,v185
v_lshlrev_b32 v185,16,v185
M v[120:123],v[132:135],a[60:63],v[120:123]
v_rcp_f32 v187,v185
v_sub_f32 v249,0,v219
M v[120:123],v[128:131],a[56:59],v[120:123]
v_mul_f32 v245,0x3e0293ee,v187
v_add_f32 v190,v204,v205
s_waitcnt lgkmcnt(0)
M v[28:31],v[136:139],a[32:35],v[28:31]
v_mul_f32 v190,0x3acccccd,v190
M v[28:31],v[140:143],a[36:39],v[28:31]
v_mul_f32 v189,0x3acccccd,v189
v_fma_f32 v189,-v190,v190,v189
M v[60:63],v[140:143],a[44:47],v[60:63]
v_max_f32 v189,0,v189
v_cvt_pk_bf16_f32 v190,v190,v189
v_and_b32 v189,0xffff0000,v190
M v[60:63],v[136:139],a[40:43],v[60:63]
v_add_f32 v189,0x3727c5ac,v189
v_cvt_pk_bf16_f32 v189,v189,v189
M v[92:95],v[136:139],a[48:51],v[92:95]
v_lshlrev_b32 v189,16,v189
v_sqrt_f32 v189,v189
M v[92:95],v[140:143],a[52:55],v[92:95]
v_lshlrev_b32 v219,16,v190
v_cvt_pk_bf16_f32 v189,v189,v189
M v[124:127],v[140:143],a[60:63],v[124:127]
v_lshlrev_b32 v189,16,v189
v_rcp_f32 v191,v189
M v[124:127],v[136:139],a[56:59],v[124:127]
v_sub_f32 v250,0,v219
v_mul_f32 v246,0x3e0293ee,v191
s_waitcnt vmcnt(8)
s_barrier
ds_read_b128 v[128:131],v168 offset:0
ds_read_b128 v[132:135],v168 offset:64
ds_read_b128 v[136:139],v169 offset:0
ds_read_b128 v[140:143],v169 offset:64
ds_read_b128 v[144:147],v170 offset:0
ds_read_b128 v[148:151],v170 offset:64
ds_read_b128 v[152:155],v171 offset:0
ds_read_b128 v[156:159],v171 offset:64
s_cmp_lg_u32 s41,0
s_cbranch_scc1 L_no_router
v_and_b32 v251,15,v242
v_add_u32 v251,s55,v251
v_lshlrev_b32 v252,2,v251
v_sub_u32 v251,0xffff,v251
v_add_f32 v223,v194,v195
v_fma_f32 v223,v247,v217,v223
v_mul_f32 v223,v223,v179
v_and_b32 v222,0xffff,v178
v_or_b32 v177,v177,v222
v_cvt_pk_bf16_f32 v223,v223,v223
v_ashrrev_i32 v222,31,v223
v_or_b32 v222,0x80000000,v222
v_xor_b32 v223,v223,v222
v_and_b32 v223,0xffff0000,v223
v_subrev_u32 v222,0,v251
v_or_b32 v176,v223,v222
v_add_f32 v223,v198,v199
v_fma_f32 v223,v248,v217,v223
v_mul_f32 v223,v223,v183
v_and_b32 v222,0xffff,v182
v_or_b32 v181,v181,v222
v_cvt_pk_bf16_f32 v223,v223,v223
v_ashrrev_i32 v222,31,v223
v_or_b32 v222,0x80000000,v222
v_xor_b32 v223,v223,v222
v_and_b32 v223,0xffff0000,v223
v_subrev_u32 v222,16,v251
v_or_b32 v223,v223,v222
v_max_u32 v176,v176,v223
v_add_f32 v223,v202,v203
v_fma_f32 v223,v249,v217,v223
v_mul_f32 v223,v223,v187
v_and_b32 v222,0xffff,v186
v_or_b32 v185,v185,v222
v_cvt_pk_bf16_f32 v223,v223,v223
v_ashrrev_i32 v222,31,v223
v_or_b32 v222,0x80000000,v222
v_xor_b32 v223,v223,v222
v_and_b32 v223,0xffff0000,v223
v_subrev_u32 v222,32,v251
v_or_b32 v223,v223,v222
v_max_u32 v176,v176,v223
v_add_f32 v223,v206,v207
v_fma_f32 v223,v250,v217,v223
v_mul_f32 v223,v223,v191
v_and_b32 v222,0xffff,v190
v_or_b32 v189,v189,v222
v_cvt_pk_bf16_f32 v223,v223,v223
v_ashrrev_i32 v222,31,v223
v_or_b32 v222,0x80000000,v222
v_xor_b32 v223,v223,v222
v_and_b32 v223,0xffff0000,v223
v_subrev_u32 v222,48,v251
v_or_b32 v223,v223,v222
v_max_u32 v176,v176,v223
s_nop 1
v_max_u32_dpp v176,v176,v176 row_ror:8 row_mask:0xf bank_mask:0xf
s_nop 1
v_max_u32_dpp v176,v176,v176 row_ror:4 row_mask:0xf bank_mask:0xf
s_nop 1
v_max_u32_dpp v176,v176,v176 row_ror:2 row_mask:0xf bank_mask:0xf
s_nop 1
v_max_u32_dpp v176,v176,v176 row_ror:1 row_mask:0xf bank_mask:0xf
L_no_router:
s_waitcnt lgkmcnt(0)
s_nop 0
buffer_store_dword v177,v252,s[32:35],s92 offen offset:0 sc1
v_pk_fma_f32 v[0:1],v[246:247],v[128:129],v[0:1] op_sel:[1,0,0] op_sel_hi:[1,1,1]
v_pk_fma_f32 v[2:3],v[246:247],v[130:131],v[2:3] op_sel:[1,0,0] op_sel_hi:[1,1,1]
v_pk_mul_f32 v[0:1],v[242:243],v[0:1] op_sel:[1,0] op_sel_hi:[1,1]
v_pk_mul_f32 v[2:3],v[242:243],v[2:3] op_sel:[1,0] op_sel_hi:[1,1]
v_cvt_pk_bf16_f32 v0,v0,v1
v_cvt_pk_bf16_f32 v2,v2,v3
v_accvgpr_write_b32 a128,v0
v_accvgpr_write_b32 a129,v2
v_pk_fma_f32 v[4:5],v[246:247],v[132:133],v[4:5] op_sel:[1,0,0] op_sel_hi:[1,1,1]
v_pk_fma_f32 v[6:7],v[246:247],v[134:135],v[6:7] op_sel:[1,0,0] op_sel_hi:[1,1,1]
v_pk_mul_f32 v[4:5],v[242:243],v[4:5] op_sel:[1,0] op_sel_hi:[1,1]
v_pk_mul_f32 v[6:7],v[242:243],v[6:7] op_sel:[1,0] op_sel_hi:[1,1]
v_cvt_pk_bf16_f32 v4,v4,v5
s_nop 0
ds_read_b128 a[192:195],v224 offset:49152
v_cvt_pk_bf16_f32 v6,v6,v7
v_accvgpr_write_b32 a130,v4
v_accvgpr_write_b32 a131,v6
v_pk_fma_f32 v[8:9],v[246:247],v[136:137],v[8:9] op_sel:[1,0,0] op_sel_hi:[1,1,1]
v_pk_fma_f32 v[10:11],v[246:247],v[138:139],v[10:11] op_sel:[1,0,0] op_sel_hi:[1,1,1]
v_pk_mul_f32 v[8:9],v[242:243],v[8:9] op_sel:[1,0] op_sel_hi:[1,1]
s_nop 0
buffer_store_dword v181,v252,s[32:35],s92 offen offset:64 sc1
v_pk_mul_f32 v[10:11],v[242:243],v[10:11] op_sel:[1,0] op_sel_hi:[1,1]
v_cvt_pk_bf16_f32 v8,v8,v9
v_cvt_pk_bf16_f32 v10,v10,v11
s_nop 0
ds_read_b128 a[196:199],v225 offset:49152
v_accvgpr_write_b32 a144,v8
v_accvgpr_write_b32 a145,v10
v_pk_fma_f32 v[12:13],v[246:247],v[140:141],v[12:13] op_sel:[1,0,0] op_sel_hi:[1,1,1]
v_pk_fma_f32 v[14:15],v[246:247],v[142:143],v[14:15] op_sel:[1,0,0] op_sel_hi:[1,1,1]
v_pk_mul_f32 v[12:13],v[242:243],v[12:13] op_sel:[1,0] op_sel_hi:[1,1]
v_pk_mul_f32 v[14:15],v[242:243],v[14:15] op_sel:[1,0] op_sel_hi:[1,1]
v_cvt_pk_bf16_f32 v12,v12,v13
v_cvt_pk_bf16_f32 v14,v14,v15
v_accvgpr_write_b32 a146,v12
s_nop 0
ds_read_b128 a[200:203],v226 offset:49152
v_accvgpr_write_b32 a147,v14
v_pk_fma_f32 v[16:17],v[246:247],v[144:145],v[16:17] op_sel:[1,0,0] op_sel_hi:[1,1,1]
v_pk_fma_f32 v[18:19],v[246:247],v[146:147],v[18:19] op_sel:[1,0,0] op_sel_hi:[1,1,1]
v_pk_mul_f32 v[16:17],v[242:243],v[16:17] op_sel:[1,0] op_sel_hi:[1,1]
v_pk_mul_f32 v[18:19],v[242:243],v[18:19] op_sel:[1,0] op_sel_hi:[1,1]
s_nop 0
buffer_store_dword v185,v252,s[32:35],s92 offen offset:128 sc1
v_cvt_pk_bf16_f32 v16,v16,v17
v_cvt_pk_bf16_f32 v18,v18,v19
v_accvgpr_write_b32 a160,v16
s_nop 0
ds_read_b128 a[204:207],v227 offset:49152
v_accvgpr_write_b32 a161,v18
v_pk_fma_f32 v[20:21],v[246:247],v[148:149],v[20:21] op_sel:[1,0,0] op_sel_hi:[1,1,1]
v_pk_fma_f32 v[22:23],v[246:247],v[150:151],v[22:23] op_sel:[1,0,0] op_sel_hi:[1,1,1]
v_pk_mul_f32 v[20:21],v[242:243],v[20:21] op_sel:[1,0] op_sel_hi:[1,1]
v_pk_mul_f32 v[22:23],v[242:243],v[22:23] op_sel:[1,0] op_sel_hi:[1,1]
v_cvt_pk_bf16_f32 v20,v20,v21
v_cvt_pk_bf16_f32 v22,v22,v23
v_accvgpr_write_b32 a162,v20
v_accvgpr_write_b32 a163,v22
s_nop 0
ds_read_b128 a[208:211],v224 offset:53248
v_pk_fma_f32 v[24:25],v[246:247],v[152:153],v[24:25] op_sel:[1,0,0] op_sel_hi:[1,1,1]
v_pk_fma_f32 v[26:27],v[246:247],v[154:155],v[26:27] op_sel:[1,0,0] op_sel_hi:[1,1,1]
v_pk_mul_f32 v[24:25],v[242:243],v[24:25] op_sel:[1,0] op_sel_hi:[1,1]
v_pk_mul_f32 v[26:27],v[242:243],v[26:27] op_sel:[1,0] op_sel_hi:[1,1]
s_nop 0
buffer_store_dword v189,v252,s[32:35],s92 offen offset:192 sc1
v_cvt_pk_bf16_f32 v24,v24,v25
v_cvt_pk_bf16_f32 v26,v26,v27
v_accvgpr_write_b32 a176,v24
v_accvgpr_write_b32 a177,v26
v_pk_fma_f32 v[28:29],v[246:247],v[156:157],v[28:29] op_sel:[1,0,0] op_sel_hi:[1,1,1]
s_nop 0
ds_read_b128 a[212:215],v225 offset:53248
v_pk_fma_f32 v[30:31],v[246:247],v[158:159],v[30:31] op_sel:[1,0,0] op_sel_hi:[1,1,1]
v_pk_mul_f32 v[28:29],v[242:243],v[28:29] op_sel:[1,0] op_sel_hi:[1,1]
v_pk_mul_f32 v[30:31],v[242:243],v[30:31] op_sel:[1,0] op_sel_hi:[1,1]
v_cvt_pk_bf16_f32 v28,v28,v29
v_cvt_pk_bf16_f32 v30,v30,v31
v_accvgpr_write_b32 a178,v28
v_accvgpr_write_b32 a179,v30
v_pk_fma_f32 v[32:33],v[248:249],v[128:129],v[32:33] op_sel:[0,0,0] op_sel_hi:[0,1,1]
v_pk_fma_f32 v[34:35],v[248:249],v[130:131],v[34:35] op_sel:[0,0,0] op_sel_hi:[0,1,1]
s_nop 0
ds_read_b128 a[216:219],v226 offset:53248
v_pk_mul_f32 v[32:33],v[244:245],v[32:33] op_sel:[0,0] op_sel_hi:[0,1]
v_pk_mul_f32 v[34:35],v[244:245],v[34:35] op_sel:[0,0] op_sel_hi:[0,1]
v_cvt_pk_bf16_f32 v32,v32,v33
s_add_u32 m0,s48,32768
s_nop 0
buffer_load_dwordx4 v236,s[12:15],s43 offen offset:0 nt lds
v_cvt_pk_bf16_f32 v34,v34,v35
v_accvgpr_write_b32 a132,v32
v_accvgpr_write_b32 a133,v34
v_pk_fma_f32 v[36:37],v[248:249],v[132:133],v[36:37] op_sel:[0,0,0] op_sel_hi:[0,1,1]
v_pk_fma_f32 v[38:39],v[248:249],v[134:135],v[38:39] op_sel:[0,0,0] op_sel_hi:[0,1,1]
s_nop 0
ds_read_b128 a[220:223],v227 offset:53248
v_pk_mul_f32 v[36:37],v[244:245],v[36:37] op_sel:[0,0] op_sel_hi:[0,1]
v_pk_mul_f32 v[38:39],v[244:245],v[38:39] op_sel:[0,0] op_sel_hi:[0,1]
v_cvt_pk_bf16_f32 v36,v36,v37
v_cvt_pk_bf16_f32 v38,v38,v39
v_accvgpr_write_b32 a134,v36
v_accvgpr_write_b32 a135,v38
v_pk_fma_f32 v[40:41],v[248:249],v[136:137],v[40:41] op_sel:[0,0,0] op_sel_hi:[0,1,1]
v_pk_fma_f32 v[42:43],v[248:249],v[138:139],v[42:43] op_sel:[0,0,0] op_sel_hi:[0,1,1]
v_pk_mul_f32 v[40:41],v[244:245],v[40:41] op_sel:[0,0] op_sel_hi:[0,1]
s_nop 0
ds_read_b128 a[224:227],v224 offset:57344
v_pk_mul_f32 v[42:43],v[244:245],v[42:43] op_sel:[0,0] op_sel_hi:[0,1]
v_cvt_pk_bf16_f32 v40,v40,v41
v_cvt_pk_bf16_f32 v42,v42,v43
v_accvgpr_write_b32 a148,v40
v_accvgpr_write_b32 a149,v42
v_pk_fma_f32 v[44:45],v[248:249],v[140:141],v[44:45] op_sel:[0,0,0] op_sel_hi:[0,1,1]
v_pk_fma_f32 v[46:47],v[248:249],v[142:143],v[46:47] op_sel:[0,0,0] op_sel_hi:[0,1,1]
v_pk_mul_f32 v[44:45],v[244:245],v[44:45] op_sel:[0,0] op_sel_hi:[0,1]
v_pk_mul_f32 v[46:47],v[244:245],v[46:47] op_sel:[0,0] op_sel_hi:[0,1]
s_nop 0
ds_read_b128 a[228:231],v225 offset:57344
s_nop 0
buffer_load_dwordx4 v237,s[12:15],s43 offen offset:1024 nt lds
v_cvt_pk_bf16_f32 v44,v44,v45
v_cvt_pk_bf16_f32 v46,v46,v47
v_accvgpr_write_b32 a150,v44
v_accvgpr_write_b32 a151,v46
v_pk_fma_f32 v[48:49],v[248:249],v[144:145],v[48:49] op_sel:[0,0,0] op_sel_hi:[0,1,1]
v_pk_fma_f32 v[50:51],v[248:249],v[146:147],v[50:51] op_sel:[0,0,0] op_sel_hi:[0,1,1]
v_pk_mul_f32 v[48:49],v[244:245],v[48:49] op_sel:[0,0] op_sel_hi:[0,1]
v_pk_mul_f32 v[50:51],v[244:245],v[50:51] op_sel:[0,0] op_sel_hi:[0,1]
s_nop 0
ds_read_b128 a[232:235],v226 offset:57344
v_cvt_pk_bf16_f32 v48,v48,v49
v_cvt_pk_bf16_f32 v50,v50,v51
v_accvgpr_write_b32 a164,v48
v_accvgpr_write_b32 a165,v50
v_pk_fma_f32 v[52:53],v[248:249],v[148:149],v[52:53] op_sel:[0,0,0] op_sel_hi:[0,1,1]
v_pk_fma_f32 v[54:55],v[248:249],v[150:151],v[54:55] op_sel:[0,0,0] op_sel_hi:[0,1,1]
v_pk_mul_f32 v[52:53],v[244:245],v[52:53] op_sel:[0,0] op_sel_hi:[0,1]
v_pk_mul_f32 v[54:55],v[244:245],v[54:55] op_sel:[0,0] op_sel_hi:[0,1]
v_cvt_pk_bf16_f32 v52,v52,v53
s_nop 0
buffer_load_dwordx4 v238,s[12:15],s43 offen offset:2048 nt lds
s_nop 0
ds_read_b128 a[236:239],v227 offset:57344
v_cvt_pk_bf16_f32 v54,v54,v55
v_accvgpr_write_b32 a166,v52
v_accvgpr_write_b32 a167,v54
v_pk_fma_f32 v[56:57],v[248:249],v[152:153],v[56:57] op_sel:[0,0,0] op_sel_hi:[0,1,1]
v_pk_fma_f32 v[58:59],v[248:249],v[154:155],v[58:59] op_sel:[0,0,0] op_sel_hi:[0,1,1]
v_pk_mul_f32 v[56:57],v[244:245],v[56:57] op_sel:[0,0] op_sel_hi:[0,1]
v_pk_mul_f32 v[58:59],v[244:245],v[58:59] op_sel:[0,0] op_sel_hi:[0,1]
v_cvt_pk_bf16_f32 v56,v56,v57
v_cvt_pk_bf16_f32 v58,v58,v59
s_waitcnt lgkmcnt(8)
v_accvgpr_write_b32 a180,v56
v_accvgpr_write_b32 a181,v58
v_pk_fma_f32 v[60:61],v[248:249],v[156:157],v[60:61] op_sel:[0,0,0] op_sel_hi:[0,1,1]
v_pk_fma_f32 v[62:63],v[248:249],v[158:159],v[62:63] op_sel:[0,0,0] op_sel_hi:[0,1,1]
s_nop 0
ds_read_b128 a[240:243],v224 offset:61440
v_pk_mul_f32 v[60:61],v[244:245],v[60:61] op_sel:[0,0] op_sel_hi:[0,1]
v_pk_mul_f32 v[62:63],v[244:245],v[62:63] op_sel:[0,0] op_sel_hi:[0,1]
v_cvt_pk_bf16_f32 v60,v60,v61
s_nop 0
buffer_load_dwordx4 v239,s[12:15],s43 offen offset:3072 nt lds
v_cvt_pk_bf16_f32 v62,v62,v63
v_accvgpr_write_b32 a182,v60
v_accvgpr_write_b32 a183,v62
v_pk_fma_f32 v[64:65],v[248:249],v[128:129],v[64:65] op_sel:[1,0,0] op_sel_hi:[1,1,1]
v_pk_fma_f32 v[66:67],v[248:249],v[130:131],v[66:67] op_sel:[1,0,0] op_sel_hi:[1,1,1]
v_pk_mul_f32 v[64:65],v[244:245],v[64:65] op_sel:[1,0] op_sel_hi:[1,1]
s_nop 0
ds_read_b128 a[244:247],v225 offset:61440
v_pk_mul_f32 v[66:67],v[244:245],v[66:67] op_sel:[1,0] op_sel_hi:[1,1]
v_cvt_pk_bf16_f32 v64,v64,v65
v_cvt_pk_bf16_f32 v66,v66,v67
v_accvgpr_write_b32 a136,v64
v_accvgpr_write_b32 a137,v66
v_pk_fma_f32 v[68:69],v[248:249],v[132:133],v[68:69] op_sel:[1,0,0] op_sel_hi:[1,1,1]
v_pk_fma_f32 v[70:71],v[248:249],v[134:135],v[70:71] op_sel:[1,0,0] op_sel_hi:[1,1,1]
v_pk_mul_f32 v[68:69],v[244:245],v[68:69] op_sel:[1,0] op_sel_hi:[1,1]
v_pk_mul_f32 v[70:71],v[244:245],v[70:71] op_sel:[1,0] op_sel_hi:[1,1]
s_nop 0
ds_read_b128 a[248:251],v226 offset:61440
v_cvt_pk_bf16_f32 v68,v68,v69
v_cvt_pk_bf16_f32 v70,v70,v71
s_add_u32 s43,s43,16384
v_accvgpr_write_b32 a138,v68
v_accvgpr_write_b32 a139,v70
v_pk_fma_f32 v[72:73],v[248:249],v[136:137],v[72:73] op_sel:[1,0,0] op_sel_hi:[1,1,1]
v_pk_fma_f32 v[74:75],v[248:249],v[138:139],v[74:75] op_sel:[1,0,0] op_sel_hi:[1,1,1]
v_pk_mul_f32 v[72:73],v[244:245],v[72:73] op_sel:[1,0] op_sel_hi:[1,1]
v_pk_mul_f32 v[74:75],v[244:245],v[74:75] op_sel:[1,0] op_sel_hi:[1,1]
s_nop 0
ds_read_b128 a[252:255],v227 offset:61440
s_add_u32 m0,s48,98304
s_nop 0
buffer_load_dwordx4 v240,s[16:19],s44 offen offset:0 nt lds
v_cvt_pk_bf16_f32 v72,v72,v73
v_cvt_pk_bf16_f32 v74,v74,v75
v_accvgpr_write_b32 a152,v72
v_accvgpr_write_b32 a153,v74
v_pk_fma_f32 v[76:77],v[248:249],v[140:141],v[76:77] op_sel:[1,0,0] op_sel_hi:[1,1,1]
v_pk_fma_f32 v[78:79],v[248:249],v[142:143],v[78:79] op_sel:[1,0,0] op_sel_hi:[1,1,1]
v_pk_mul_f32 v[76:77],v[244:245],v[76:77] op_sel:[1,0] op_sel_hi:[1,1]
v_pk_mul_f32 v[78:79],v[244:245],v[78:79] op_sel:[1,0] op_sel_hi:[1,1]
v_cvt_pk_bf16_f32 v76,v76,v77
s_waitcnt lgkmcnt(4)
v_cvt_pk_bf16_f32 v78,v78,v79
v_accvgpr_write_b32 a154,v76
v_accvgpr_write_b32 a155,v78
v_pk_fma_f32 v[80:81],v[248:249],v[144:145],v[80:81] op_sel:[1,0,0] op_sel_hi:[1,1,1]
s_nop 0
ds_read_b128 a[0:3],v224 offset:0
v_pk_fma_f32 v[82:83],v[248:249],v[146:147],v[82:83] op_sel:[1,0,0] op_sel_hi:[1,1,1]
v_pk_mul_f32 v[80:81],v[244:245],v[80:81] op_sel:[1,0] op_sel_hi:[1,1]
v_pk_mul_f32 v[82:83],v[244:245],v[82:83] op_sel:[1,0] op_sel_hi:[1,1]
v_cvt_pk_bf16_f32 v80,v80,v81
v_cvt_pk_bf16_f32 v82,v82,v83
v_accvgpr_write_b32 a168,v80
v_accvgpr_write_b32 a169,v82
v_pk_fma_f32 v[84:85],v[248:249],v[148:149],v[84:85] op_sel:[1,0,0] op_sel_hi:[1,1,1]
v_pk_fma_f32 v[86:87],v[248:249],v[150:151],v[86:87] op_sel:[1,0,0] op_sel_hi:[1,1,1]
s_nop 0
ds_read_b128 a[4:7],v225 offset:0
s_nop 0
buffer_load_dwordx4 v241,s[16:19],s44 offen offset:1024 nt lds
v_pk_mul_f32 v[84:85],v[244:245],v[84:85] op_sel:[1,0] op_sel_hi:[1,1]
v_pk_mul_f32 v[86:87],v[244:245],v[86:87] op_sel:[1,0] op_sel_hi:[1,1]
v_cvt_pk_bf16_f32 v84,v84,v85
v_cvt_pk_bf16_f32 v86,v86,v87
v_accvgpr_write_b32 a170,v84
v_accvgpr_write_b32 a171,v86
v_pk_fma_f32 v[88:89],v[248:249],v[152:153],v[88:89] op_sel:[1,0,0] op_sel_hi:[1,1,1]
v_pk_fma_f32 v[90:91],v[248:249],v[154:155],v[90:91] op_sel:[1,0,0] op_sel_hi:[1,1,1]
v_pk_mul_f32 v[88:89],v[244:245],v[88:89] op_sel:[1,0] op_sel_hi:[1,1]
s_nop 0
ds_read_b128 a[8:11],v226 offset:0
v_pk_mul_f32 v[90:91],v[244:245],v[90:91] op_sel:[1,0] op_sel_hi:[1,1]
v_cvt_pk_bf16_f32 v88,v88,v89
v_cvt_pk_bf16_f32 v90,v90,v91
v_accvgpr_write_b32 a184,v88
v_accvgpr_write_b32 a185,v90
v_pk_fma_f32 v[92:93],v[248:249],v[156:157],v[92:93] op_sel:[1,0,0] op_sel_hi:[1,1,1]
v_pk_fma_f32 v[94:95],v[248:249],v[158:159],v[94:95] op_sel:[1,0,0] op_sel_hi:[1,1,1]
v_pk_mul_f32 v[92:93],v[244:245],v[92:93] op_sel:[1,0] op_sel_hi:[1,1]
s_nop 0
ds_read_b128 a[12:15],v227 offset:0
s_nop 0
buffer_load_dwordx4 v240,s[16:19],s44 offen offset:2048 nt lds
v_pk_mul_f32 v[94:95],v[244:245],v[94:95] op_sel:[1,0] op_sel_hi:[1,1]
v_cvt_pk_bf16_f32 v92,v92,v93
v_cvt_pk_bf16_f32 v94,v94,v95
v_accvgpr_write_b32 a186,v92
v_accvgpr_write_b32 a187,v94
v_pk_fma_f32 v[96:97],v[250:251],v[128:129],v[96:97] op_sel:[0,0,0] op_sel_hi:[0,1,1]
v_pk_fma_f32 v[98:99],v[250:251],v[130:131],v[98:99] op_sel:[0,0,0] op_sel_hi:[0,1,1]
v_pk_mul_f32 v[96:97],v[246:247],v[96:97] op_sel:[0,0] op_sel_hi:[0,1]
v_pk_mul_f32 v[98:99],v[246:247],v[98:99] op_sel:[0,0] op_sel_hi:[0,1]
s_nop 0
ds_read_b128 a[16:19],v224 offset:4096
v_cvt_pk_bf16_f32 v96,v96,v97
v_cvt_pk_bf16_f32 v98,v98,v99
v_accvgpr_write_b32 a140,v96
v_accvgpr_write_b32 a141,v98
v_pk_fma_f32 v[100:101],v[250:251],v[132:133],v[100:101] op_sel:[0,0,0] op_sel_hi:[0,1,1]
v_pk_fma_f32 v[102:103],v[250:251],v[134:135],v[102:103] op_sel:[0,0,0] op_sel_hi:[0,1,1]
v_pk_mul_f32 v[100:101],v[246:247],v[100:101] op_sel:[0,0] op_sel_hi:[0,1]
v_pk_mul_f32 v[102:103],v[246:247],v[102:103] op_sel:[0,0] op_sel_hi:[0,1]
s_nop 0
buffer_load_dwordx4 v241,s[16:19],s44 offen offset:3072 nt lds
v_cvt_pk_bf16_f32 v100,v100,v101
s_nop 0
ds_read_b128 a[20:23],v225 offset:4096
v_cvt_pk_bf16_f32 v102,v102,v103
v_accvgpr_write_b32 a142,v100
v_accvgpr_write_b32 a143,v102
v_pk_fma_f32 v[104:105],v[250:251],v[136:137],v[104:105] op_sel:[0,0,0] op_sel_hi:[0,1,1]
v_pk_fma_f32 v[106:107],v[250:251],v[138:139],v[106:107] op_sel:[0,0,0] op_sel_hi:[0,1,1]
v_pk_mul_f32 v[104:105],v[246:247],v[104:105] op_sel:[0,0] op_sel_hi:[0,1]
v_pk_mul_f32 v[106:107],v[246:247],v[106:107] op_sel:[0,0] op_sel_hi:[0,1]
v_cvt_pk_bf16_f32 v104,v104,v105
s_nop 0
ds_read_b128 a[24:27],v226 offset:4096
v_cvt_pk_bf16_f32 v106,v106,v107
v_accvgpr_write_b32 a156,v104
v_accvgpr_write_b32 a157,v106
v_pk_fma_f32 v[108:109],v[250:251],v[140:141],v[108:109] op_sel:[0,0,0] op_sel_hi:[0,1,1]
v_pk_fma_f32 v[110:111],v[250:251],v[142:143],v[110:111] op_sel:[0,0,0] op_sel_hi:[0,1,1]
v_pk_mul_f32 v[108:109],v[246:247],v[108:109] op_sel:[0,0] op_sel_hi:[0,1]
v_pk_mul_f32 v[110:111],v[246:247],v[110:111] op_sel:[0,0] op_sel_hi:[0,1]
v_cvt_pk_bf16_f32 v108,v108,v109
s_add_u32 s44,s44,16384
v_cvt_pk_bf16_f32 v110,v110,v111
s_nop 0
ds_read_b128 a[28:31],v227 offset:4096
v_accvgpr_write_b32 a158,v108
v_accvgpr_write_b32 a159,v110
v_pk_fma_f32 v[112:113],v[250:251],v[144:145],v[112:113] op_sel:[0,0,0] op_sel_hi:[0,1,1]
v_pk_fma_f32 v[114:115],v[250:251],v[146:147],v[114:115] op_sel:[0,0,0] op_sel_hi:[0,1,1]
v_pk_mul_f32 v[112:113],v[246:247],v[112:113] op_sel:[0,0] op_sel_hi:[0,1]
v_pk_mul_f32 v[114:115],v[246:247],v[114:115] op_sel:[0,0] op_sel_hi:[0,1]
v_cvt_pk_bf16_f32 v112,v112,v113
v_cvt_pk_bf16_f32 v114,v114,v115
v_accvgpr_write_b32 a172,v112
v_accvgpr_write_b32 a173,v114
v_pk_fma_f32 v[116:117],v[250:251],v[148:149],v[116:117] op_sel:[0,0,0] op_sel_hi:[0,1,1]
v_pk_fma_f32 v[118:119],v[250:251],v[150:151],v[118:119] op_sel:[0,0,0] op_sel_hi:[0,1,1]
v_pk_mul_f32 v[116:117],v[246:247],v[116:117] op_sel:[0,0] op_sel_hi:[0,1]
v_pk_mul_f32 v[118:119],v[246:247],v[118:119] op_sel:[0,0] op_sel_hi:[0,1]
v_cvt_pk_bf16_f32 v116,v116,v117
v_cvt_pk_bf16_f32 v118,v118,v119
v_accvgpr_write_b32 a174,v116
v_accvgpr_write_b32 a175,v118
v_pk_fma_f32 v[120:121],v[250:251],v[152:153],v[120:121] op_sel:[0,0,0] op_sel_hi:[0,1,1]
v_pk_fma_f32 v[122:123],v[250:251],v[154:155],v[122:123] op_sel:[0,0,0] op_sel_hi:[0,1,1]
v_pk_mul_f32 v[120:121],v[246:247],v[120:121] op_sel:[0,0] op_sel_hi:[0,1]
v_pk_mul_f32 v[122:123],v[246:247],v[122:123] op_sel:[0,0] op_sel_hi:[0,1]
v_cvt_pk_bf16_f32 v120,v120,v121
v_cvt_pk_bf16_f32 v122,v122,v123
v_accvgpr_write_b32 a188,v120
v_accvgpr_write_b32 a189,v122
v_pk_fma_f32 v[124:125],v[250:251],v[156:157],v[124:125] op_sel:[0,0,0] op_sel_hi:[0,1,1]
v_pk_fma_f32 v[126:127],v[250:251],v[158:159],v[126:127] op_sel:[0,0,0] op_sel_hi:[0,1,1]
v_pk_mul_f32 v[124:125],v[246:247],v[124:125] op_sel:[0,0] op_sel_hi:[0,1]
v_pk_mul_f32 v[126:127],v[246:247],v[126:127] op_sel:[0,0] op_sel_hi:[0,1]
v_cvt_pk_bf16_f32 v124,v124,v125
v_cvt_pk_bf16_f32 v126,v126,v127
v_accvgpr_write_b32 a190,v124
v_accvgpr_write_b32 a191,v126
v_mov_b32 v208,v160
v_mov_b32 v209,v160
s_cmp_lg_u32 s81,0
s_cbranch_scc1 L_exact
s_waitcnt lgkmcnt(8)
M v[0:3],a[192:195],a[128:131],0
ds_read_b128 a[32:35],v224 offset:8192
M v[0:3],a[196:199],a[144:147],v[0:3]
ds_read_b128 a[36:39],v225 offset:8192
M v[0:3],a[200:203],a[160:163],v[0:3]
ds_read_b128 a[40:43],v226 offset:8192
M v[0:3],a[204:207],a[176:179],v[0:3]
ds_read_b128 a[44:47],v227 offset:8192
M v[16:19],a[204:207],a[180:183],0
ds_read_b128 a[48:51],v224 offset:12288
M v[16:19],a[200:203],a[164:167],v[16:19]
ds_read_b128 a[52:55],v225 offset:12288
M v[16:19],a[196:199],a[148:151],v[16:19]
ds_read_b128 a[56:59],v226 offset:12288
M v[16:19],a[192:195],a[132:135],v[16:19]
ds_read_b128 a[60:63],v227 offset:12288
M v[32:35],a[192:195],a[136:139],0
M v[32:35],a[196:199],a[152:155],v[32:35]
v_mov_b32 v210,v160
v_mov_b32 v211,v160
v_max3_f32 v218,v0,v1,v2
v_max_f32 v218,v218,v3
M v[32:35],a[200:203],a[168:171],v[32:35]
v_mov_b32 v223,v218
s_nop 1
v_permlane32_swap_b32 v218,v223
v_max_f32 v218,v218,v223
v_mov_b32 v223,v218
M v[32:35],a[204:207],a[184:187],v[32:35]
s_nop 1
v_permlane16_swap_b32 v218,v223
v_max_f32 v218,v218,v223
v_sub_f32 v192,0,v218
M v[48:51],a[204:207],a[188:191],0
v_sub_f32 v193,0,v218
v_sub_f32 v194,0,v218
v_sub_f32 v195,0,v218
v_max3_f32 v219,v16,v17,v18
M v[48:51],a[200:203],a[172:175],v[48:51]
v_max_f32 v219,v219,v19
v_mov_b32 v223,v219
s_nop 1
v_permlane32_swap_b32 v219,v223
M v[48:51],a[196:199],a[156:159],v[48:51]
v_max_f32 v219,v219,v223
v_mov_b32 v223,v219
s_nop 1
v_permlane16_swap_b32 v219,v223
v_max_f32 v219,v219,v223
M v[48:51],a[192:195],a[140:143],v[48:51]
v_sub_f32 v196,0,v219
v_sub_f32 v197,0,v219
v_sub_f32 v198,0,v219
v_sub_f32 v199,0,v219
M v[4:7],a[208:211],a[128:131],0
M v[4:7],a[212:215],a[144:147],v[4:7]
M v[4:7],a[216:219],a[160:163],v[4:7]
v_max3_f32 v220,v32,v33,v34
v_max_f32 v220,v220,v35
M v[4:7],a[220:223],a[176:179],v[4:7]
v_mov_b32 v223,v220
s_nop 1
M v[8:11],a[236:239],a[176:179],0
v_permlane32_swap_b32 v220,v223
M v[8:11],a[232:235],a[160:163],v[8:11]
v_max_f32 v220,v220,v223
v_mov_b32 v223,v220
M v[8:11],a[228:231],a[144:147],v[8:11]
s_nop 1
v_permlane16_swap_b32 v220,v223
M v[8:11],a[224:227],a[128:131],v[8:11]
v_max_f32 v220,v220,v223
v_sub_f32 v200,0,v220
M v[12:15],a[240:243],a[128:131],0
v_sub_f32 v201,0,v220
v_sub_f32 v202,0,v220
M v[12:15],a[244:247],a[144:147],v[12:15]
v_sub_f32 v203,0,v220
M v[12:15],a[248:251],a[160:163],v[12:15]
v_max3_f32 v221,v48,v49,v50
v_max_f32 v221,v221,v51
M v[12:15],a[252:255],a[176:179],v[12:15]
v_mov_b32 v223,v221
s_nop 1
M v[20:23],a[208:211],a[132:135],0
v_permlane32_swap_b32 v221,v223
v_max_f32 v221,v221,v223
M v[20:23],a[212:215],a[148:151],v[20:23]
v_mov_b32 v223,v221
s_nop 1
M v[20:23],a[216:219],a[164:167],v[20:23]
v_permlane16_swap_b32 v221,v223
M v[20:23],a[220:223],a[180:183],v[20:23]
v_max_f32 v221,v221,v223
v_sub_f32 v204,0,v221
M v[24:27],a[236:239],a[180:183],0
v_sub_f32 v205,0,v221
v_sub_f32 v206,0,v221
M v[24:27],a[232:235],a[164:167],v[24:27]
v_sub_f32 v207,0,v221
v_sub_f32 v32,v32,v220
M v[24:27],a[228:231],a[148:151],v[24:27]
v_sub_f32 v33,v33,v220
v_sub_f32 v34,v34,v220
M v[24:27],a[224:227],a[132:135],v[24:27]
v_sub_f32 v35,v35,v220
M v[28:31],a[240:243],a[132:135],0
v_sub_f32 v48,v48,v221
v_sub_f32 v49,v49,v221
M v[28:31],a[244:247],a[148:151],v[28:31]
v_sub_f32 v50,v50,v221
v_sub_f32 v51,v51,v221
M v[28:31],a[248:251],a[164:167],v[28:31]
M v[28:31],a[252:255],a[180:183],v[28:31]
M v[36:39],a[208:211],a[136:139],v[200:203]
v_sub_f32 v0,v0,v218
v_sub_f32 v1,v1,v218
M v[36:39],a[212:215],a[152:155],v[36:39]
v_sub_f32 v2,v2,v218
v_sub_f32 v3,v3,v218
M v[36:39],a[216:219],a[168:171],v[36:39]
v_sub_f32 v4,v4,v218
v_sub_f32 v5,v5,v218
M v[36:39],a[220:223],a[184:187],v[36:39]
v_sub_f32 v6,v6,v218
v_sub_f32 v7,v7,v218
M v[40:43],a[236:239],a[184:187],v[200:203]
v_sub_f32 v8,v8,v218
v_sub_f32 v9,v9,v218
M v[40:43],a[232:235],a[168:171],v[40:43]
v_sub_f32 v10,v10,v218
v_sub_f32 v11,v11,v218
M v[40:43],a[228:231],a[152:155],v[40:43]
v_sub_f32 v12,v12,v218
v_sub_f32 v13,v13,v218
M v[40:43],a[224:227],a[136:139],v[40:43]
v_sub_f32 v14,v14,v218
v_sub_f32 v15,v15,v218
M v[44:47],a[240:243],a[136:139],v[200:203]
v_sub_f32 v16,v16,v219
v_sub_f32 v17,v17,v219
M v[44:47],a[244:247],a[152:155],v[44:47]
v_sub_f32 v18,v18,v219
v_sub_f32 v19,v19,v219
M v[44:47],a[248:251],a[168:171],v[44:47]
v_sub_f32 v20,v20,v219
v_sub_f32 v21,v21,v219
M v[44:47],a[252:255],a[184:187],v[44:47]
v_sub_f32 v22,v22,v219
v_sub_f32 v23,v23,v219
M v[52:55],a[208:211],a[140:143],v[204:207]
v_sub_f32 v24,v24,v219
v_sub_f32 v25,v25,v219
M v[52:55],a[212:215],a[156:159],v[52:55]
v_sub_f32 v26,v26,v219
v_sub_f32 v27,v27,v219
M v[52:55],a[216:219],a[172:175],v[52:55]
v_sub_f32 v28,v28,v219
v_sub_f32 v29,v29,v219
M v[52:55],a[220:223],a[188:191],v[52:55]
v_sub_f32 v30,v30,v219
v_sub_f32 v31,v31,v219
M v[56:59],a[236:239],a[188:191],v[204:207]
v_exp_f32 v0,v0
M v[56:59],a[232:235],a[172:175],v[56:59]
v_exp_f32 v1,v1
M v[56:59],a[228:231],a[156:159],v[56:59]
v_exp_f32 v2,v2
M v[56:59],a[224:227],a[140:143],v[56:59]
v_exp_f32 v3,v3
v_cvt_pk_bf16_f32 v128,v0,v1
M v[60:63],a[240:243],a[140:143],v[204:207]
v_exp_f32 v4,v4
M v[60:63],a[244:247],a[156:159],v[60:63]
v_exp_f32 v5,v5
v_cvt_pk_bf16_f32 v129,v2,v3
M v[60:63],a[248:251],a[172:175],v[60:63]
v_exp_f32 v6,v6
M v[60:63],a[252:255],a[188:191],v[60:63]
v_exp_f32 v7,v7
s_waitcnt lgkmcnt(0)
M v[64:67],a[0:3],a[128:131],v[192:195]
v_cvt_pk_bf16_f32 v130,v4,v5
v_exp_f32 v8,v8
M v[64:67],a[4:7],a[144:147],v[64:67]
v_exp_f32 v9,v9
v_cvt_pk_bf16_f32 v131,v6,v7
M v[64:67],a[8:11],a[160:163],v[64:67]
v_exp_f32 v10,v10
M v[64:67],a[12:15],a[176:179],v[64:67]
v_exp_f32 v11,v11
v_cvt_pk_bf16_f32 v132,v8,v9
M v[68:71],a[28:31],a[176:179],v[192:195]
v_exp_f32 v12,v12
v_exp_f32 v13,v13
M v[68:71],a[24:27],a[160:163],v[68:71]
v_cvt_pk_bf16_f32 v133,v10,v11
v_exp_f32 v14,v14
M v[68:71],a[20:23],a[144:147],v[68:71]
v_exp_f32 v15,v15
v_cvt_pk_bf16_f32 v134,v12,v13
M v[68:71],a[16:19],a[128:131],v[68:71]
v_exp_f32 v16,v16
v_exp_f32 v17,v17
M v[72:75],a[32:35],a[128:131],v[192:195]
v_cvt_pk_bf16_f32 v135,v14,v15
v_exp_f32 v18,v18
M v[72:75],a[36:39],a[144:147],v[72:75]
v_exp_f32 v19,v19
v_accvgpr_write_b32 a224,0
M v[72:75],a[40:43],a[160:163],v[72:75]
v_cvt_pk_bf16_f32 v136,v16,v17
v_exp_f32 v20,v20
M v[72:75],a[44:47],a[176:179],v[72:75]
v_exp_f32 v21,v21
v_accvgpr_write_b32 a225,0
M v[76:79],a[60:63],a[176:179],v[192:195]
v_cvt_pk_bf16_f32 v137,v18,v19
v_exp_f32 v22,v22
M v[76:79],a[56:59],a[160:163],v[76:79]
v_exp_f32 v23,v23
v_cvt_pk_bf16_f32 v138,v20,v21
M v[76:79],a[52:55],a[144:147],v[76:79]
v_accvgpr_write_b32 a226,0
v_exp_f32 v24,v24
M v[76:79],a[48:51],a[128:131],v[76:79]
v_exp_f32 v25,v25
M v[80:83],a[0:3],a[132:135],v[196:199]
v_cvt_pk_bf16_f32 v139,v22,v23
v_exp_f32 v26,v26
M v[80:83],a[4:7],a[148:151],v[80:83]
v_accvgpr_write_b32 a227,0
v_exp_f32 v27,v27
M v[80:83],a[8:11],a[164:167],v[80:83]
v_cvt_pk_bf16_f32 v140,v24,v25
v_exp_f32 v28,v28
M v[80:83],a[12:15],a[180:183],v[80:83]
v_exp_f32 v29,v29
v_accvgpr_write_b32 a228,0
M v[84:87],a[28:31],a[180:183],v[196:199]
v_cvt_pk_bf16_f32 v141,v26,v27
v_exp_f32 v30,v30
M v[84:87],a[24:27],a[164:167],v[84:87]
v_exp_f32 v31,v31
v_accvgpr_write_b32 a229,0
M v[84:87],a[20:23],a[148:151],v[84:87]
v_cvt_pk_bf16_f32 v142,v28,v29
v_exp_f32 v32,v32
M v[84:87],a[16:19],a[132:135],v[84:87]
v_exp_f32 v33,v33
v_cvt_pk_bf16_f32 v143,v30,v31
M v[88:91],a[32:35],a[132:135],v[196:199]
v_accvgpr_write_b32 a230,0
v_exp_f32 v34,v34
M v[88:91],a[36:39],a[148:151],v[88:91]
v_exp_f32 v35,v35
M v[88:91],a[40:43],a[164:167],v[88:91]
v_cvt_pk_bf16_f32 v144,v32,v33
v_exp_f32 v36,v36
M v[88:91],a[44:47],a[180:183],v[88:91]
v_accvgpr_write_b32 a231,0
v_exp_f32 v37,v37
M v[92:95],a[60:63],a[180:183],v[196:199]
v_cvt_pk_bf16_f32 v145,v34,v35
v_exp_f32 v38,v38
M v[92:95],a[56:59],a[164:167],v[92:95]
v_exp_f32 v39,v39
v_accvgpr_write_b32 a232,0
M v[92:95],a[52:55],a[148:151],v[92:95]
v_cvt_pk_bf16_f32 v146,v36,v37
v_exp_f32 v40,v40
M v[92:95],a[48:51],a[132:135],v[92:95]
v_exp_f32 v41,v41
v_accvgpr_write_b32 a233,0
M v[96:99],a[0:3],a[136:139],v[200:203]
v_cvt_pk_bf16_f32 v147,v38,v39
v_exp_f32 v42,v42
M v[96:99],a[4:7],a[152:155],v[96:99]
v_exp_f32 v43,v43
v_cvt_pk_bf16_f32 v148,v40,v41
M v[96:99],a[8:11],a[168:171],v[96:99]
v_accvgpr_write_b32 a234,0
v_exp_f32 v44,v44
M v[96:99],a[12:15],a[184:187],v[96:99]
v_exp_f32 v45,v45
v_cvt_pk_bf16_f32 v149,v42,v43
M v[100:103],a[28:31],a[184:187],v[200:203]
v_exp_f32 v46,v46
v_accvgpr_write_b32 a235,0
M v[100:103],a[24:27],a[168:171],v[100:103]
v_exp_f32 v47,v47
v_cvt_pk_bf16_f32 v150,v44,v45
M v[100:103],a[20:23],a[152:155],v[100:103]
v_exp_f32 v48,v48
v_accvgpr_write_b32 a236,0
M v[100:103],a[16:19],a[136:139],v[100:103]
v_exp_f32 v49,v49
v_cvt_pk_bf16_f32 v151,v46,v47
M v[104:107],a[32:35],a[136:139],v[200:203]
v_exp_f32 v50,v50
M v[104:107],a[36:39],a[152:155],v[104:107]
v_exp_f32 v51,v51
v_accvgpr_write_b32 a237,0
M v[104:107],a[40:43],a[168:171],v[104:107]
v_cvt_pk_bf16_f32 v152,v48,v49
v_exp_f32 v52,v52
M v[104:107],a[44:47],a[184:187],v[104:107]
v_exp_f32 v53,v53
s_waitcnt vmcnt(8)
M v[108:111],a[60:63],a[184:187],v[200:203]
s_barrier
v_cvt_pk_bf16_f32 v153,v50,v51
v_accvgpr_write_b32 a238,0
M v[108:111],a[56:59],a[168:171],v[108:111]
buffer_store_dword v176,off,s[36:39],s83 sc1
v_exp_f32 v54,v54
M v[108:111],a[52:55],a[152:155],v[108:111]
ds_read_b128 a[192:195],v224 offset:16384
s_add_u32 m0,s48,49152
M v[108:111],a[48:51],a[136:139],v[108:111]
buffer_load_dwordx4 v236,s[12:15],s43 offen offset:0 nt lds
M v[112:115],a[0:3],a[140:143],v[204:207]
ds_read_b128 a[196:199],v225 offset:16384
v_exp_f32 v55,v55
M v[112:115],a[4:7],a[156:159],v[112:115]
buffer_load_dwordx4 v237,s[12:15],s43 offen offset:1024 nt lds
v_cvt_pk_bf16_f32 v154,v52,v53
M v[112:115],a[8:11],a[172:175],v[112:115]
ds_read_b128 a[200:203],v226 offset:16384
v_exp_f32 v56,v56
M v[112:115],a[12:15],a[188:191],v[112:115]
buffer_load_dwordx4 v238,s[12:15],s43 offen offset:2048 nt lds
v_accvgpr_write_b32 a239,0
M v[116:119],a[28:31],a[188:191],v[204:207]
ds_read_b128 a[204:207],v227 offset:16384
v_exp_f32 v57,v57
M v[116:119],a[24:27],a[172:175],v[116:119]
buffer_load_dwordx4 v239,s[12:15],s43 offen offset:3072 nt lds
v_cvt_pk_bf16_f32 v155,v54,v55
M v[116:119],a[20:23],a[156:159],v[116:119]
ds_read_b64_tr_b16 a[208:209],v228 offset:16384
s_add_u32 s43,s43,16384
s_add_u32 m0,s48,114688
M v[116:119],a[16:19],a[140:143],v[116:119]
buffer_load_dwordx4 v240,s[16:19],s44 offen offset:0 nt lds
v_exp_f32 v58,v58
M v[120:123],a[32:35],a[140:143],v[204:207]
ds_read_b64_tr_b16 a[210:211],v228 offset:20480
v_exp_f32 v59,v59
M v[120:123],a[36:39],a[156:159],v[120:123]
buffer_load_dwordx4 v241,s[16:19],s44 offen offset:1024 nt lds
v_cvt_pk_bf16_f32 v156,v56,v57
M v[120:123],a[40:43],a[172:175],v[120:123]
ds_read_b64_tr_b16 a[212:213],v228 offset:24576
v_exp_f32 v60,v60
M v[120:123],a[44:47],a[188:191],v[120:123]
buffer_load_dwordx4 v240,s[16:19],s44 offen offset:2048 nt lds
M v[124:127],a[60:63],a[188:191],v[204:207]
ds_read_b64_tr_b16 a[214:215],v228 offset:28672
v_exp_f32 v61,v61
M v[124:127],a[56:59],a[172:175],v[124:127]
buffer_load_dwordx4 v241,s[16:19],s44 offen offset:3072 nt lds
v_cvt_pk_bf16_f32 v157,v58,v59
M v[124:127],a[52:55],a[156:159],v[124:127]
v_exp_f32 v62,v62
s_add_u32 s44,s44,16384
M v[124:127],a[48:51],a[140:143],v[124:127]
v_exp_f32 v63,v63
v_cvt_pk_bf16_f32 v158,v60,v61
v_cvt_pk_bf16_f32 v159,v62,v63
s_waitcnt lgkmcnt(4)
M v[0:3],a[192:195],a[128:131],v[192:195]
ds_read_b64_tr_b16 a[216:217],v229 offset:16384
v_mov_b32 v220,-1
M v[0:3],a[196:199],a[144:147],v[0:3]
v_exp_f32 v64,v64
M v[0:3],a[200:203],a[160:163],v[0:3]
ds_read_b64_tr_b16 a[218:219],v229 offset:20480
v_exp_f32 v65,v65
M v[0:3],a[204:207],a[176:179],v[0:3]
v_exp_f32 v66,v66
M v[16:19],a[204:207],a[180:183],v[196:199]
ds_read_b64_tr_b16 a[220:221],v229 offset:24576
v_exp_f32 v67,v67
M v[16:19],a[200:203],a[164:167],v[16:19]
v_cvt_pk_bf16_f32 v160,v64,v65
M v[16:19],a[196:199],a[148:151],v[16:19]
ds_read_b64_tr_b16 a[222:223],v229 offset:28672
s_add_u32 m0,s48,0
M v[16:19],a[192:195],a[132:135],v[16:19]
v_exp_f32 v68,v68
v_mov_b32 v221,-1
M v[32:35],a[192:195],a[136:139],v[200:203]
buffer_load_dwordx4 v236,s[12:15],s43 offen offset:0 nt lds
M v[32:35],a[196:199],a[152:155],v[32:35]
v_exp_f32 v69,v69
M v[32:35],a[200:203],a[168:171],v[32:35]
buffer_load_dwordx4 v237,s[12:15],s43 offen offset:1024 nt lds
v_cvt_pk_bf16_f32 v161,v66,v67
M v[32:35],a[204:207],a[184:187],v[32:35]
v_exp_f32 v70,v70
M v[48:51],a[204:207],a[188:191],v[204:207]
buffer_load_dwordx4 v238,s[12:15],s43 offen offset:2048 nt lds
M v[48:51],a[200:203],a[172:175],v[48:51]
v_exp_f32 v71,v71
M v[48:51],a[196:199],a[156:159],v[48:51]
buffer_load_dwordx4 v239,s[12:15],s43 offen offset:3072 nt lds
M v[48:51],a[192:195],a[140:143],v[48:51]
s_add_u32 s43,s43,16384
s_waitcnt lgkmcnt(0)
MS a[224:227],v[208:211],v[128:135],v255
ds_read_b128 a[192:195],v224 offset:20480
v_cvt_pk_bf16_f32 v162,v68,v69
M a[0:3],a[208:211],v[128:131],0
v_exp_f32 v72,v72
M a[0:3],a[212:215],v[132:135],a[0:3]
ds_read_b128 a[196:199],v225 offset:20480
v_mov_b32 v222,-1
M a[4:7],a[212:215],v[140:143],0
v_exp_f32 v73,v73
v_cvt_pk_bf16_f32 v163,v70,v71
M a[4:7],a[208:211],v[136:139],a[4:7]
ds_read_b128 a[200:203],v226 offset:20480
v_exp_f32 v74,v74
M a[8:11],a[208:211],v[144:147],0
v_exp_f32 v75,v75
M a[8:11],a[212:215],v[148:151],a[8:11]
ds_read_b128 a[204:207],v227 offset:20480
v_cvt_pk_bf16_f32 v164,v72,v73
M a[12:15],a[212:215],v[156:159],0
v_exp_f32 v76,v76
v_mov_b32 v223,-1
M a[12:15],a[208:211],v[152:155],a[12:15]
v_exp_f32 v77,v77
M a[28:31],a[216:219],v[152:155],0
ds_read_b64_tr_b16 a[208:209],v230 offset:16384
v_cvt_pk_bf16_f32 v165,v74,v75
M a[28:31],a[220:223],v[156:159],a[28:31]
v_exp_f32 v78,v78
M a[24:27],a[220:223],v[148:151],0
ds_read_b64_tr_b16 a[210:211],v230 offset:20480
M a[24:27],a[216:219],v[144:147],a[24:27]
v_exp_f32 v79,v79
M a[20:23],a[216:219],v[136:139],0
ds_read_b64_tr_b16 a[212:213],v230 offset:24576
v_cvt_pk_bf16_f32 v166,v76,v77
M a[20:23],a[220:223],v[140:143],a[20:23]
v_exp_f32 v80,v80
M a[16:19],a[220:223],v[132:135],0
ds_read_b64_tr_b16 a[214:215],v230 offset:28672
v_mov_b32 v218,0
M a[16:19],a[216:219],v[128:131],a[16:19]
v_exp_f32 v81,v81
s_waitcnt lgkmcnt(4)
M v[4:7],a[192:195],a[128:131],v[192:195]
ds_read_b64_tr_b16 a[216:217],v231 offset:16384
v_cvt_pk_bf16_f32 v167,v78,v79
M v[4:7],a[196:199],a[144:147],v[4:7]
v_exp_f32 v82,v82
M v[4:7],a[200:203],a[160:163],v[4:7]
ds_read_b64_tr_b16 a[218:219],v231 offset:20480
M v[4:7],a[204:207],a[176:179],v[4:7]
v_exp_f32 v83,v83
M v[20:23],a[204:207],a[180:183],v[196:199]
ds_read_b64_tr_b16 a[220:221],v231 offset:24576
v_cvt_pk_bf16_f32 v168,v80,v81
M v[20:23],a[200:203],a[164:167],v[20:23]
v_exp_f32 v84,v84
v_min_u32 v219,39,v242
M v[20:23],a[196:199],a[148:151],v[20:23]
ds_read_b64_tr_b16 a[222:223],v231 offset:28672
s_add_u32 m0,s48,65536
M v[20:23],a[192:195],a[132:135],v[20:23]
v_exp_f32 v85,v85
M v[36:39],a[192:195],a[136:139],v[200:203]
buffer_load_dwordx4 v240,s[16:19],s44 offen offset:0 nt lds
M v[36:39],a[196:199],a[152:155],v[36:39]
v_cvt_pk_bf16_f32 v169,v82,v83
M v[36:39],a[200:203],a[168:171],v[36:39]
buffer_load_dwordx4 v241,s[16:19],s44 offen offset:1024 nt lds
M v[36:39],a[204:207],a[184:187],v[36:39]
v_exp_f32 v86,v86
M v[52:55],a[204:207],a[188:191],v[204:207]
buffer_load_dwordx4 v240,s[16:19],s44 offen offset:2048 nt lds
M v[52:55],a[200:203],a[172:175],v[52:55]
v_exp_f32 v87,v87
M v[52:55],a[196:199],a[156:159],v[52:55]
buffer_load_dwordx4 v241,s[16:19],s44 offen offset:3072 nt lds
M v[52:55],a[192:195],a[140:143],v[52:55]
s_add_u32 s44,s44,16384
s_waitcnt lgkmcnt(0)
MS a[228:231],v[208:211],v[136:143],v255
ds_read_b128 a[192:195],v224 offset:24576
v_cvt_pk_bf16_f32 v170,v84,v85
M a[32:35],a[208:211],v[128:131],0
v_exp_f32 v88,v88
M a[32:35],a[212:215],v[132:135],a[32:35]
ds_read_b128 a[196:199],v225 offset:24576
v_lshlrev_b32 v219,4,v219
M a[36:39],a[212:215],v[140:143],0
v_exp_f32 v89,v89
M a[36:39],a[208:211],v[136:139],a[36:39]
ds_read_b128 a[200:203],v226 offset:24576
v_cvt_pk_bf16_f32 v171,v86,v87
M a[40:43],a[208:211],v[144:147],0
v_exp_f32 v90,v90
M a[40:43],a[212:215],v[148:151],a[40:43]
ds_read_b128 a[204:207],v227 offset:24576
v_exp_f32 v91,v91
M a[44:47],a[212:215],v[156:159],0
v_add_u32 v244,0,v242
v_cvt_pk_bf16_f32 v172,v88,v89
M a[44:47],a[208:211],v[152:155],a[44:47]
v_exp_f32 v92,v92
M a[60:63],a[216:219],v[152:155],0
ds_read_b64_tr_b16 a[208:209],v232 offset:16384
v_mul_u32_u24 v245,6554,v244
M a[60:63],a[220:223],v[156:159],a[60:63]
buffer_store_dwordx4 v[220:223],v219,s[32:35],s80 offen offset:0 sc1
v_lshrrev_b32 v245,16,v245
v_mul_u32_u24 v245,1120,v245
M a[56:59],a[220:223],v[148:151],0
ds_read_b64_tr_b16 a[210:211],v232 offset:20480
v_exp_f32 v93,v93
M a[56:59],a[216:219],v[144:147],a[56:59]
v_lshl_add_u32 v244,v244,4,v245
v_cvt_pk_bf16_f32 v173,v90,v91
M a[52:55],a[216:219],v[136:139],0
ds_read_b64_tr_b16 a[212:213],v232 offset:24576
v_exp_f32 v94,v94
M a[52:55],a[220:223],v[140:143],a[52:55]
s_add_u32 m0,s52,0
s_nop 0
buffer_load_dwordx4 v244,s[24:27],s53 offen nt lds
M a[48:51],a[220:223],v[132:135],0
ds_read_b64_tr_b16 a[214:215],v232 offset:28672
v_exp_f32 v95,v95
M a[48:51],a[216:219],v[128:131],a[48:51]
v_cvt_pk_bf16_f32 v174,v92,v93
s_waitcnt lgkmcnt(4)
M v[8:11],a[192:195],a[128:131],v[192:195]
ds_read_b64_tr_b16 a[216:217],v233 offset:16384
v_exp_f32 v96,v96
M v[8:11],a[196:199],a[144:147],v[8:11]
v_exp_f32 v97,v97
M v[8:11],a[200:203],a[160:163],v[8:11]
ds_read_b64_tr_b16 a[218:219],v233 offset:20480
v_cvt_pk_bf16_f32 v175,v94,v95
M v[8:11],a[204:207],a[176:179],v[8:11]
v_exp_f32 v98,v98
M v[24:27],a[204:207],a[180:183],v[196:199]
ds_read_b64_tr_b16 a[220:221],v233 offset:24576
v_add_u32 v244,64,v242
M v[24:27],a[200:203],a[164:167],v[24:27]
v_exp_f32 v99,v99
M v[24:27],a[196:199],a[148:151],v[24:27]
ds_read_b64_tr_b16 a[222:223],v233 offset:28672
v_mul_u32_u24 v245,6554,v244
M v[24:27],a[192:195],a[132:135],v[24:27]
v_cvt_pk_bf16_f32 v176,v96,v97
v_lshrrev_b32 v245,16,v245
M v[40:43],a[192:195],a[136:139],v[200:203]
v_exp_f32 v100,v100
M v[40:43],a[196:199],a[152:155],v[40:43]
v_exp_f32 v101,v101
v_mul_u32_u24 v245,1120,v245
M v[40:43],a[200:203],a[168:171],v[40:43]
v_cvt_pk_bf16_f32 v177,v98,v99
v_lshl_add_u32 v244,v244,4,v245
M v[40:43],a[204:207],a[184:187],v[40:43]
v_exp_f32 v102,v102
M v[56:59],a[204:207],a[188:191],v[204:207]
s_add_u32 m0,s52,1024
s_nop 0
buffer_load_dwordx4 v244,s[24:27],s53 offen nt lds
M v[56:59],a[200:203],a[172:175],v[56:59]
v_exp_f32 v103,v103
v_cvt_pk_bf16_f32 v178,v100,v101
M v[56:59],a[196:199],a[156:159],v[56:59]
v_exp_f32 v104,v104
M v[56:59],a[192:195],a[140:143],v[56:59]
buffer_store_dword v218,off,s[32:35],s82 sc1
s_waitcnt lgkmcnt(0)
MS a[232:235],v[208:211],v[144:151],v255
ds_read_b128 a[192:195],v224 offset:28672
M a[64:67],a[208:211],v[128:131],0
v_exp_f32 v105,v105
v_add_u32 v244,128,v242
M a[64:67],a[212:215],v[132:135],a[64:67]
ds_read_b128 a[196:199],v225 offset:28672
v_cvt_pk_bf16_f32 v179,v102,v103
M a[68:71],a[212:215],v[140:143],0
v_exp_f32 v106,v106
M a[68:71],a[208:211],v[136:139],a[68:71]
ds_read_b128 a[200:203],v226 offset:28672
v_mul_u32_u24 v245,6554,v244
M a[72:75],a[208:211],v[144:147],0
v_exp_f32 v107,v107
M a[72:75],a[212:215],v[148:151],a[72:75]
ds_read_b128 a[204:207],v227 offset:28672
v_lshrrev_b32 v245,16,v245
M a[76:79],a[212:215],v[156:159],0
v_cvt_pk_bf16_f32 v180,v104,v105
v_mul_u32_u24 v245,1120,v245
M a[76:79],a[208:211],v[152:155],a[76:79]
v_exp_f32 v108,v108
M a[92:95],a[216:219],v[152:155],0
ds_read_b64_tr_b16 a[208:209],v234 offset:16384
v_lshl_add_u32 v244,v244,4,v245
M a[92:95],a[220:223],v[156:159],a[92:95]
v_exp_f32 v109,v109
M a[88:91],a[220:223],v[148:151],0
ds_read_b64_tr_b16 a[210:211],v234 offset:20480
v_cvt_pk_bf16_f32 v181,v106,v107
M a[88:91],a[216:219],v[144:147],a[88:91]
s_add_u32 m0,s52,2048
s_nop 0
buffer_load_dwordx4 v244,s[24:27],s53 offen nt lds
M a[84:87],a[216:219],v[136:139],0
ds_read_b64_tr_b16 a[212:213],v234 offset:24576
v_exp_f32 v110,v110
M a[84:87],a[220:223],v[140:143],a[84:87]
v_exp_f32 v111,v111
M a[80:83],a[220:223],v[132:135],0
ds_read_b64_tr_b16 a[214:215],v234 offset:28672
v_cvt_pk_bf16_f32 v182,v108,v109
M a[80:83],a[216:219],v[128:131],a[80:83]
v_exp_f32 v112,v112
s_waitcnt lgkmcnt(4)
M v[12:15],a[192:195],a[128:131],v[192:195]
ds_read_b64_tr_b16 a[216:217],v235 offset:16384
M v[12:15],a[196:199],a[144:147],v[12:15]
v_exp_f32 v113,v113
v_add_u32 v244,192,v242
M v[12:15],a[200:203],a[160:163],v[12:15]
ds_read_b64_tr_b16 a[218:219],v235 offset:20480
v_cvt_pk_bf16_f32 v183,v110,v111
M v[12:15],a[204:207],a[176:179],v[12:15]
v_exp_f32 v114,v114
M v[28:31],a[204:207],a[180:183],v[196:199]
ds_read_b64_tr_b16 a[220:221],v235 offset:24576
v_mul_u32_u24 v245,6554,v244
M v[28:31],a[200:203],a[164:167],v[28:31]
v_exp_f32 v115,v115
M v[28:31],a[196:199],a[148:151],v[28:31]
ds_read_b64_tr_b16 a[222:223],v235 offset:28672
v_lshrrev_b32 v245,16,v245
M v[28:31],a[192:195],a[132:135],v[28:31]
v_cvt_pk_bf16_f32 v184,v112,v113
v_mul_u32_u24 v245,1120,v245
M v[44:47],a[192:195],a[136:139],v[200:203]
v_exp_f32 v116,v116
M v[44:47],a[196:199],a[152:155],v[44:47]
buffer_store_dwordx4 v[220:223],off,s[32:35],s45 offset:0 sc1
v_lshl_add_u32 v244,v244,4,v245
M v[44:47],a[200:203],a[168:171],v[44:47]
s_add_u32 m0,s52,3072
s_nop 0
buffer_load_dwordx4 v244,s[24:27],s53 offen nt lds
M v[44:47],a[204:207],a[184:187],v[44:47]
v_exp_f32 v117,v117
M v[60:63],a[204:207],a[188:191],v[204:207]
v_cvt_pk_bf16_f32 v185,v114,v115
M v[60:63],a[200:203],a[172:175],v[60:63]
v_exp_f32 v118,v118
M v[60:63],a[196:199],a[156:159],v[60:63]
v_exp_f32 v119,v119
M v[60:63],a[192:195],a[140:143],v[60:63]
v_cvt_pk_bf16_f32 v186,v116,v117
s_waitcnt vmcnt(23) lgkmcnt(0)
MS a[236:239],v[208:211],v[152:159],v255
s_barrier
v_exp_f32 v120,v120
M a[96:99],a[208:211],v[128:131],0
ds_read_b128 a[192:195],v224 offset:32768
v_add_u32 v244,256,v242
M a[96:99],a[212:215],v[132:135],a[96:99]
v_exp_f32 v121,v121
M a[100:103],a[212:215],v[140:143],0
ds_read_b128 a[196:199],v225 offset:32768
v_mul_u32_u24 v245,6554,v244
v_cvt_pk_bf16_f32 v187,v118,v119
M a[100:103],a[208:211],v[136:139],a[100:103]
v_exp_f32 v122,v122
M a[104:107],a[208:211],v[144:147],0
ds_read_b128 a[200:203],v226 offset:32768
v_lshrrev_b32 v245,16,v245
M a[104:107],a[212:215],v[148:151],a[104:107]
v_exp_f32 v123,v123
M a[108:111],a[212:215],v[156:159],0
ds_read_b128 a[204:207],v227 offset:32768
v_mul_u32_u24 v245,1120,v245
M a[108:111],a[208:211],v[152:155],a[108:111]
v_cvt_pk_bf16_f32 v188,v120,v121
v_lshl_add_u32 v244,v244,4,v245
M a[124:127],a[216:219],v[152:155],0
ds_read_b64_tr_b16 a[208:209],v228 offset:32768
v_exp_f32 v124,v124
M a[124:127],a[220:223],v[156:159],a[124:127]
s_add_u32 m0,s52,4096
s_nop 0
buffer_load_dwordx4 v244,s[24:27],s53 offen nt lds
M a[120:123],a[220:223],v[148:151],0
ds_read_b64_tr_b16 a[210:211],v228 offset:36864
M a[120:123],a[216:219],v[144:147],a[120:123]
v_exp_f32 v125,v125
M a[116:119],a[216:219],v[136:139],0
ds_read_b64_tr_b16 a[212:213],v228 offset:40960
v_cvt_pk_bf16_f32 v189,v122,v123
M a[116:119],a[220:223],v[140:143],a[116:119]
v_exp_f32 v126,v126
M a[112:115],a[220:223],v[132:135],0
ds_read_b64_tr_b16 a[214:215],v228 offset:45056
v_exp_f32 v127,v127
M a[112:115],a[216:219],v[128:131],a[112:115]
v_cvt_pk_bf16_f32 v190,v124,v125
v_cvt_pk_bf16_f32 v191,v126,v127
s_waitcnt lgkmcnt(4)
M v[64:67],a[192:195],a[128:131],v[192:195]
ds_read_b64_tr_b16 a[216:217],v229 offset:32768
v_lshlrev_b32 v219,4,v242
M v[64:67],a[196:199],a[144:147],v[64:67]
v_exp_f32 v0,v0
M v[64:67],a[200:203],a[160:163],v[64:67]
ds_read_b64_tr_b16 a[218:219],v229 offset:36864
M v[64:67],a[204:207],a[176:179],v[64:67]
v_exp_f32 v1,v1
M v[80:83],a[204:207],a[180:183],v[196:199]
ds_read_b64_tr_b16 a[220:221],v229 offset:40960
M v[80:83],a[200:203],a[164:167],v[80:83]
v_exp_f32 v2,v2
M v[80:83],a[196:199],a[148:151],v[80:83]
ds_read_b64_tr_b16 a[222:223],v229 offset:45056
s_add_u32 m0,s48,16384
M v[80:83],a[192:195],a[132:135],v[80:83]
v_exp_f32 v3,v3
M v[96:99],a[192:195],a[136:139],v[200:203]
buffer_load_dwordx4 v236,s[12:15],s43 offen offset:0 nt lds
M v[96:99],a[196:199],a[152:155],v[96:99]
v_cvt_pk_bf16_f32 v128,v0,v1
M v[96:99],a[200:203],a[168:171],v[96:99]
buffer_load_dwordx4 v237,s[12:15],s43 offen offset:1024 nt lds
M v[96:99],a[204:207],a[184:187],v[96:99]
v_exp_f32 v4,v4
M v[112:115],a[204:207],a[188:191],v[204:207]
buffer_load_dwordx4 v238,s[12:15],s43 offen offset:2048 nt lds
M v[112:115],a[200:203],a[172:175],v[112:115]
s_lshl_b32 s50,s2,2
s_add_u32 s50,s50,s40
s_mul_i32 s50,s50,5120
s_add_u32 s47,s50,28311552
M v[112:115],a[196:199],a[156:159],v[112:115]
buffer_load_dwordx4 v239,s[12:15],s43 offen offset:3072 nt lds
M v[112:115],a[192:195],a[140:143],v[112:115]
s_add_u32 s43,s43,16384
s_waitcnt lgkmcnt(0)
MS a[224:227],v[208:211],v[160:167],v255
ds_read_b128 a[192:195],v224 offset:36864
M a[0:3],a[208:211],v[160:163],a[0:3]
v_exp_f32 v5,v5
M a[0:3],a[212:215],v[164:167],a[0:3]
ds_read_b128 a[196:199],v225 offset:36864
v_cvt_pk_bf16_f32 v129,v2,v3
M a[4:7],a[212:215],v[172:175],a[4:7]
v_exp_f32 v6,v6
M a[4:7],a[208:211],v[168:171],a[4:7]
ds_read_b128 a[200:203],v226 offset:36864
M a[8:11],a[208:211],v[176:179],a[8:11]
v_exp_f32 v7,v7
M a[8:11],a[212:215],v[180:183],a[8:11]
ds_read_b128 a[204:207],v227 offset:36864
v_cvt_pk_bf16_f32 v130,v4,v5
M a[12:15],a[212:215],v[188:191],a[12:15]
v_exp_f32 v8,v8
M a[12:15],a[208:211],v[184:187],a[12:15]
v_exp_f32 v9,v9
M a[28:31],a[216:219],v[184:187],a[28:31]
ds_read_b64_tr_b16 a[208:209],v230 offset:32768
v_cvt_pk_bf16_f32 v131,v6,v7
M a[28:31],a[220:223],v[188:191],a[28:31]
v_exp_f32 v10,v10
M a[24:27],a[220:223],v[180:183],a[24:27]
ds_read_b64_tr_b16 a[210:211],v230 offset:36864
M a[24:27],a[216:219],v[176:179],a[24:27]
v_exp_f32 v11,v11
M a[20:23],a[216:219],v[168:171],a[20:23]
ds_read_b64_tr_b16 a[212:213],v230 offset:40960
v_cvt_pk_bf16_f32 v132,v8,v9
M a[20:23],a[220:223],v[172:175],a[20:23]
v_exp_f32 v12,v12
M a[16:19],a[220:223],v[164:167],a[16:19]
ds_read_b64_tr_b16 a[214:215],v230 offset:45056
v_exp_f32 v13,v13
M a[16:19],a[216:219],v[160:163],a[16:19]
v_cvt_pk_bf16_f32 v133,v10,v11
s_waitcnt lgkmcnt(4)
M v[68:71],a[192:195],a[128:131],v[192:195]
ds_read_b64_tr_b16 a[216:217],v231 offset:32768
M v[68:71],a[196:199],a[144:147],v[68:71]
v_exp_f32 v14,v14
M v[68:71],a[200:203],a[160:163],v[68:71]
ds_read_b64_tr_b16 a[218:219],v231 offset:36864
M v[68:71],a[204:207],a[176:179],v[68:71]
v_exp_f32 v15,v15
M v[84:87],a[204:207],a[180:183],v[196:199]
ds_read_b64_tr_b16 a[220:221],v231 offset:40960
v_cvt_pk_bf16_f32 v134,v12,v13
M v[84:87],a[200:203],a[164:167],v[84:87]
v_exp_f32 v16,v16
M v[84:87],a[196:199],a[148:151],v[84:87]
ds_read_b64_tr_b16 a[222:223],v231 offset:45056
s_add_u32 m0,s48,81920
M v[84:87],a[192:195],a[132:135],v[84:87]
v_exp_f32 v17,v17
M v[100:103],a[192:195],a[136:139],v[200:203]
buffer_load_dwordx4 v240,s[16:19],s44 offen offset:0 nt lds
M v[100:103],a[196:199],a[152:155],v[100:103]
v_cvt_pk_bf16_f32 v135,v14,v15
M v[100:103],a[200:203],a[168:171],v[100:103]
buffer_load_dwordx4 v241,s[16:19],s44 offen offset:1024 nt lds
M v[100:103],a[204:207],a[184:187],v[100:103]
v_exp_f32 v18,v18
M v[116:119],a[204:207],a[188:191],v[204:207]
buffer_load_dwordx4 v240,s[16:19],s44 offen offset:2048 nt lds
M v[116:119],a[200:203],a[172:175],v[116:119]
v_exp_f32 v19,v19
M v[116:119],a[196:199],a[156:159],v[116:119]
buffer_load_dwordx4 v241,s[16:19],s44 offen offset:3072 nt lds
M v[116:119],a[192:195],a[140:143],v[116:119]
s_add_u32 s44,s44,16384
s_waitcnt lgkmcnt(0)
MS a[228:231],v[208:211],v[168:175],v255
ds_read_b128 a[192:195],v224 offset:40960
v_cvt_pk_bf16_f32 v136,v16,v17
M a[32:35],a[208:211],v[160:163],a[32:35]
v_exp_f32 v20,v20
M a[32:35],a[212:215],v[164:167],a[32:35]
ds_read_b128 a[196:199],v225 offset:40960
M a[36:39],a[212:215],v[172:175],a[36:39]
v_exp_f32 v21,v21
M a[36:39],a[208:211],v[168:171],a[36:39]
ds_read_b128 a[200:203],v226 offset:40960
M a[40:43],a[208:211],v[176:179],a[40:43]
buffer_store_dwordx4 v[220:223],v219,s[32:35],s47 offen offset:0 sc1
M a[40:43],a[212:215],v[180:183],a[40:43]
ds_read_b128 a[204:207],v227 offset:40960
v_cvt_pk_bf16_f32 v137,v18,v19
M a[44:47],a[212:215],v[188:191],a[44:47]
v_exp_f32 v22,v22
M a[44:47],a[208:211],v[184:187],a[44:47]
v_exp_f32 v23,v23
M a[60:63],a[216:219],v[184:187],a[60:63]
ds_read_b64_tr_b16 a[208:209],v232 offset:32768
v_cvt_pk_bf16_f32 v138,v20,v21
M a[60:63],a[220:223],v[188:191],a[60:63]
v_exp_f32 v24,v24
M a[56:59],a[220:223],v[180:183],a[56:59]
ds_read_b64_tr_b16 a[210:211],v232 offset:36864
M a[56:59],a[216:219],v[176:179],a[56:59]
v_exp_f32 v25,v25
M a[52:55],a[216:219],v[168:171],a[52:55]
ds_read_b64_tr_b16 a[212:213],v232 offset:40960
v_cvt_pk_bf16_f32 v139,v22,v23
M a[52:55],a[220:223],v[172:175],a[52:55]
v_exp_f32 v26,v26
M a[48:51],a[220:223],v[164:167],a[48:51]
ds_read_b64_tr_b16 a[214:215],v232 offset:45056
v_exp_f32 v27,v27
M a[48:51],a[216:219],v[160:163],a[48:51]
v_cvt_pk_bf16_f32 v140,v24,v25
s_waitcnt lgkmcnt(4)
M v[72:75],a[192:195],a[128:131],v[192:195]
ds_read_b64_tr_b16 a[216:217],v233 offset:32768
v_exp_f32 v28,v28
M v[72:75],a[196:199],a[144:147],v[72:75]
v_exp_f32 v29,v29
M v[72:75],a[200:203],a[160:163],v[72:75]
ds_read_b64_tr_b16 a[218:219],v233 offset:36864
v_cvt_pk_bf16_f32 v141,v26,v27
M v[72:75],a[204:207],a[176:179],v[72:75]
v_exp_f32 v30,v30
M v[88:91],a[204:207],a[180:183],v[196:199]
ds_read_b64_tr_b16 a[220:221],v233 offset:40960
M v[88:91],a[200:203],a[164:167],v[88:91]
v_exp_f32 v31,v31
M v[88:91],a[196:199],a[148:151],v[88:91]
ds_read_b64_tr_b16 a[222:223],v233 offset:45056
v_cvt_pk_bf16_f32 v142,v28,v29
M v[88:91],a[192:195],a[132:135],v[88:91]
v_exp_f32 v32,v32
M v[104:107],a[192:195],a[136:139],v[200:203]
v_exp_f32 v33,v33
M v[104:107],a[196:199],a[152:155],v[104:107]
buffer_store_dwordx4 v[220:223],v219,s[32:35],s47 offen offset:1024 sc1
M v[104:107],a[200:203],a[168:171],v[104:107]
v_cvt_pk_bf16_f32 v143,v30,v31
M v[104:107],a[204:207],a[184:187],v[104:107]
v_exp_f32 v34,v34
M v[120:123],a[204:207],a[188:191],v[204:207]
v_exp_f32 v35,v35
M v[120:123],a[200:203],a[172:175],v[120:123]
v_cvt_pk_bf16_f32 v144,v32,v33
v_exp_f32 v36,v36
M v[120:123],a[196:199],a[156:159],v[120:123]
v_exp_f32 v37,v37
M v[120:123],a[192:195],a[140:143],v[120:123]
v_cvt_pk_bf16_f32 v145,v34,v35
s_waitcnt lgkmcnt(0)
MS a[232:235],v[208:211],v[176:183],v255
ds_read_b128 a[192:195],v224 offset:45056
v_exp_f32 v38,v38
M a[64:67],a[208:211],v[160:163],a[64:67]
v_exp_f32 v39,v39
M a[64:67],a[212:215],v[164:167],a[64:67]
ds_read_b128 a[196:199],v225 offset:45056
v_cvt_pk_bf16_f32 v146,v36,v37
M a[68:71],a[212:215],v[172:175],a[68:71]
v_exp_f32 v40,v40
M a[68:71],a[208:211],v[168:171],a[68:71]
ds_read_b128 a[200:203],v226 offset:45056
M a[72:75],a[208:211],v[176:179],a[72:75]
v_exp_f32 v41,v41
M a[72:75],a[212:215],v[180:183],a[72:75]
ds_read_b128 a[204:207],v227 offset:45056
v_cvt_pk_bf16_f32 v147,v38,v39
M a[76:79],a[212:215],v[188:191],a[76:79]
v_exp_f32 v42,v42
M a[76:79],a[208:211],v[184:187],a[76:79]
v_exp_f32 v43,v43
M a[92:95],a[216:219],v[184:187],a[92:95]
ds_read_b64_tr_b16 a[208:209],v234 offset:32768
v_cvt_pk_bf16_f32 v148,v40,v41
M a[92:95],a[220:223],v[188:191],a[92:95]
v_exp_f32 v44,v44
M a[88:91],a[220:223],v[180:183],a[88:91]
ds_read_b64_tr_b16 a[210:211],v234 offset:36864
M a[88:91],a[216:219],v[176:179],a[88:91]
v_exp_f32 v45,v45
M a[84:87],a[216:219],v[168:171],a[84:87]
ds_read_b64_tr_b16 a[212:213],v234 offset:40960
v_cvt_pk_bf16_f32 v149,v42,v43
M a[84:87],a[220:223],v[172:175],a[84:87]
buffer_store_dwordx4 v[220:223],v219,s[32:35],s47 offen offset:2048 sc1
M a[80:83],a[220:223],v[164:167],a[80:83]
ds_read_b64_tr_b16 a[214:215],v234 offset:45056
M a[80:83],a[216:219],v[160:163],a[80:83]
s_waitcnt lgkmcnt(4)
M v[76:79],a[192:195],a[128:131],v[192:195]
ds_read_b64_tr_b16 a[216:217],v235 offset:32768
v_exp_f32 v46,v46
M v[76:79],a[196:199],a[144:147],v[76:79]
v_exp_f32 v47,v47
M v[76:79],a[200:203],a[160:163],v[76:79]
ds_read_b64_tr_b16 a[218:219],v235 offset:36864
v_cvt_pk_bf16_f32 v150,v44,v45
M v[76:79],a[204:207],a[176:179],v[76:79]
v_exp_f32 v48,v48
M v[92:95],a[204:207],a[180:183],v[196:199]
ds_read_b64_tr_b16 a[220:221],v235 offset:40960
M v[92:95],a[200:203],a[164:167],v[92:95]
v_exp_f32 v49,v49
M v[92:95],a[196:199],a[148:151],v[92:95]
ds_read_b64_tr_b16 a[222:223],v235 offset:45056
v_cvt_pk_bf16_f32 v151,v46,v47
M v[92:95],a[192:195],a[132:135],v[92:95]
v_exp_f32 v50,v50
M v[108:111],a[192:195],a[136:139],v[200:203]
v_exp_f32 v51,v51
M v[108:111],a[196:199],a[152:155],v[108:111]
v_cvt_pk_bf16_f32 v152,v48,v49
M v[108:111],a[200:203],a[168:171],v[108:111]
v_exp_f32 v52,v52
M v[108:111],a[204:207],a[184:187],v[108:111]
v_exp_f32 v53,v53
M v[124:127],a[204:207],a[188:191],v[204:207]
v_cvt_pk_bf16_f32 v153,v50,v51
M v[124:127],a[200:203],a[172:175],v[124:127]
v_exp_f32 v54,v54
M v[124:127],a[196:199],a[156:159],v[124:127]
v_exp_f32 v55,v55
M v[124:127],a[192:195],a[140:143],v[124:127]
v_cvt_pk_bf16_f32 v154,v52,v53
s_waitcnt vmcnt(27) lgkmcnt(0)
MS a[236:239],v[208:211],v[184:191],v255
s_barrier
v_exp_f32 v56,v56
M a[96:99],a[208:211],v[160:163],a[96:99]
ds_read_b128 a[192:195],v224 offset:49152
M a[96:99],a[212:215],v[164:167],a[96:99]
v_exp_f32 v57,v57
M a[100:103],a[212:215],v[172:175],a[100:103]
ds_read_b128 a[196:199],v225 offset:49152
v_cvt_pk_bf16_f32 v155,v54,v55
M a[100:103],a[208:211],v[168:171],a[100:103]
v_exp_f32 v58,v58
M a[104:107],a[208:211],v[176:179],a[104:107]
ds_read_b128 a[200:203],v226 offset:49152
M a[104:107],a[212:215],v[180:183],a[104:107]
buffer_store_dwordx4 v[220:223],v219,s[32:35],s47 offen offset:3072 sc1
M a[108:111],a[212:215],v[188:191],a[108:111]
ds_read_b128 a[204:207],v227 offset:49152
M a[108:111],a[208:211],v[184:187],a[108:111]
v_exp_f32 v59,v59
M a[124:127],a[216:219],v[184:187],a[124:127]
ds_read_b64_tr_b16 a[208:209],v228 offset:49152
v_cvt_pk_bf16_f32 v156,v56,v57
M a[124:127],a[220:223],v[188:191],a[124:127]
v_exp_f32 v60,v60
M a[120:123],a[220:223],v[180:183],a[120:123]
ds_read_b64_tr_b16 a[210:211],v228 offset:53248
M a[120:123],a[216:219],v[176:179],a[120:123]
v_exp_f32 v61,v61
M a[116:119],a[216:219],v[168:171],a[116:119]
ds_read_b64_tr_b16 a[212:213],v228 offset:57344
v_cvt_pk_bf16_f32 v157,v58,v59
M a[116:119],a[220:223],v[172:175],a[116:119]
v_exp_f32 v62,v62
M a[112:115],a[220:223],v[164:167],a[112:115]
ds_read_b64_tr_b16 a[214:215],v228 offset:61440
v_exp_f32 v63,v63
M a[112:115],a[216:219],v[160:163],a[112:115]
v_cvt_pk_bf16_f32 v158,v60,v61
v_cvt_pk_bf16_f32 v159,v62,v63
s_waitcnt lgkmcnt(4)
M v[0:3],a[192:195],a[128:131],v[192:195]
ds_read_b64_tr_b16 a[216:217],v229 offset:49152
v_exp_f32 v64,v64
M v[0:3],a[196:199],a[144:147],v[0:3]
v_exp_f32 v65,v65
M v[0:3],a[200:203],a[160:163],v[0:3]
ds_read_b64_tr_b16 a[218:219],v229 offset:53248
v_exp_f32 v66,v66
M v[0:3],a[204:207],a[176:179],v[0:3]
v_exp_f32 v67,v67
M v[16:19],a[204:207],a[180:183],v[196:199]
ds_read_b64_tr_b16 a[220:221],v229 offset:57344
v_cvt_pk_bf16_f32 v160,v64,v65
M v[16:19],a[200:203],a[164:167],v[16:19]
v_exp_f32 v68,v68
M v[16:19],a[196:199],a[148:151],v[16:19]
ds_read_b64_tr_b16 a[222:223],v229 offset:61440
s_add_u32 m0,s48,32768
M v[16:19],a[192:195],a[132:135],v[16:19]
v_exp_f32 v69,v69
M v[32:35],a[192:195],a[136:139],v[200:203]
buffer_load_dwordx4 v236,s[12:15],s43 offen offset:0 nt lds
M v[32:35],a[196:199],a[152:155],v[32:35]
v_cvt_pk_bf16_f32 v161,v66,v67
M v[32:35],a[200:203],a[168:171],v[32:35]
buffer_load_dwordx4 v237,s[12:15],s43 offen offset:1024 nt lds
M v[32:35],a[204:207],a[184:187],v[32:35]
v_exp_f32 v70,v70
M v[48:51],a[204:207],a[188:191],v[204:207]
buffer_load_dwordx4 v238,s[12:15],s43 offen offset:2048 nt lds
M v[48:51],a[200:203],a[172:175],v[48:51]
s_add_u32 s47,s47,4096
v_exp_f32 v71,v71
M v[48:51],a[196:199],a[156:159],v[48:51]
buffer_load_dwordx4 v239,s[12:15],s43 offen offset:3072 nt lds
M v[48:51],a[192:195],a[140:143],v[48:51]
s_add_u32 s43,s43,16384
s_waitcnt lgkmcnt(0)
MS a[224:227],v[208:211],v[128:135],v255
ds_read_b128 a[192:195],v224 offset:53248
v_cvt_pk_bf16_f32 v162,v68,v69
M a[0:3],a[208:211],v[128:131],a[0:3]
v_exp_f32 v72,v72
M a[0:3],a[212:215],v[132:135],a[0:3]
ds_read_b128 a[196:199],v225 offset:53248
M a[4:7],a[212:215],v[140:143],a[4:7]
v_exp_f32 v73,v73
M a[4:7],a[208:211],v[136:139],a[4:7]
ds_read_b128 a[200:203],v226 offset:53248
v_cvt_pk_bf16_f32 v163,v70,v71
M a[8:11],a[208:211],v[144:147],a[8:11]
buffer_store_dwordx4 v[220:223],v219,s[32:35],s47 offen offset:0 sc1
M a[8:11],a[212:215],v[148:151],a[8:11]
ds_read_b128 a[204:207],v227 offset:53248
M a[12:15],a[212:215],v[156:159],a[12:15]
v_exp_f32 v74,v74
M a[12:15],a[208:211],v[152:155],a[12:15]
v_exp_f32 v75,v75
M a[28:31],a[216:219],v[152:155],a[28:31]
ds_read_b64_tr_b16 a[208:209],v230 offset:49152
v_cvt_pk_bf16_f32 v164,v72,v73
M a[28:31],a[220:223],v[156:159],a[28:31]
v_exp_f32 v76,v76
M a[24:27],a[220:223],v[148:151],a[24:27]
ds_read_b64_tr_b16 a[210:211],v230 offset:53248
M a[24:27],a[216:219],v[144:147],a[24:27]
v_exp_f32 v77,v77
M a[20:23],a[216:219],v[136:139],a[20:23]
ds_read_b64_tr_b16 a[212:213],v230 offset:57344
v_cvt_pk_bf16_f32 v165,v74,v75
M a[20:23],a[220:223],v[140:143],a[20:23]
v_exp_f32 v78,v78
M a[16:19],a[220:223],v[132:135],a[16:19]
ds_read_b64_tr_b16 a[214:215],v230 offset:61440
v_exp_f32 v79,v79
M a[16:19],a[216:219],v[128:131],a[16:19]
v_cvt_pk_bf16_f32 v166,v76,v77
s_waitcnt lgkmcnt(4)
M v[4:7],a[192:195],a[128:131],v[192:195]
ds_read_b64_tr_b16 a[216:217],v231 offset:49152
v_exp_f32 v80,v80
M v[4:7],a[196:199],a[144:147],v[4:7]
v_exp_f32 v81,v81
M v[4:7],a[200:203],a[160:163],v[4:7]
ds_read_b64_tr_b16 a[218:219],v231 offset:53248
v_cvt_pk_bf16_f32 v167,v78,v79
M v[4:7],a[204:207],a[176:179],v[4:7]
v_exp_f32 v82,v82
M v[20:23],a[204:207],a[180:183],v[196:199]
ds_read_b64_tr_b16 a[220:221],v231 offset:57344
v_exp_f32 v83,v83
M v[20:23],a[200:203],a[164:167],v[20:23]
v_cvt_pk_bf16_f32 v168,v80,v81
M v[20:23],a[196:199],a[148:151],v[20:23]
ds_read_b64_tr_b16 a[222:223],v231 offset:61440
s_add_u32 m0,s48,98304
M v[20:23],a[192:195],a[132:135],v[20:23]
v_exp_f32 v84,v84
M v[36:39],a[192:195],a[136:139],v[200:203]
buffer_load_dwordx4 v240,s[16:19],s44 offen offset:0 nt lds
M v[36:39],a[196:199],a[152:155],v[36:39]
v_exp_f32 v85,v85
v_cvt_pk_bf16_f32 v169,v82,v83
M v[36:39],a[200:203],a[168:171],v[36:39]
buffer_load_dwordx4 v241,s[16:19],s44 offen offset:1024 nt lds
M v[36:39],a[204:207],a[184:187],v[36:39]
v_exp_f32 v86,v86
M v[52:55],a[204:207],a[188:191],v[204:207]
buffer_load_dwordx4 v240,s[16:19],s44 offen offset:2048 nt lds
M v[52:55],a[200:203],a[172:175],v[52:55]
v_exp_f32 v87,v87
M v[52:55],a[196:199],a[156:159],v[52:55]
buffer_load_dwordx4 v241,s[16:19],s44 offen offset:3072 nt lds
M v[52:55],a[192:195],a[140:143],v[52:55]
s_add_u32 s44,s44,16384
s_waitcnt lgkmcnt(0)
MS a[228:231],v[208:211],v[136:143],v255
ds_read_b128 a[192:195],v224 offset:57344
v_cvt_pk_bf16_f32 v170,v84,v85
M a[32:35],a[208:211],v[128:131],a[32:35]
v_exp_f32 v88,v88
M a[32:35],a[212:215],v[132:135],a[32:35]
ds_read_b128 a[196:199],v225 offset:57344
M a[36:39],a[212:215],v[140:143],a[36:39]
v_exp_f32 v89,v89
M a[36:39],a[208:211],v[136:139],a[36:39]
ds_read_b128 a[200:203],v226 offset:57344
v_cvt_pk_bf16_f32 v171,v86,v87
M a[40:43],a[208:211],v[144:147],a[40:43]
v_exp_f32 v90,v90
M a[40:43],a[212:215],v[148:151],a[40:43]
ds_read_b128 a[204:207],v227 offset:57344
v_and_b32 v214,31,v242
M a[44:47],a[212:215],v[156:159],a[44:47]
v_exp_f32 v91,v91
M a[44:47],a[208:211],v[152:155],a[44:47]
v_lshlrev_b32 v214,2,v214
v_cvt_pk_bf16_f32 v172,v88,v89
M a[60:63],a[216:219],v[152:155],a[60:63]
ds_read_b64_tr_b16 a[208:209],v232 offset:49152
v_exp_f32 v92,v92
M a[60:63],a[220:223],v[156:159],a[60:63]
buffer_load_dword v213,v214,s[36:39],0 offen
M a[56:59],a[220:223],v[148:151],a[56:59]
ds_read_b64_tr_b16 a[210:211],v232 offset:53248
M a[56:59],a[216:219],v[144:147],a[56:59]
v_exp_f32 v93,v93
M a[52:55],a[216:219],v[136:139],a[52:55]
ds_read_b64_tr_b16 a[212:213],v232 offset:57344
v_cvt_pk_bf16_f32 v173,v90,v91
M a[52:55],a[220:223],v[140:143],a[52:55]
v_exp_f32 v94,v94
M a[48:51],a[220:223],v[132:135],a[48:51]
ds_read_b64_tr_b16 a[214:215],v232 offset:61440
v_exp_f32 v95,v95
M a[48:51],a[216:219],v[128:131],a[48:51]
v_cvt_pk_bf16_f32 v174,v92,v93
s_waitcnt lgkmcnt(4)
M v[8:11],a[192:195],a[128:131],v[192:195]
ds_read_b64_tr_b16 a[216:217],v233 offset:49152
M v[8:11],a[196:199],a[144:147],v[8:11]
v_exp_f32 v96,v96
M v[8:11],a[200:203],a[160:163],v[8:11]
ds_read_b64_tr_b16 a[218:219],v233 offset:53248
v_lshrrev_b32 v212,2,v242
M v[8:11],a[204:207],a[176:179],v[8:11]
v_exp_f32 v97,v97
v_mul_u32_u24 v212,160,v212
M v[24:27],a[204:207],a[180:183],v[196:199]
ds_read_b64_tr_b16 a[220:221],v233 offset:57344
v_cvt_pk_bf16_f32 v175,v94,v95
M v[24:27],a[200:203],a[164:167],v[24:27]
v_exp_f32 v98,v98
M v[24:27],a[196:199],a[148:151],v[24:27]
ds_read_b64_tr_b16 a[222:223],v233 offset:61440
v_and_b32 v215,3,v242
M v[24:27],a[192:195],a[132:135],v[24:27]
v_exp_f32 v99,v99
M v[40:43],a[192:195],a[136:139],v[200:203]
v_cvt_pk_bf16_f32 v176,v96,v97
v_mul_u32_u24 v215,40,v215
M v[40:43],a[196:199],a[152:155],v[40:43]
v_exp_f32 v100,v100
M v[40:43],a[200:203],a[168:171],v[40:43]
v_exp_f32 v101,v101
M v[40:43],a[204:207],a[184:187],v[40:43]
v_add3_u32 v212,v212,v215,s52
v_cvt_pk_bf16_f32 v177,v98,v99
M v[56:59],a[204:207],a[188:191],v[204:207]
v_exp_f32 v102,v102
M v[56:59],a[200:203],a[172:175],v[56:59]
v_lshlrev_b32 v215,4,v242
M v[56:59],a[196:199],a[156:159],v[56:59]
v_exp_f32 v103,v103
M v[56:59],a[192:195],a[140:143],v[56:59]
s_waitcnt vmcnt(22)
s_waitcnt lgkmcnt(0)
MS a[232:235],v[208:211],v[144:151],v255
ds_read_b128 a[192:195],v224 offset:61440
v_cvt_pk_bf16_f32 v178,v100,v101
M a[64:67],a[208:211],v[128:131],a[64:67]
v_exp_f32 v104,v104
M a[64:67],a[212:215],v[132:135],a[64:67]
ds_read_b128 a[196:199],v225 offset:61440
s_nop 0
ds_read_b64_tr_b16 v[216:217],v212 offset:0
M a[68:71],a[212:215],v[140:143],a[68:71]
v_exp_f32 v105,v105
M a[68:71],a[208:211],v[136:139],a[68:71]
ds_read_b128 a[200:203],v226 offset:61440
v_cvt_pk_bf16_f32 v179,v102,v103
M a[72:75],a[208:211],v[144:147],a[72:75]
v_exp_f32 v106,v106
M a[72:75],a[212:215],v[148:151],a[72:75]
ds_read_b128 a[204:207],v227 offset:61440
v_exp_f32 v107,v107
M a[76:79],a[212:215],v[156:159],a[76:79]
ds_read_b64_tr_b16 v[218:219],v212 offset:2560
v_cvt_pk_bf16_f32 v180,v104,v105
M a[76:79],a[208:211],v[152:155],a[76:79]
v_exp_f32 v108,v108
M a[92:95],a[216:219],v[152:155],a[92:95]
ds_read_b64_tr_b16 a[208:209],v234 offset:49152
M a[92:95],a[220:223],v[156:159],a[92:95]
v_exp_f32 v109,v109
M a[88:91],a[220:223],v[148:151],a[88:91]
ds_read_b64_tr_b16 a[210:211],v234 offset:53248
M a[88:91],a[216:219],v[144:147],a[88:91]
ds_read_b64_tr_b16 v[220:221],v212 offset:8
v_cvt_pk_bf16_f32 v181,v106,v107
M a[84:87],a[216:219],v[136:139],a[84:87]
ds_read_b64_tr_b16 a[212:213],v234 offset:57344
v_exp_f32 v110,v110
M a[84:87],a[220:223],v[140:143],a[84:87]
v_exp_f32 v111,v111
M a[80:83],a[220:223],v[132:135],a[80:83]
ds_read_b64_tr_b16 a[214:215],v234 offset:61440
v_cvt_pk_bf16_f32 v182,v108,v109
M a[80:83],a[216:219],v[128:131],a[80:83]
ds_read_b64_tr_b16 v[222:223],v212 offset:2568
s_waitcnt lgkmcnt(7)
M v[12:15],a[192:195],a[128:131],v[192:195]
ds_read_b64_tr_b16 a[216:217],v235 offset:49152
v_exp_f32 v112,v112
M v[12:15],a[196:199],a[144:147],v[12:15]
v_exp_f32 v113,v113
M v[12:15],a[200:203],a[160:163],v[12:15]
ds_read_b64_tr_b16 a[218:219],v235 offset:53248
v_cvt_pk_bf16_f32 v183,v110,v111
M v[12:15],a[204:207],a[176:179],v[12:15]
v_exp_f32 v114,v114
M v[28:31],a[204:207],a[180:183],v[196:199]
ds_read_b64_tr_b16 a[220:221],v235 offset:57344
M v[28:31],a[200:203],a[164:167],v[28:31]
ds_read_b64_tr_b16 a[240:241],v212 offset:16
v_exp_f32 v115,v115
M v[28:31],a[196:199],a[148:151],v[28:31]
ds_read_b64_tr_b16 a[222:223],v235 offset:61440
v_cvt_pk_bf16_f32 v184,v112,v113
M v[28:31],a[192:195],a[132:135],v[28:31]
v_exp_f32 v116,v116
M v[44:47],a[192:195],a[136:139],v[200:203]
ds_read_b64_tr_b16 a[242:243],v212 offset:2576
M v[44:47],a[196:199],a[152:155],v[44:47]
v_exp_f32 v117,v117
M v[44:47],a[200:203],a[168:171],v[44:47]
v_cvt_pk_bf16_f32 v185,v114,v115
v_exp_f32 v118,v118
M v[44:47],a[204:207],a[184:187],v[44:47]
v_exp_f32 v119,v119
M v[60:63],a[204:207],a[188:191],v[204:207]
ds_read_b64_tr_b16 a[244:245],v212 offset:24
v_cvt_pk_bf16_f32 v186,v116,v117
M v[60:63],a[200:203],a[172:175],v[60:63]
v_exp_f32 v120,v120
M v[60:63],a[196:199],a[156:159],v[60:63]
v_exp_f32 v121,v121
M v[60:63],a[192:195],a[140:143],v[60:63]
ds_read_b64_tr_b16 a[246:247],v212 offset:2584
s_waitcnt lgkmcnt(3)
MS a[236:239],v[208:211],v[152:159],v255
s_barrier
M a[96:99],a[208:211],v[128:131],a[96:99]
ds_read_b128 a[192:195],v224 offset:0
v_cvt_pk_bf16_f32 v187,v118,v119
M a[96:99],a[212:215],v[132:135],a[96:99]
v_exp_f32 v122,v122
M a[100:103],a[212:215],v[140:143],a[100:103]
ds_read_b128 a[196:199],v225 offset:0
M a[100:103],a[208:211],v[136:139],a[100:103]
v_exp_f32 v123,v123
M a[104:107],a[208:211],v[144:147],a[104:107]
ds_read_b128 a[200:203],v226 offset:0
v_cvt_pk_bf16_f32 v188,v120,v121
M a[104:107],a[212:215],v[148:151],a[104:107]
ds_read_b64_tr_b16 a[248:249],v212 offset:32
M a[108:111],a[212:215],v[156:159],a[108:111]
ds_read_b128 a[204:207],v227 offset:0
M a[108:111],a[208:211],v[152:155],a[108:111]
v_exp_f32 v124,v124
M a[124:127],a[216:219],v[152:155],a[124:127]
ds_read_b64_tr_b16 a[208:209],v228 offset:0
M a[124:127],a[220:223],v[156:159],a[124:127]
v_exp_f32 v125,v125
M a[120:123],a[220:223],v[148:151],a[120:123]
ds_read_b64_tr_b16 a[210:211],v228 offset:4096
v_cvt_pk_bf16_f32 v189,v122,v123
M a[120:123],a[216:219],v[144:147],a[120:123]
v_exp_f32 v126,v126
M a[116:119],a[216:219],v[136:139],a[116:119]
ds_read_b64_tr_b16 a[212:213],v228 offset:8192
M a[116:119],a[220:223],v[140:143],a[116:119]
ds_read_b64_tr_b16 a[250:251],v212 offset:2592
M a[112:115],a[220:223],v[132:135],a[112:115]
ds_read_b64_tr_b16 a[214:215],v228 offset:12288
v_exp_f32 v127,v127
M a[112:115],a[216:219],v[128:131],a[112:115]
v_cvt_pk_bf16_f32 v190,v124,v125
v_cvt_pk_bf16_f32 v191,v126,v127
s_waitcnt lgkmcnt(5)
M v[64:67],a[192:195],a[128:131],v[192:195]
ds_read_b64_tr_b16 a[216:217],v229 offset:0
M v[64:67],a[196:199],a[144:147],v[64:67]
s_waitcnt lgkmcnt(2)
buffer_store_dwordx4 v[216:219],v215,s[32:35],s54 offen offset:0 sc1
M v[64:67],a[200:203],a[160:163],v[64:67]
ds_read_b64_tr_b16 a[218:219],v229 offset:4096
v_exp_f32 v0,v0
M v[64:67],a[204:207],a[176:179],v[64:67]
v_exp_f32 v1,v1
M v[80:83],a[204:207],a[180:183],v[196:199]
ds_read_b64_tr_b16 a[220:221],v229 offset:8192
v_exp_f32 v2,v2
M v[80:83],a[200:203],a[164:167],v[80:83]
v_exp_f32 v3,v3
M v[80:83],a[196:199],a[148:151],v[80:83]
ds_read_b64_tr_b16 a[222:223],v229 offset:12288
s_add_u32 m0,s48,49152
M v[80:83],a[192:195],a[132:135],v[80:83]
v_cvt_pk_bf16_f32 v128,v0,v1
v_exp_f32 v4,v4
M v[96:99],a[192:195],a[136:139],v[200:203]
buffer_load_dwordx4 v236,s[12:15],s43 offen offset:0 nt lds
M v[96:99],a[196:199],a[152:155],v[96:99]
v_exp_f32 v5,v5
M v[96:99],a[200:203],a[168:171],v[96:99]
buffer_load_dwordx4 v237,s[12:15],s43 offen offset:1024 nt lds
M v[96:99],a[204:207],a[184:187],v[96:99]
v_cvt_pk_bf16_f32 v129,v2,v3
v_exp_f32 v6,v6
M v[112:115],a[204:207],a[188:191],v[204:207]
buffer_load_dwordx4 v238,s[12:15],s43 offen offset:2048 nt lds
M v[112:115],a[200:203],a[172:175],v[112:115]
v_exp_f32 v7,v7
M v[112:115],a[196:199],a[156:159],v[112:115]
buffer_load_dwordx4 v239,s[12:15],s43 offen offset:3072 nt lds
M v[112:115],a[192:195],a[140:143],v[112:115]
s_add_u32 s43,s43,16384
s_waitcnt lgkmcnt(0)
MS a[224:227],v[208:211],v[160:167],v255
ds_read_b128 a[192:195],v224 offset:4096
v_cvt_pk_bf16_f32 v130,v4,v5
M a[0:3],a[208:211],v[160:163],a[0:3]
v_exp_f32 v8,v8
M a[0:3],a[212:215],v[164:167],a[0:3]
ds_read_b128 a[196:199],v225 offset:4096
M a[4:7],a[212:215],v[172:175],a[4:7]
v_exp_f32 v9,v9
M a[4:7],a[208:211],v[168:171],a[4:7]
ds_read_b128 a[200:203],v226 offset:4096
v_cvt_pk_bf16_f32 v131,v6,v7
M a[8:11],a[208:211],v[176:179],a[8:11]
v_exp_f32 v10,v10
M a[8:11],a[212:215],v[180:183],a[8:11]
ds_read_b128 a[204:207],v227 offset:4096
v_exp_f32 v11,v11
M a[12:15],a[212:215],v[188:191],a[12:15]
v_cvt_pk_bf16_f32 v132,v8,v9
v_exp_f32 v12,v12
M a[12:15],a[208:211],v[184:187],a[12:15]
v_exp_f32 v13,v13
M a[28:31],a[216:219],v[184:187],a[28:31]
ds_read_b64_tr_b16 a[208:209],v230 offset:0
v_cvt_pk_bf16_f32 v133,v10,v11
M a[28:31],a[220:223],v[188:191],a[28:31]
v_exp_f32 v14,v14
M a[24:27],a[220:223],v[180:183],a[24:27]
ds_read_b64_tr_b16 a[210:211],v230 offset:4096
M a[24:27],a[216:219],v[176:179],a[24:27]
v_exp_f32 v15,v15
M a[20:23],a[216:219],v[168:171],a[20:23]
ds_read_b64_tr_b16 a[212:213],v230 offset:8192
v_cvt_pk_bf16_f32 v134,v12,v13
M a[20:23],a[220:223],v[172:175],a[20:23]
v_exp_f32 v16,v16
M a[16:19],a[220:223],v[164:167],a[16:19]
ds_read_b64_tr_b16 a[214:215],v230 offset:12288
M a[16:19],a[216:219],v[160:163],a[16:19]
v_exp_f32 v17,v17
s_waitcnt lgkmcnt(4)
M v[68:71],a[192:195],a[128:131],v[192:195]
ds_read_b64_tr_b16 a[216:217],v231 offset:0
v_cvt_pk_bf16_f32 v135,v14,v15
M v[68:71],a[196:199],a[144:147],v[68:71]
v_exp_f32 v18,v18
M v[68:71],a[200:203],a[160:163],v[68:71]
ds_read_b64_tr_b16 a[218:219],v231 offset:4096
M v[68:71],a[204:207],a[176:179],v[68:71]
v_exp_f32 v19,v19
M v[84:87],a[204:207],a[180:183],v[196:199]
ds_read_b64_tr_b16 a[220:221],v231 offset:8192
v_cvt_pk_bf16_f32 v136,v16,v17
M v[84:87],a[200:203],a[164:167],v[84:87]
v_exp_f32 v20,v20
M v[84:87],a[196:199],a[148:151],v[84:87]
ds_read_b64_tr_b16 a[222:223],v231 offset:12288
s_add_u32 m0,s48,114688
M v[84:87],a[192:195],a[132:135],v[84:87]
v_exp_f32 v21,v21
M v[100:103],a[192:195],a[136:139],v[200:203]
buffer_load_dwordx4 v240,s[16:19],s44 offen offset:0 nt lds
M v[100:103],a[196:199],a[152:155],v[100:103]
v_cvt_pk_bf16_f32 v137,v18,v19
M v[100:103],a[200:203],a[168:171],v[100:103]
buffer_load_dwordx4 v241,s[16:19],s44 offen offset:1024 nt lds
M v[100:103],a[204:207],a[184:187],v[100:103]
v_exp_f32 v22,v22
M v[116:119],a[204:207],a[188:191],v[204:207]
buffer_load_dwordx4 v240,s[16:19],s44 offen offset:2048 nt lds
M v[116:119],a[200:203],a[172:175],v[116:119]
v_exp_f32 v23,v23
M v[116:119],a[196:199],a[156:159],v[116:119]
buffer_load_dwordx4 v241,s[16:19],s44 offen offset:3072 nt lds
M v[116:119],a[192:195],a[140:143],v[116:119]
s_add_u32 s44,s44,16384
s_waitcnt lgkmcnt(0)
MS a[228:231],v[208:211],v[168:175],v255
ds_read_b128 a[192:195],v224 offset:8192
v_cvt_pk_bf16_f32 v138,v20,v21
M a[32:35],a[208:211],v[160:163],a[32:35]
buffer_store_dwordx4 v[220:223],v215,s[32:35],s54 offen offset:1024 sc1
M a[32:35],a[212:215],v[164:167],a[32:35]
ds_read_b128 a[196:199],v225 offset:8192
v_exp_f32 v24,v24
M a[36:39],a[212:215],v[172:175],a[36:39]
v_exp_f32 v25,v25
M a[36:39],a[208:211],v[168:171],a[36:39]
ds_read_b128 a[200:203],v226 offset:8192
v_cvt_pk_bf16_f32 v139,v22,v23
M a[40:43],a[208:211],v[176:179],a[40:43]
v_exp_f32 v26,v26
M a[40:43],a[212:215],v[180:183],a[40:43]
ds_read_b128 a[204:207],v227 offset:8192
s_waitcnt vmcnt(10)
M a[44:47],a[212:215],v[188:191],a[44:47]
v_exp_f32 v27,v27
M a[44:47],a[208:211],v[184:187],a[44:47]
v_cmp_eq_u32 vcc,0,v213
s_cbranch_vccnz L_slow_key
L_ok_key:
M a[60:63],a[216:219],v[184:187],a[60:63]
ds_read_b64_tr_b16 a[208:209],v232 offset:0
v_cvt_pk_bf16_f32 v140,v24,v25
M a[60:63],a[220:223],v[188:191],a[60:63]
v_exp_f32 v28,v28
M a[56:59],a[220:223],v[180:183],a[56:59]
ds_read_b64_tr_b16 a[210:211],v232 offset:4096
v_exp_f32 v29,v29
M a[56:59],a[216:219],v[176:179],a[56:59]
v_cvt_pk_bf16_f32 v141,v26,v27
v_lshlrev_b32 v212,2,v242
M a[52:55],a[216:219],v[168:171],a[52:55]
ds_read_b64_tr_b16 a[212:213],v232 offset:8192
v_exp_f32 v30,v30
M a[52:55],a[220:223],v[172:175],a[52:55]
v_exp_f32 v31,v31
M a[48:51],a[220:223],v[164:167],a[48:51]
ds_read_b64_tr_b16 a[214:215],v232 offset:12288
s_nop 1
M a[48:51],a[216:219],v[160:163],a[48:51]
v_cvt_pk_bf16_f32 v142,v28,v29
s_waitcnt lgkmcnt(4)
M v[72:75],a[192:195],a[128:131],v[192:195]
ds_read_b64_tr_b16 a[216:217],v233 offset:0
M v[72:75],a[196:199],a[144:147],v[72:75]
v_exp_f32 v32,v32
M v[72:75],a[200:203],a[160:163],v[72:75]
ds_read_b64_tr_b16 a[218:219],v233 offset:4096
v_max_u32_dpp v213,v213,v213 row_ror:8 row_mask:0xf bank_mask:0xf
M v[72:75],a[204:207],a[176:179],v[72:75]
v_exp_f32 v33,v33
s_nop 1
M v[88:91],a[204:207],a[180:183],v[196:199]
ds_read_b64_tr_b16 a[220:221],v233 offset:8192
v_cvt_pk_bf16_f32 v143,v30,v31
M v[88:91],a[200:203],a[164:167],v[88:91]
v_exp_f32 v34,v34
M v[88:91],a[196:199],a[148:151],v[88:91]
ds_read_b64_tr_b16 a[222:223],v233 offset:12288
v_max_u32_dpp v213,v213,v213 row_ror:4 row_mask:0xf bank_mask:0xf
M v[88:91],a[192:195],a[132:135],v[88:91]
v_exp_f32 v35,v35
M v[104:107],a[192:195],a[136:139],v[200:203]
v_cvt_pk_bf16_f32 v144,v32,v33
s_nop 1
M v[104:107],a[196:199],a[152:155],v[104:107]
v_exp_f32 v36,v36
M v[104:107],a[200:203],a[168:171],v[104:107]
v_exp_f32 v37,v37
M v[104:107],a[204:207],a[184:187],v[104:107]
v_max_u32_dpp v213,v213,v213 row_ror:2 row_mask:0xf bank_mask:0xf
v_cvt_pk_bf16_f32 v145,v34,v35
M v[120:123],a[204:207],a[188:191],v[204:207]
v_exp_f32 v38,v38
M v[120:123],a[200:203],a[172:175],v[120:123]
s_nop 1
M v[120:123],a[196:199],a[156:159],v[120:123]
v_exp_f32 v39,v39
M v[120:123],a[192:195],a[140:143],v[120:123]
v_max_u32_dpp v213,v213,v213 row_ror:1 row_mask:0xf bank_mask:0xf
s_waitcnt lgkmcnt(0)
MS a[232:235],v[208:211],v[176:183],v255
ds_read_b128 a[192:195],v224 offset:12288
v_cvt_pk_bf16_f32 v146,v36,v37
M a[64:67],a[208:211],v[160:163],a[64:67]
v_exp_f32 v40,v40
M a[64:67],a[212:215],v[164:167],a[64:67]
ds_read_b128 a[196:199],v225 offset:12288
s_nop 0
M a[68:71],a[212:215],v[172:175],a[68:71]
v_exp_f32 v41,v41
v_cvt_pk_bf16_f32 v147,v38,v39
M a[68:71],a[208:211],v[168:171],a[68:71]
ds_read_b128 a[200:203],v226 offset:12288
v_readlane_b32 s101,v213,0
M a[72:75],a[208:211],v[176:179],a[72:75]
v_exp_f32 v42,v42
M a[72:75],a[212:215],v[180:183],a[72:75]
ds_read_b128 a[204:207],v227 offset:12288
v_exp_f32 v43,v43
M a[76:79],a[212:215],v[188:191],a[76:79]
v_readlane_b32 s100,v213,16
v_cvt_pk_bf16_f32 v148,v40,v41
M a[76:79],a[208:211],v[184:187],a[76:79]
v_exp_f32 v44,v44
M a[92:95],a[216:219],v[184:187],a[92:95]
ds_read_b64_tr_b16 a[208:209],v234 offset:0
s_nop 3
M a[92:95],a[220:223],v[188:191],a[92:95]
v_exp_f32 v45,v45
M a[88:91],a[220:223],v[180:183],a[88:91]
ds_read_b64_tr_b16 a[210:211],v234 offset:4096
M a[88:91],a[216:219],v[176:179],a[88:91]
s_max_u32 s101,s101,s100
s_and_b32 s100,s101,0xffff
s_sub_u32 s100,0xffff,s100
M a[84:87],a[216:219],v[168:171],a[84:87]
ds_read_b64_tr_b16 a[212:213],v234 offset:8192
v_cvt_pk_bf16_f32 v149,v42,v43
M a[84:87],a[220:223],v[172:175],a[84:87]
v_exp_f32 v46,v46
M a[80:83],a[220:223],v[164:167],a[80:83]
ds_read_b64_tr_b16 a[214:215],v234 offset:12288
v_exp_f32 v47,v47
M a[80:83],a[216:219],v[160:163],a[80:83]
s_waitcnt lgkmcnt(4)
M v[76:79],a[192:195],a[128:131],v[192:195]
ds_read_b64_tr_b16 a[216:217],v235 offset:0
M v[76:79],a[196:199],a[144:147],v[76:79]
buffer_store_dwordx4 a[240:243],v215,s[32:35],s54 offen offset:2048 sc1
M v[76:79],a[200:203],a[160:163],v[76:79]
ds_read_b64_tr_b16 a[218:219],v235 offset:4096
v_cvt_pk_bf16_f32 v150,v44,v45
M v[76:79],a[204:207],a[176:179],v[76:79]
s_lshl_b32 s51,s40,8
s_add_u32 m0,s51,151552
s_mul_i32 s50,s100,1280
s_add_u32 s51,s51,s50
buffer_load_dword v212,s[8:11],s51 offen lds
s_mov_b32 m0,152576
s_add_u32 s51,s50,1024
buffer_load_dword v212,s[8:11],s51 offen lds
M v[92:95],a[204:207],a[180:183],v[196:199]
ds_read_b64_tr_b16 a[220:221],v235 offset:8192
v_exp_f32 v48,v48
M v[92:95],a[200:203],a[164:167],v[92:95]
v_exp_f32 v49,v49
M v[92:95],a[196:199],a[148:151],v[92:95]
ds_read_b64_tr_b16 a[222:223],v235 offset:12288
v_cvt_pk_bf16_f32 v151,v46,v47
M v[92:95],a[192:195],a[132:135],v[92:95]
v_exp_f32 v50,v50
M v[108:111],a[192:195],a[136:139],v[200:203]
v_exp_f32 v51,v51
M v[108:111],a[196:199],a[152:155],v[108:111]
v_cvt_pk_bf16_f32 v152,v48,v49
M v[108:111],a[200:203],a[168:171],v[108:111]
v_exp_f32 v52,v52
M v[108:111],a[204:207],a[184:187],v[108:111]
v_exp_f32 v53,v53
M v[124:127],a[204:207],a[188:191],v[204:207]
v_cvt_pk_bf16_f32 v153,v50,v51
M v[124:127],a[200:203],a[172:175],v[124:127]
v_exp_f32 v54,v54
M v[124:127],a[196:199],a[156:159],v[124:127]
v_exp_f32 v55,v55
M v[124:127],a[192:195],a[140:143],v[124:127]
s_waitcnt vmcnt(12) lgkmcnt(0)
MS a[236:239],v[208:211],v[184:191],v255
s_barrier
v_cvt_pk_bf16_f32 v154,v52,v53
M a[96:99],a[208:211],v[160:163],a[96:99]
ds_read_b128 a[192:195],v224 offset:16384
v_exp_f32 v56,v56
M a[96:99],a[212:215],v[164:167],a[96:99]
v_exp_f32 v57,v57
M a[100:103],a[212:215],v[172:175],a[100:103]
ds_read_b128 a[196:199],v225 offset:16384
v_cvt_pk_bf16_f32 v155,v54,v55
M a[100:103],a[208:211],v[168:171],a[100:103]
v_exp_f32 v58,v58
M a[104:107],a[208:211],v[176:179],a[104:107]
ds_read_b128 a[200:203],v226 offset:16384
M a[104:107],a[212:215],v[180:183],a[104:107]
v_exp_f32 v59,v59
M a[108:111],a[212:215],v[188:191],a[108:111]
ds_read_b128 a[204:207],v227 offset:16384
v_cvt_pk_bf16_f32 v156,v56,v57
M a[108:111],a[208:211],v[184:187],a[108:111]
s_lshl_b32 s50,s100,2
s_add_u32 s50,s50,25165824
buffer_load_dword v214,off,s[32:35],s50 sc1
M a[124:127],a[216:219],v[184:187],a[124:127]
ds_read_b64_tr_b16 a[208:209],v228 offset:16384
M a[124:127],a[220:223],v[188:191],a[124:127]
v_exp_f32 v60,v60
M a[120:123],a[220:223],v[180:183],a[120:123]
ds_read_b64_tr_b16 a[210:211],v228 offset:20480
M a[120:123],a[216:219],v[176:179],a[120:123]
v_exp_f32 v61,v61
M a[116:119],a[216:219],v[168:171],a[116:119]
ds_read_b64_tr_b16 a[212:213],v228 offset:24576
v_cvt_pk_bf16_f32 v157,v58,v59
M a[116:119],a[220:223],v[172:175],a[116:119]
v_exp_f32 v62,v62
M a[112:115],a[220:223],v[164:167],a[112:115]
ds_read_b64_tr_b16 a[214:215],v228 offset:28672
v_exp_f32 v63,v63
M a[112:115],a[216:219],v[160:163],a[112:115]
v_cvt_pk_bf16_f32 v158,v60,v61
v_cvt_pk_bf16_f32 v159,v62,v63
s_waitcnt lgkmcnt(4)
M v[0:3],a[192:195],a[128:131],v[192:195]
ds_read_b64_tr_b16 a[216:217],v229 offset:16384
v_exp_f32 v64,v64
M v[0:3],a[196:199],a[144:147],v[0:3]
v_exp_f32 v65,v65
M v[0:3],a[200:203],a[160:163],v[0:3]
ds_read_b64_tr_b16 a[218:219],v229 offset:20480
v_exp_f32 v66,v66
M v[0:3],a[204:207],a[176:179],v[0:3]
v_exp_f32 v67,v67
M v[16:19],a[204:207],a[180:183],v[196:199]
ds_read_b64_tr_b16 a[220:221],v229 offset:24576
v_cvt_pk_bf16_f32 v160,v64,v65
M v[16:19],a[200:203],a[164:167],v[16:19]
v_exp_f32 v68,v68
M v[16:19],a[196:199],a[148:151],v[16:19]
ds_read_b64_tr_b16 a[222:223],v229 offset:28672
s_add_u32 m0,s48,0
M v[16:19],a[192:195],a[132:135],v[16:19]
v_exp_f32 v69,v69
M v[32:35],a[192:195],a[136:139],v[200:203]
buffer_load_dwordx4 v236,s[12:15],s43 offen offset:0 nt lds
M v[32:35],a[196:199],a[152:155],v[32:35]
v_cvt_pk_bf16_f32 v161,v66,v67
M v[32:35],a[200:203],a[168:171],v[32:35]
buffer_load_dwordx4 v237,s[12:15],s43 offen offset:1024 nt lds
M v[32:35],a[204:207],a[184:187],v[32:35]
v_exp_f32 v70,v70
M v[48:51],a[204:207],a[188:191],v[204:207]
buffer_load_dwordx4 v238,s[12:15],s43 offen offset:2048 nt lds
M v[48:51],a[200:203],a[172:175],v[48:51]
buffer_store_dwordx4 a[244:247],v215,s[32:35],s54 offen offset:3072 sc1
M v[48:51],a[196:199],a[156:159],v[48:51]
buffer_load_dwordx4 v239,s[12:15],s43 offen offset:3072 nt lds
M v[48:51],a[192:195],a[140:143],v[48:51]
s_add_u32 s43,s43,16384
s_waitcnt lgkmcnt(0)
MS a[224:227],v[208:211],v[128:135],v255
ds_read_b128 a[192:195],v224 offset:20480
M a[0:3],a[208:211],v[128:131],a[0:3]
v_exp_f32 v71,v71
M a[0:3],a[212:215],v[132:135],a[0:3]
ds_read_b128 a[196:199],v225 offset:20480
v_cvt_pk_bf16_f32 v162,v68,v69
M a[4:7],a[212:215],v[140:143],a[4:7]
v_exp_f32 v72,v72
M a[4:7],a[208:211],v[136:139],a[4:7]
ds_read_b128 a[200:203],v226 offset:20480
M a[8:11],a[208:211],v[144:147],a[8:11]
v_exp_f32 v73,v73
M a[8:11],a[212:215],v[148:151],a[8:11]
ds_read_b128 a[204:207],v227 offset:20480
v_cvt_pk_bf16_f32 v163,v70,v71
M a[12:15],a[212:215],v[156:159],a[12:15]
v_exp_f32 v74,v74
M a[12:15],a[208:211],v[152:155],a[12:15]
v_exp_f32 v75,v75
M a[28:31],a[216:219],v[152:155],a[28:31]
ds_read_b64_tr_b16 a[208:209],v230 offset:16384
v_cvt_pk_bf16_f32 v164,v72,v73
M a[28:31],a[220:223],v[156:159],a[28:31]
v_exp_f32 v76,v76
M a[24:27],a[220:223],v[148:151],a[24:27]
ds_read_b64_tr_b16 a[210:211],v230 offset:20480
M a[24:27],a[216:219],v[144:147],a[24:27]
v_exp_f32 v77,v77
M a[20:23],a[216:219],v[136:139],a[20:23]
ds_read_b64_tr_b16 a[212:213],v230 offset:24576
v_cvt_pk_bf16_f32 v165,v74,v75
M a[20:23],a[220:223],v[140:143],a[20:23]
v_exp_f32 v78,v78
M a[16:19],a[220:223],v[132:135],a[16:19]
ds_read_b64_tr_b16 a[214:215],v230 offset:28672
v_exp_f32 v79,v79
M a[16:19],a[216:219],v[128:131],a[16:19]
v_cvt_pk_bf16_f32 v166,v76,v77
s_waitcnt lgkmcnt(4)
M v[4:7],a[192:195],a[128:131],v[192:195]
ds_read_b64_tr_b16 a[216:217],v231 offset:16384
v_exp_f32 v80,v80
M v[4:7],a[196:199],a[144:147],v[4:7]
v_exp_f32 v81,v81
M v[4:7],a[200:203],a[160:163],v[4:7]
ds_read_b64_tr_b16 a[218:219],v231 offset:20480
v_cvt_pk_bf16_f32 v167,v78,v79
M v[4:7],a[204:207],a[176:179],v[4:7]
v_exp_f32 v82,v82
M v[20:23],a[204:207],a[180:183],v[196:199]
ds_read_b64_tr_b16 a[220:221],v231 offset:24576
M v[20:23],a[200:203],a[164:167],v[20:23]
v_exp_f32 v83,v83
v_cvt_pk_bf16_f32 v168,v80,v81
M v[20:23],a[196:199],a[148:151],v[20:23]
ds_read_b64_tr_b16 a[222:223],v231 offset:28672
s_add_u32 m0,s48,65536
M v[20:23],a[192:195],a[132:135],v[20:23]
v_exp_f32 v84,v84
M v[36:39],a[192:195],a[136:139],v[200:203]
buffer_load_dwordx4 v240,s[16:19],s44 offen offset:0 nt lds
M v[36:39],a[196:199],a[152:155],v[36:39]
v_exp_f32 v85,v85
M v[36:39],a[200:203],a[168:171],v[36:39]
buffer_load_dwordx4 v241,s[16:19],s44 offen offset:1024 nt lds
M v[36:39],a[204:207],a[184:187],v[36:39]
v_cvt_pk_bf16_f32 v169,v82,v83
v_exp_f32 v86,v86
M v[52:55],a[204:207],a[188:191],v[204:207]
buffer_load_dwordx4 v240,s[16:19],s44 offen offset:2048 nt lds
M v[52:55],a[200:203],a[172:175],v[52:55]
v_exp_f32 v87,v87
M v[52:55],a[196:199],a[156:159],v[52:55]
buffer_load_dwordx4 v241,s[16:19],s44 offen offset:3072 nt lds
M v[52:55],a[192:195],a[140:143],v[52:55]
s_add_u32 s44,s44,16384
s_waitcnt lgkmcnt(0)
MS a[228:231],v[208:211],v[136:143],v255
ds_read_b128 a[192:195],v224 offset:24576
v_cvt_pk_bf16_f32 v170,v84,v85
M a[32:35],a[208:211],v[128:131],a[32:35]
v_exp_f32 v88,v88
M a[32:35],a[212:215],v[132:135],a[32:35]
ds_read_b128 a[196:199],v225 offset:24576
M a[36:39],a[212:215],v[140:143],a[36:39]
v_exp_f32 v89,v89
M a[36:39],a[208:211],v[136:139],a[36:39]
ds_read_b128 a[200:203],v226 offset:24576
v_cvt_pk_bf16_f32 v171,v86,v87
M a[40:43],a[208:211],v[144:147],a[40:43]
v_exp_f32 v90,v90
M a[40:43],a[212:215],v[148:151],a[40:43]
ds_read_b128 a[204:207],v227 offset:24576
v_exp_f32 v91,v91
M a[44:47],a[212:215],v[156:159],a[44:47]
v_lshrrev_b32 v212,2,v242
v_cvt_pk_bf16_f32 v172,v88,v89
M a[44:47],a[208:211],v[152:155],a[44:47]
v_exp_f32 v92,v92
M a[60:63],a[216:219],v[152:155],a[60:63]
ds_read_b64_tr_b16 a[208:209],v232 offset:16384
v_mul_u32_u24 v212,3456,v212
M a[60:63],a[220:223],v[156:159],a[60:63]
v_exp_f32 v93,v93
M a[56:59],a[220:223],v[148:151],a[56:59]
ds_read_b64_tr_b16 a[210:211],v232 offset:20480
v_cvt_pk_bf16_f32 v173,v90,v91
M a[56:59],a[216:219],v[144:147],a[56:59]
v_exp_f32 v94,v94
M a[52:55],a[216:219],v[136:139],a[52:55]
ds_read_b64_tr_b16 a[212:213],v232 offset:24576
v_and_b32 v213,3,v242
M a[52:55],a[220:223],v[140:143],a[52:55]
v_exp_f32 v95,v95
M a[48:51],a[220:223],v[132:135],a[48:51]
ds_read_b64_tr_b16 a[214:215],v232 offset:28672
v_cvt_pk_bf16_f32 v174,v92,v93
M a[48:51],a[216:219],v[128:131],a[48:51]
v_lshl_add_u32 v212,v213,4,v212
s_waitcnt lgkmcnt(4)
M v[8:11],a[192:195],a[128:131],v[192:195]
ds_read_b64_tr_b16 a[216:217],v233 offset:16384
v_exp_f32 v96,v96
M v[8:11],a[196:199],a[144:147],v[8:11]
s_add_u32 s54,s54,4096
buffer_store_dwordx4 a[248:251],v215,s[32:35],s54 offen offset:0 sc1
M v[8:11],a[200:203],a[160:163],v[8:11]
ds_read_b64_tr_b16 a[218:219],v233 offset:20480
M v[8:11],a[204:207],a[176:179],v[8:11]
s_add_u32 m0,s59,131072
s_add_u32 s50,s58,0
buffer_load_dwordx4 v212,s[4:7],s50 offen nt lds
M v[24:27],a[204:207],a[180:183],v[196:199]
ds_read_b64_tr_b16 a[220:221],v233 offset:24576
M v[24:27],a[200:203],a[164:167],v[24:27]
v_exp_f32 v97,v97
M v[24:27],a[196:199],a[148:151],v[24:27]
ds_read_b64_tr_b16 a[222:223],v233 offset:28672
v_cvt_pk_bf16_f32 v175,v94,v95
M v[24:27],a[192:195],a[132:135],v[24:27]
v_exp_f32 v98,v98
M v[40:43],a[192:195],a[136:139],v[200:203]
v_exp_f32 v99,v99
M v[40:43],a[196:199],a[152:155],v[40:43]
v_cvt_pk_bf16_f32 v176,v96,v97
M v[40:43],a[200:203],a[168:171],v[40:43]
v_exp_f32 v100,v100
M v[40:43],a[204:207],a[184:187],v[40:43]
v_exp_f32 v101,v101
M v[56:59],a[204:207],a[188:191],v[204:207]
v_cvt_pk_bf16_f32 v177,v98,v99
M v[56:59],a[200:203],a[172:175],v[56:59]
v_exp_f32 v102,v102
M v[56:59],a[196:199],a[156:159],v[56:59]
s_add_u32 m0,s59,132096
s_add_u32 s50,s58,55296
buffer_load_dwordx4 v212,s[4:7],s50 offen nt lds
M v[56:59],a[192:195],a[140:143],v[56:59]
s_waitcnt lgkmcnt(0)
MS a[232:235],v[208:211],v[144:151],v255
ds_read_b128 a[192:195],v224 offset:28672
M a[64:67],a[208:211],v[128:131],a[64:67]
v_exp_f32 v103,v103
M a[64:67],a[212:215],v[132:135],a[64:67]
ds_read_b128 a[196:199],v225 offset:28672
v_cvt_pk_bf16_f32 v178,v100,v101
M a[68:71],a[212:215],v[140:143],a[68:71]
v_exp_f32 v104,v104
M a[68:71],a[208:211],v[136:139],a[68:71]
ds_read_b128 a[200:203],v226 offset:28672
M a[72:75],a[208:211],v[144:147],a[72:75]
v_exp_f32 v105,v105
M a[72:75],a[212:215],v[148:151],a[72:75]
ds_read_b128 a[204:207],v227 offset:28672
v_cvt_pk_bf16_f32 v179,v102,v103
M a[76:79],a[212:215],v[156:159],a[76:79]
v_exp_f32 v106,v106
M a[76:79],a[208:211],v[152:155],a[76:79]
v_exp_f32 v107,v107
M a[92:95],a[216:219],v[152:155],a[92:95]
ds_read_b64_tr_b16 a[208:209],v234 offset:16384
v_cvt_pk_bf16_f32 v180,v104,v105
M a[92:95],a[220:223],v[156:159],a[92:95]
v_exp_f32 v108,v108
M a[88:91],a[220:223],v[148:151],a[88:91]
ds_read_b64_tr_b16 a[210:211],v234 offset:20480
M a[88:91],a[216:219],v[144:147],a[88:91]
v_exp_f32 v109,v109
M a[84:87],a[216:219],v[136:139],a[84:87]
ds_read_b64_tr_b16 a[212:213],v234 offset:24576
M a[84:87],a[220:223],v[140:143],a[84:87]
s_add_u32 m0,s59,133120
s_add_u32 s50,s58,110592
buffer_load_dwordx4 v212,s[4:7],s50 offen nt lds
M a[80:83],a[220:223],v[132:135],a[80:83]
ds_read_b64_tr_b16 a[214:215],v234 offset:28672
v_cvt_pk_bf16_f32 v181,v106,v107
M a[80:83],a[216:219],v[128:131],a[80:83]
v_exp_f32 v110,v110
s_waitcnt lgkmcnt(4)
M v[12:15],a[192:195],a[128:131],v[192:195]
ds_read_b64_tr_b16 a[216:217],v235 offset:16384
M v[12:15],a[196:199],a[144:147],v[12:15]
v_exp_f32 v111,v111
M v[12:15],a[200:203],a[160:163],v[12:15]
ds_read_b64_tr_b16 a[218:219],v235 offset:20480
v_cvt_pk_bf16_f32 v182,v108,v109
M v[12:15],a[204:207],a[176:179],v[12:15]
v_exp_f32 v112,v112
M v[28:31],a[204:207],a[180:183],v[196:199]
ds_read_b64_tr_b16 a[220:221],v235 offset:24576
M v[28:31],a[200:203],a[164:167],v[28:31]
v_exp_f32 v113,v113
M v[28:31],a[196:199],a[148:151],v[28:31]
ds_read_b64_tr_b16 a[222:223],v235 offset:28672
v_cvt_pk_bf16_f32 v183,v110,v111
M v[28:31],a[192:195],a[132:135],v[28:31]
v_exp_f32 v114,v114
M v[44:47],a[192:195],a[136:139],v[200:203]
v_exp_f32 v115,v115
M v[44:47],a[196:199],a[152:155],v[44:47]
s_add_u32 m0,s59,134144
s_add_u32 s50,s58,165888
buffer_load_dwordx4 v212,s[4:7],s50 offen nt lds
M v[44:47],a[200:203],a[168:171],v[44:47]
v_cvt_pk_bf16_f32 v184,v112,v113
M v[44:47],a[204:207],a[184:187],v[44:47]
v_exp_f32 v116,v116
M v[60:63],a[204:207],a[188:191],v[204:207]
v_exp_f32 v117,v117
v_cvt_pk_bf16_f32 v185,v114,v115
M v[60:63],a[200:203],a[172:175],v[60:63]
v_exp_f32 v118,v118
M v[60:63],a[196:199],a[156:159],v[60:63]
v_exp_f32 v119,v119
M v[60:63],a[192:195],a[140:143],v[60:63]
v_cvt_pk_bf16_f32 v186,v116,v117
s_waitcnt lgkmcnt(0)
MS a[236:239],v[208:211],v[152:159],v255
s_barrier
M a[96:99],a[208:211],v[128:131],a[96:99]
ds_read_b128 a[192:195],v224 offset:32768
v_exp_f32 v120,v120
M a[96:99],a[212:215],v[132:135],a[96:99]
v_exp_f32 v121,v121
M a[100:103],a[212:215],v[140:143],a[100:103]
ds_read_b128 a[196:199],v225 offset:32768
v_cvt_pk_bf16_f32 v187,v118,v119
M a[100:103],a[208:211],v[136:139],a[100:103]
s_add_u32 m0,s59,135168
s_add_u32 s50,s58,221184
buffer_load_dwordx4 v212,s[4:7],s50 offen nt lds
M a[104:107],a[208:211],v[144:147],a[104:107]
ds_read_b128 a[200:203],v226 offset:32768
M a[104:107],a[212:215],v[148:151],a[104:107]
v_exp_f32 v122,v122
M a[108:111],a[212:215],v[156:159],a[108:111]
ds_read_b128 a[204:207],v227 offset:32768
M a[108:111],a[208:211],v[152:155],a[108:111]
v_exp_f32 v123,v123
M a[124:127],a[216:219],v[152:155],a[124:127]
ds_read_b64_tr_b16 a[208:209],v228 offset:32768
v_cvt_pk_bf16_f32 v188,v120,v121
M a[124:127],a[220:223],v[156:159],a[124:127]
v_exp_f32 v124,v124
M a[120:123],a[220:223],v[148:151],a[120:123]
ds_read_b64_tr_b16 a[210:211],v228 offset:36864
M a[120:123],a[216:219],v[144:147],a[120:123]
v_exp_f32 v125,v125
M a[116:119],a[216:219],v[136:139],a[116:119]
ds_read_b64_tr_b16 a[212:213],v228 offset:40960
v_cvt_pk_bf16_f32 v189,v122,v123
M a[116:119],a[220:223],v[140:143],a[116:119]
v_exp_f32 v126,v126
M a[112:115],a[220:223],v[132:135],a[112:115]
ds_read_b64_tr_b16 a[214:215],v228 offset:45056
v_exp_f32 v127,v127
M a[112:115],a[216:219],v[128:131],a[112:115]
v_cvt_pk_bf16_f32 v190,v124,v125
v_cvt_pk_bf16_f32 v191,v126,v127
s_waitcnt lgkmcnt(4)
M v[64:67],a[192:195],a[128:131],v[192:195]
ds_read_b64_tr_b16 a[216:217],v229 offset:32768
M v[64:67],a[196:199],a[144:147],v[64:67]
v_exp_f32 v0,v0
M v[64:67],a[200:203],a[160:163],v[64:67]
ds_read_b64_tr_b16 a[218:219],v229 offset:36864
M v[64:67],a[204:207],a[176:179],v[64:67]
v_exp_f32 v1,v1
M v[80:83],a[204:207],a[180:183],v[196:199]
ds_read_b64_tr_b16 a[220:221],v229 offset:40960
M v[80:83],a[200:203],a[164:167],v[80:83]
v_exp_f32 v2,v2
M v[80:83],a[196:199],a[148:151],v[80:83]
ds_read_b64_tr_b16 a[222:223],v229 offset:45056
s_add_u32 m0,s48,16384
M v[80:83],a[192:195],a[132:135],v[80:83]
v_exp_f32 v3,v3
M v[96:99],a[192:195],a[136:139],v[200:203]
buffer_load_dwordx4 v236,s[12:15],s43 offen offset:0 nt lds
M v[96:99],a[196:199],a[152:155],v[96:99]
v_cvt_pk_bf16_f32 v128,v0,v1
M v[96:99],a[200:203],a[168:171],v[96:99]
buffer_load_dwordx4 v237,s[12:15],s43 offen offset:1024 nt lds
M v[96:99],a[204:207],a[184:187],v[96:99]
v_exp_f32 v4,v4
M v[112:115],a[204:207],a[188:191],v[204:207]
buffer_load_dwordx4 v238,s[12:15],s43 offen offset:2048 nt lds
M v[112:115],a[200:203],a[172:175],v[112:115]
v_exp_f32 v5,v5
M v[112:115],a[196:199],a[156:159],v[112:115]
buffer_load_dwordx4 v239,s[12:15],s43 offen offset:3072 nt lds
M v[112:115],a[192:195],a[140:143],v[112:115]
s_add_u32 s43,s43,16384
s_waitcnt lgkmcnt(0)
MS a[224:227],v[208:211],v[160:167],v255
ds_read_b128 a[192:195],v224 offset:36864
v_cvt_pk_bf16_f32 v129,v2,v3
M a[0:3],a[208:211],v[160:163],a[0:3]
v_exp_f32 v6,v6
M a[0:3],a[212:215],v[164:167],a[0:3]
ds_read_b128 a[196:199],v225 offset:36864
M a[4:7],a[212:215],v[172:175],a[4:7]
v_exp_f32 v7,v7
M a[4:7],a[208:211],v[168:171],a[4:7]
ds_read_b128 a[200:203],v226 offset:36864
v_cvt_pk_bf16_f32 v130,v4,v5
M a[8:11],a[208:211],v[176:179],a[8:11]
v_exp_f32 v8,v8
M a[8:11],a[212:215],v[180:183],a[8:11]
ds_read_b128 a[204:207],v227 offset:36864
v_exp_f32 v9,v9
M a[12:15],a[212:215],v[188:191],a[12:15]
v_cvt_pk_bf16_f32 v131,v6,v7
M a[12:15],a[208:211],v[184:187],a[12:15]
v_exp_f32 v10,v10
M a[28:31],a[216:219],v[184:187],a[28:31]
ds_read_b64_tr_b16 a[208:209],v230 offset:32768
M a[28:31],a[220:223],v[188:191],a[28:31]
v_exp_f32 v11,v11
M a[24:27],a[220:223],v[180:183],a[24:27]
ds_read_b64_tr_b16 a[210:211],v230 offset:36864
v_cvt_pk_bf16_f32 v132,v8,v9
M a[24:27],a[216:219],v[176:179],a[24:27]
v_exp_f32 v12,v12
M a[20:23],a[216:219],v[168:171],a[20:23]
ds_read_b64_tr_b16 a[212:213],v230 offset:40960
M a[20:23],a[220:223],v[172:175],a[20:23]
v_exp_f32 v13,v13
M a[16:19],a[220:223],v[164:167],a[16:19]
ds_read_b64_tr_b16 a[214:215],v230 offset:45056
v_cvt_pk_bf16_f32 v133,v10,v11
M a[16:19],a[216:219],v[160:163],a[16:19]
v_exp_f32 v14,v14
s_waitcnt lgkmcnt(4)
M v[68:71],a[192:195],a[128:131],v[192:195]
ds_read_b64_tr_b16 a[216:217],v231 offset:32768
M v[68:71],a[196:199],a[144:147],v[68:71]
v_exp_f32 v15,v15
M v[68:71],a[200:203],a[160:163],v[68:71]
ds_read_b64_tr_b16 a[218:219],v231 offset:36864
v_cvt_pk_bf16_f32 v134,v12,v13
M v[68:71],a[204:207],a[176:179],v[68:71]
v_exp_f32 v16,v16
M v[84:87],a[204:207],a[180:183],v[196:199]
ds_read_b64_tr_b16 a[220:221],v231 offset:40960
M v[84:87],a[200:203],a[164:167],v[84:87]
v_exp_f32 v17,v17
M v[84:87],a[196:199],a[148:151],v[84:87]
ds_read_b64_tr_b16 a[222:223],v231 offset:45056
s_add_u32 m0,s48,81920
M v[84:87],a[192:195],a[132:135],v[84:87]
v_cvt_pk_bf16_f32 v135,v14,v15
M v[100:103],a[192:195],a[136:139],v[200:203]
buffer_load_dwordx4 v240,s[16:19],s44 offen offset:0 nt lds
M v[100:103],a[196:199],a[152:155],v[100:103]
v_exp_f32 v18,v18
M v[100:103],a[200:203],a[168:171],v[100:103]
buffer_load_dwordx4 v241,s[16:19],s44 offen offset:1024 nt lds
M v[100:103],a[204:207],a[184:187],v[100:103]
v_exp_f32 v19,v19
M v[116:119],a[204:207],a[188:191],v[204:207]
buffer_load_dwordx4 v240,s[16:19],s44 offen offset:2048 nt lds
M v[116:119],a[200:203],a[172:175],v[116:119]
v_cvt_pk_bf16_f32 v136,v16,v17
M v[116:119],a[196:199],a[156:159],v[116:119]
buffer_load_dwordx4 v241,s[16:19],s44 offen offset:3072 nt lds
M v[116:119],a[192:195],a[140:143],v[116:119]
s_add_u32 s44,s44,16384
s_waitcnt lgkmcnt(0)
MS a[228:231],v[208:211],v[168:175],v255
ds_read_b128 a[192:195],v224 offset:40960
v_exp_f32 v20,v20
M a[32:35],a[208:211],v[160:163],a[32:35]
v_exp_f32 v21,v21
M a[32:35],a[212:215],v[164:167],a[32:35]
ds_read_b128 a[196:199],v225 offset:40960
v_cvt_pk_bf16_f32 v137,v18,v19
M a[36:39],a[212:215],v[172:175],a[36:39]
v_exp_f32 v22,v22
M a[36:39],a[208:211],v[168:171],a[36:39]
ds_read_b128 a[200:203],v226 offset:40960
M a[40:43],a[208:211],v[176:179],a[40:43]
v_exp_f32 v23,v23
M a[40:43],a[212:215],v[180:183],a[40:43]
ds_read_b128 a[204:207],v227 offset:40960
v_cvt_pk_bf16_f32 v138,v20,v21
M a[44:47],a[212:215],v[188:191],a[44:47]
v_exp_f32 v24,v24
M a[44:47],a[208:211],v[184:187],a[44:47]
v_exp_f32 v25,v25
M a[60:63],a[216:219],v[184:187],a[60:63]
ds_read_b64_tr_b16 a[208:209],v232 offset:32768
v_cvt_pk_bf16_f32 v139,v22,v23
M a[60:63],a[220:223],v[188:191],a[60:63]
v_exp_f32 v26,v26
M a[56:59],a[220:223],v[180:183],a[56:59]
ds_read_b64_tr_b16 a[210:211],v232 offset:36864
M a[56:59],a[216:219],v[176:179],a[56:59]
v_exp_f32 v27,v27
M a[52:55],a[216:219],v[168:171],a[52:55]
ds_read_b64_tr_b16 a[212:213],v232 offset:40960
v_cvt_pk_bf16_f32 v140,v24,v25
M a[52:55],a[220:223],v[172:175],a[52:55]
v_exp_f32 v28,v28
M a[48:51],a[220:223],v[164:167],a[48:51]
ds_read_b64_tr_b16 a[214:215],v232 offset:45056
M a[48:51],a[216:219],v[160:163],a[48:51]
s_waitcnt lgkmcnt(4)
M v[72:75],a[192:195],a[128:131],v[192:195]
ds_read_b64_tr_b16 a[216:217],v233 offset:32768
M v[72:75],a[196:199],a[144:147],v[72:75]
v_exp_f32 v29,v29
M v[72:75],a[200:203],a[160:163],v[72:75]
ds_read_b64_tr_b16 a[218:219],v233 offset:36864
v_cvt_pk_bf16_f32 v141,v26,v27
M v[72:75],a[204:207],a[176:179],v[72:75]
v_exp_f32 v30,v30
M v[88:91],a[204:207],a[180:183],v[196:199]
ds_read_b64_tr_b16 a[220:221],v233 offset:40960
M v[88:91],a[200:203],a[164:167],v[88:91]
v_exp_f32 v31,v31
M v[88:91],a[196:199],a[148:151],v[88:91]
ds_read_b64_tr_b16 a[222:223],v233 offset:45056
v_cvt_pk_bf16_f32 v142,v28,v29
M v[88:91],a[192:195],a[132:135],v[88:91]
v_exp_f32 v32,v32
M v[104:107],a[192:195],a[136:139],v[200:203]
v_exp_f32 v33,v33
M v[104:107],a[196:199],a[152:155],v[104:107]
v_cvt_pk_bf16_f32 v143,v30,v31
M v[104:107],a[200:203],a[168:171],v[104:107]
v_exp_f32 v34,v34
M v[104:107],a[204:207],a[184:187],v[104:107]
v_exp_f32 v35,v35
M v[120:123],a[204:207],a[188:191],v[204:207]
v_cvt_pk_bf16_f32 v144,v32,v33
M v[120:123],a[200:203],a[172:175],v[120:123]
v_exp_f32 v36,v36
M v[120:123],a[196:199],a[156:159],v[120:123]
v_exp_f32 v37,v37
M v[120:123],a[192:195],a[140:143],v[120:123]
v_cvt_pk_bf16_f32 v145,v34,v35
s_waitcnt lgkmcnt(0)
MS a[232:235],v[208:211],v[176:183],v255
ds_read_b128 a[192:195],v224 offset:45056
v_exp_f32 v38,v38
M a[64:67],a[208:211],v[160:163],a[64:67]
v_exp_f32 v39,v39
M a[64:67],a[212:215],v[164:167],a[64:67]
ds_read_b128 a[196:199],v225 offset:45056
v_cvt_pk_bf16_f32 v146,v36,v37
M a[68:71],a[212:215],v[172:175],a[68:71]
v_exp_f32 v40,v40
M a[68:71],a[208:211],v[168:171],a[68:71]
ds_read_b128 a[200:203],v226 offset:45056
M a[72:75],a[208:211],v[176:179],a[72:75]
v_exp_f32 v41,v41
M a[72:75],a[212:215],v[180:183],a[72:75]
ds_read_b128 a[204:207],v227 offset:45056
v_cvt_pk_bf16_f32 v147,v38,v39
M a[76:79],a[212:215],v[188:191],a[76:79]
v_exp_f32 v42,v42
M a[76:79],a[208:211],v[184:187],a[76:79]
v_exp_f32 v43,v43
M a[92:95],a[216:219],v[184:187],a[92:95]
ds_read_b64_tr_b16 a[208:209],v234 offset:32768
v_cvt_pk_bf16_f32 v148,v40,v41
M a[92:95],a[220:223],v[188:191],a[92:95]
v_exp_f32 v44,v44
M a[88:91],a[220:223],v[180:183],a[88:91]
ds_read_b64_tr_b16 a[210:211],v234 offset:36864
M a[88:91],a[216:219],v[176:179],a[88:91]
v_exp_f32 v45,v45
M a[84:87],a[216:219],v[168:171],a[84:87]
ds_read_b64_tr_b16 a[212:213],v234 offset:40960
v_cvt_pk_bf16_f32 v149,v42,v43
M a[84:87],a[220:223],v[172:175],a[84:87]
v_exp_f32 v46,v46
M a[80:83],a[220:223],v[164:167],a[80:83]
ds_read_b64_tr_b16 a[214:215],v234 offset:45056
M a[80:83],a[216:219],v[160:163],a[80:83]
s_waitcnt lgkmcnt(4)
M v[76:79],a[192:195],a[128:131],v[192:195]
ds_read_b64_tr_b16 a[216:217],v235 offset:32768
M v[76:79],a[196:199],a[144:147],v[76:79]
v_exp_f32 v47,v47
M v[76:79],a[200:203],a[160:163],v[76:79]
ds_read_b64_tr_b16 a[218:219],v235 offset:36864
v_cvt_pk_bf16_f32 v150,v44,v45
M v[76:79],a[204:207],a[176:179],v[76:79]
v_exp_f32 v48,v48
M v[92:95],a[204:207],a[180:183],v[196:199]
ds_read_b64_tr_b16 a[220:221],v235 offset:40960
M v[92:95],a[200:203],a[164:167],v[92:95]
v_exp_f32 v49,v49
M v[92:95],a[196:199],a[148:151],v[92:95]
ds_read_b64_tr_b16 a[222:223],v235 offset:45056
v_cvt_pk_bf16_f32 v151,v46,v47
M v[92:95],a[192:195],a[132:135],v[92:95]
v_exp_f32 v50,v50
M v[108:111],a[192:195],a[136:139],v[200:203]
v_exp_f32 v51,v51
M v[108:111],a[196:199],a[152:155],v[108:111]
v_cvt_pk_bf16_f32 v152,v48,v49
M v[108:111],a[200:203],a[168:171],v[108:111]
v_exp_f32 v52,v52
M v[108:111],a[204:207],a[184:187],v[108:111]
v_exp_f32 v53,v53
M v[124:127],a[204:207],a[188:191],v[204:207]
v_cvt_pk_bf16_f32 v153,v50,v51
M v[124:127],a[200:203],a[172:175],v[124:127]
v_exp_f32 v54,v54
M v[124:127],a[196:199],a[156:159],v[124:127]
v_exp_f32 v55,v55
M v[124:127],a[192:195],a[140:143],v[124:127]
s_waitcnt vmcnt(8)
s_waitcnt lgkmcnt(0)
MS a[236:239],v[208:211],v[184:191],v255
s_barrier
v_cvt_pk_bf16_f32 v154,v52,v53
M a[96:99],a[208:211],v[160:163],a[96:99]
ds_read_b128 a[192:195],v224 offset:49152
v_exp_f32 v56,v56
M a[96:99],a[212:215],v[164:167],a[96:99]
v_exp_f32 v57,v57
M a[100:103],a[212:215],v[172:175],a[100:103]
ds_read_b128 a[196:199],v225 offset:49152
v_cvt_pk_bf16_f32 v155,v54,v55
M a[100:103],a[208:211],v[168:171],a[100:103]
v_exp_f32 v58,v58
M a[104:107],a[208:211],v[176:179],a[104:107]
ds_read_b128 a[200:203],v226 offset:49152
M a[104:107],a[212:215],v[180:183],a[104:107]
v_exp_f32 v59,v59
M a[108:111],a[212:215],v[188:191],a[108:111]
ds_read_b128 a[204:207],v227 offset:49152
v_cvt_pk_bf16_f32 v156,v56,v57
M a[108:111],a[208:211],v[184:187],a[108:111]
v_exp_f32 v60,v60
M a[124:127],a[216:219],v[184:187],a[124:127]
ds_read_b64_tr_b16 a[208:209],v228 offset:49152
M a[124:127],a[220:223],v[188:191],a[124:127]
v_exp_f32 v61,v61
M a[120:123],a[220:223],v[180:183],a[120:123]
ds_read_b64_tr_b16 a[210:211],v228 offset:53248
v_cvt_pk_bf16_f32 v157,v58,v59
M a[120:123],a[216:219],v[176:179],a[120:123]
v_exp_f32 v62,v62
M a[116:119],a[216:219],v[168:171],a[116:119]
ds_read_b64_tr_b16 a[212:213],v228 offset:57344
M a[116:119],a[220:223],v[172:175],a[116:119]
v_exp_f32 v63,v63
M a[112:115],a[220:223],v[164:167],a[112:115]
ds_read_b64_tr_b16 a[214:215],v228 offset:61440
M a[112:115],a[216:219],v[160:163],a[112:115]
v_cvt_pk_bf16_f32 v158,v60,v61
v_cvt_pk_bf16_f32 v159,v62,v63
s_waitcnt lgkmcnt(4)
M v[0:3],a[192:195],a[128:131],v[192:195]
ds_read_b64_tr_b16 a[216:217],v229 offset:49152
v_exp_f32 v64,v64
M v[0:3],a[196:199],a[144:147],v[0:3]
v_exp_f32 v65,v65
M v[0:3],a[200:203],a[160:163],v[0:3]
ds_read_b64_tr_b16 a[218:219],v229 offset:53248
v_lshrrev_b32 v246,4,v242
M v[0:3],a[204:207],a[176:179],v[0:3]
v_exp_f32 v66,v66
v_bfe_u32 v244,v242,2,2
M v[16:19],a[204:207],a[180:183],v[196:199]
ds_read_b64_tr_b16 a[220:221],v229 offset:57344
v_exp_f32 v67,v67
M v[16:19],a[200:203],a[164:167],v[16:19]
v_lshl_add_u32 v244,v246,3,v244
v_lshlrev_b32 v244,6,v244
M v[16:19],a[196:199],a[148:151],v[16:19]
ds_read_b64_tr_b16 a[222:223],v229 offset:61440
v_cvt_pk_bf16_f32 v160,v64,v65
s_add_u32 m0,s48,32768
M v[16:19],a[192:195],a[132:135],v[16:19]
v_exp_f32 v68,v68
M v[32:35],a[192:195],a[136:139],v[200:203]
buffer_load_dwordx4 v236,s[12:15],s43 offen offset:0 nt lds
M v[32:35],a[196:199],a[152:155],v[32:35]
v_and_b32 v245,3,v242
v_lshl_add_u32 v244,v245,3,v244
M v[32:35],a[200:203],a[168:171],v[32:35]
buffer_load_dwordx4 v237,s[12:15],s43 offen offset:1024 nt lds
M v[32:35],a[204:207],a[184:187],v[32:35]
v_exp_f32 v69,v69
M v[48:51],a[204:207],a[188:191],v[204:207]
buffer_load_dwordx4 v238,s[12:15],s43 offen offset:2048 nt lds
M v[48:51],a[200:203],a[172:175],v[48:51]
s_and_b32 s50,s40,1
s_mul_i32 s50,s50,10240
s_lshr_b32 s51,s40,1
s_lshl_b32 s51,s51,5
M v[48:51],a[196:199],a[156:159],v[48:51]
buffer_load_dwordx4 v239,s[12:15],s43 offen offset:3072 nt lds
M v[48:51],a[192:195],a[140:143],v[48:51]
s_add_u32 s43,s43,16384
s_waitcnt lgkmcnt(0)
MS a[224:227],v[208:211],v[128:135],v255
ds_read_b128 a[192:195],v224 offset:53248
v_cvt_pk_bf16_f32 v161,v66,v67
M a[0:3],a[208:211],v[128:131],a[0:3]
v_exp_f32 v70,v70
M a[0:3],a[212:215],v[132:135],a[0:3]
ds_read_b128 a[196:199],v225 offset:53248
v_exp_f32 v71,v71
M a[4:7],a[212:215],v[140:143],a[4:7]
s_add_u32 s50,s50,s51
s_add_u32 s50,s50,131072
v_add_u32 v244,s50,v244
M a[4:7],a[208:211],v[136:139],a[4:7]
ds_read_b128 a[200:203],v226 offset:53248
v_cvt_pk_bf16_f32 v162,v68,v69
M a[8:11],a[208:211],v[144:147],a[8:11]
v_exp_f32 v72,v72
M a[8:11],a[212:215],v[148:151],a[8:11]
ds_read_b128 a[204:207],v227 offset:53248
M a[12:15],a[212:215],v[156:159],a[12:15]
v_exp_f32 v73,v73
M a[12:15],a[208:211],v[152:155],a[12:15]
s_and_b32 s50,s3,3
s_mul_i32 s50,s50,320
s_add_u32 s50,s50,151552
v_lshl_add_u32 v245,v246,4,s50
M a[28:31],a[216:219],v[152:155],a[28:31]
ds_read_b64_tr_b16 a[208:209],v230 offset:49152
v_cvt_pk_bf16_f32 v163,v70,v71
M a[28:31],a[220:223],v[156:159],a[28:31]
v_exp_f32 v74,v74
M a[24:27],a[220:223],v[148:151],a[24:27]
ds_read_b64_tr_b16 a[210:211],v230 offset:53248
M a[24:27],a[216:219],v[144:147],a[24:27]
v_exp_f32 v75,v75
M a[20:23],a[216:219],v[136:139],a[20:23]
ds_read_b64_tr_b16 a[212:213],v230 offset:57344
v_cvt_pk_bf16_f32 v164,v72,v73
M a[20:23],a[220:223],v[140:143],a[20:23]
ds_read_b64_tr_b16 a[240:241],v244 offset:0
v_exp_f32 v76,v76
M a[16:19],a[220:223],v[132:135],a[16:19]
ds_read_b64_tr_b16 a[214:215],v230 offset:61440
v_exp_f32 v77,v77
M a[16:19],a[216:219],v[128:131],a[16:19]
ds_read_b64_tr_b16 a[242:243],v244 offset:256
s_waitcnt lgkmcnt(6)
M v[4:7],a[192:195],a[128:131],v[192:195]
ds_read_b64_tr_b16 a[216:217],v231 offset:49152
v_cvt_pk_bf16_f32 v165,v74,v75
M v[4:7],a[196:199],a[144:147],v[4:7]
ds_read_b128 a[244:247],v245 offset:0
v_exp_f32 v78,v78
M v[4:7],a[200:203],a[160:163],v[4:7]
ds_read_b64_tr_b16 a[218:219],v231 offset:53248
v_exp_f32 v79,v79
M v[4:7],a[204:207],a[176:179],v[4:7]
ds_read_b64_tr_b16 a[248:249],v244 offset:2048
v_cvt_pk_bf16_f32 v166,v76,v77
M v[20:23],a[204:207],a[180:183],v[196:199]
ds_read_b64_tr_b16 a[220:221],v231 offset:57344
v_exp_f32 v80,v80
M v[20:23],a[200:203],a[164:167],v[20:23]
ds_read_b64_tr_b16 a[250:251],v244 offset:2304
v_exp_f32 v81,v81
M v[20:23],a[196:199],a[148:151],v[20:23]
ds_read_b64_tr_b16 a[222:223],v231 offset:61440
s_add_u32 m0,s48,98304
M v[20:23],a[192:195],a[132:135],v[20:23]
ds_read_b128 a[252:255],v245 offset:64
v_cvt_pk_bf16_f32 v167,v78,v79
M v[36:39],a[192:195],a[136:139],v[200:203]
buffer_load_dwordx4 v240,s[16:19],s44 offen offset:0 nt lds
M v[36:39],a[196:199],a[152:155],v[36:39]
v_exp_f32 v82,v82
M v[36:39],a[200:203],a[168:171],v[36:39]
buffer_load_dwordx4 v241,s[16:19],s44 offen offset:1024 nt lds
M v[36:39],a[204:207],a[184:187],v[36:39]
v_exp_f32 v83,v83
M v[52:55],a[204:207],a[188:191],v[204:207]
buffer_load_dwordx4 v240,s[16:19],s44 offen offset:2048 nt lds
M v[52:55],a[200:203],a[172:175],v[52:55]
v_lshlrev_b32 v247,16,v214
v_cvt_pk_bf16_f32 v168,v80,v81
M v[52:55],a[196:199],a[156:159],v[52:55]
buffer_load_dwordx4 v241,s[16:19],s44 offen offset:3072 nt lds
M v[52:55],a[192:195],a[140:143],v[52:55]
s_add_u32 s44,s44,16384
s_waitcnt lgkmcnt(1)
MS a[228:231],v[208:211],v[136:143],v255
ds_read_b128 a[192:195],v224 offset:57344
v_and_b32 v248,0xffff0000,v214
M a[32:35],a[208:211],v[128:131],a[32:35]
v_exp_f32 v84,v84
M a[32:35],a[212:215],v[132:135],a[32:35]
ds_read_b128 a[196:199],v225 offset:57344
v_rcp_f32 v248,v248
M a[36:39],a[212:215],v[140:143],a[36:39]
v_exp_f32 v85,v85
v_cvt_pk_bf16_f32 v169,v82,v83
M a[36:39],a[208:211],v[136:139],a[36:39]
ds_read_b128 a[200:203],v226 offset:57344
v_and_b32 v249,15,v242
M a[40:43],a[208:211],v[144:147],a[40:43]
v_exp_f32 v86,v86
M a[40:43],a[212:215],v[148:151],a[40:43]
ds_read_b128 a[204:207],v227 offset:57344
v_cmp_eq_u32 vcc,0,v249
M a[44:47],a[212:215],v[156:159],a[44:47]
v_exp_f32 v87,v87
v_lshlrev_b32 v246,4,v246
M a[44:47],a[208:211],v[152:155],a[44:47]
v_mov_b32 v249,41943040
v_cvt_pk_bf16_f32 v170,v84,v85
M a[60:63],a[216:219],v[152:155],a[60:63]
ds_read_b64_tr_b16 a[208:209],v232 offset:49152
v_cndmask_b32 v246,v249,v246,vcc
M a[60:63],a[220:223],v[156:159],a[60:63]
v_exp_f32 v88,v88
M a[56:59],a[220:223],v[148:151],a[56:59]
ds_read_b64_tr_b16 a[210:211],v232 offset:53248
v_exp_f32 v89,v89
M a[56:59],a[216:219],v[144:147],a[56:59]
M v[220:223],a[240:243],v[208:211],0
v_cvt_pk_bf16_f32 v171,v86,v87
M a[52:55],a[216:219],v[136:139],a[52:55]
ds_read_b64_tr_b16 a[212:213],v232 offset:57344
v_exp_f32 v90,v90
M a[52:55],a[220:223],v[140:143],a[52:55]
M v[216:219],a[240:243],a[244:247],0
M a[48:51],a[220:223],v[132:135],a[48:51]
ds_read_b64_tr_b16 a[214:215],v232 offset:61440
v_exp_f32 v91,v91
M a[48:51],a[216:219],v[128:131],a[48:51]
ds_read_b64_tr_b16 a[240:241],v244 offset:4096
v_cvt_pk_bf16_f32 v172,v88,v89
s_waitcnt lgkmcnt(5)
M v[8:11],a[192:195],a[128:131],v[192:195]
ds_read_b64_tr_b16 a[216:217],v233 offset:49152
v_exp_f32 v92,v92
M v[8:11],a[196:199],a[144:147],v[8:11]
ds_read_b64_tr_b16 a[242:243],v244 offset:4352
v_exp_f32 v93,v93
M v[8:11],a[200:203],a[160:163],v[8:11]
ds_read_b64_tr_b16 a[218:219],v233 offset:53248
v_cvt_pk_bf16_f32 v173,v90,v91
M v[8:11],a[204:207],a[176:179],v[8:11]
ds_read_b128 a[244:247],v245 offset:128
v_exp_f32 v94,v94
M v[24:27],a[204:207],a[180:183],v[196:199]
ds_read_b64_tr_b16 a[220:221],v233 offset:57344
v_exp_f32 v95,v95
M v[24:27],a[200:203],a[164:167],v[24:27]
v_cvt_pk_bf16_f32 v174,v92,v93
M v[24:27],a[196:199],a[148:151],v[24:27]
ds_read_b64_tr_b16 a[222:223],v233 offset:61440
M v[220:223],a[248:251],v[208:211],v[220:223]
M v[24:27],a[192:195],a[132:135],v[24:27]
v_exp_f32 v96,v96
M v[40:43],a[192:195],a[136:139],v[200:203]
M v[216:219],a[248:251],a[252:255],v[216:219]
M v[40:43],a[196:199],a[152:155],v[40:43]
v_exp_f32 v97,v97
v_cvt_pk_bf16_f32 v175,v94,v95
M v[40:43],a[200:203],a[168:171],v[40:43]
ds_read_b64_tr_b16 a[248:249],v244 offset:6144
M v[40:43],a[204:207],a[184:187],v[40:43]
v_exp_f32 v98,v98
M v[56:59],a[204:207],a[188:191],v[204:207]
v_exp_f32 v99,v99
M v[56:59],a[200:203],a[172:175],v[56:59]
ds_read_b64_tr_b16 a[250:251],v244 offset:6400
v_cvt_pk_bf16_f32 v176,v96,v97
M v[56:59],a[196:199],a[156:159],v[56:59]
v_exp_f32 v100,v100
M v[56:59],a[192:195],a[140:143],v[56:59]
ds_read_b128 a[252:255],v245 offset:192
s_waitcnt lgkmcnt(3)
MS a[232:235],v[208:211],v[144:151],v255
ds_read_b128 a[192:195],v224 offset:61440
v_exp_f32 v101,v101
M a[64:67],a[208:211],v[128:131],a[64:67]
v_cvt_pk_bf16_f32 v177,v98,v99
M a[64:67],a[212:215],v[132:135],a[64:67]
ds_read_b128 a[196:199],v225 offset:61440
v_exp_f32 v102,v102
M a[68:71],a[212:215],v[140:143],a[68:71]
M v[220:223],a[240:243],v[208:211],v[220:223]
M a[68:71],a[208:211],v[136:139],a[68:71]
ds_read_b128 a[200:203],v226 offset:61440
v_exp_f32 v103,v103
M a[72:75],a[208:211],v[144:147],a[72:75]
M v[216:219],a[240:243],a[244:247],v[216:219]
v_cvt_pk_bf16_f32 v178,v100,v101
M a[72:75],a[212:215],v[148:151],a[72:75]
ds_read_b128 a[204:207],v227 offset:61440
v_exp_f32 v104,v104
M a[76:79],a[212:215],v[156:159],a[76:79]
ds_read_b64_tr_b16 a[240:241],v244 offset:8192
v_exp_f32 v105,v105
M a[76:79],a[208:211],v[152:155],a[76:79]
ds_read_b64_tr_b16 a[242:243],v244 offset:8448
v_cvt_pk_bf16_f32 v179,v102,v103
M a[92:95],a[216:219],v[152:155],a[92:95]
ds_read_b64_tr_b16 a[208:209],v234 offset:49152
v_exp_f32 v106,v106
M a[92:95],a[220:223],v[156:159],a[92:95]
ds_read_b128 a[244:247],v245 offset:256
v_exp_f32 v107,v107
M a[88:91],a[220:223],v[148:151],a[88:91]
ds_read_b64_tr_b16 a[210:211],v234 offset:53248
v_cvt_pk_bf16_f32 v180,v104,v105
M a[88:91],a[216:219],v[144:147],a[88:91]
s_waitcnt lgkmcnt(9)
v_exp_f32 v108,v108
M a[84:87],a[216:219],v[136:139],a[84:87]
ds_read_b64_tr_b16 a[212:213],v234 offset:57344
M v[220:223],a[248:251],v[208:211],v[220:223]
M a[84:87],a[220:223],v[140:143],a[84:87]
v_exp_f32 v109,v109
M a[80:83],a[220:223],v[132:135],a[80:83]
ds_read_b64_tr_b16 a[214:215],v234 offset:61440
v_cvt_pk_bf16_f32 v181,v106,v107
M a[80:83],a[216:219],v[128:131],a[80:83]
M v[216:219],a[248:251],a[252:255],v[216:219]
s_waitcnt lgkmcnt(7)
M v[12:15],a[192:195],a[128:131],v[192:195]
ds_read_b64_tr_b16 a[216:217],v235 offset:49152
v_exp_f32 v110,v110
M v[12:15],a[196:199],a[144:147],v[12:15]
v_exp_f32 v111,v111
M v[12:15],a[200:203],a[160:163],v[12:15]
ds_read_b64_tr_b16 a[218:219],v235 offset:53248
s_waitcnt lgkmcnt(5)
M v[12:15],a[204:207],a[176:179],v[12:15]
M v[220:223],a[240:243],v[208:211],v[220:223]
M v[28:31],a[204:207],a[180:183],v[196:199]
ds_read_b64_tr_b16 a[220:221],v235 offset:57344
v_cvt_pk_bf16_f32 v182,v108,v109
M v[28:31],a[200:203],a[164:167],v[28:31]
v_exp_f32 v112,v112
M v[28:31],a[196:199],a[148:151],v[28:31]
ds_read_b64_tr_b16 a[222:223],v235 offset:61440
M v[216:219],a[240:243],a[244:247],v[216:219]
M v[28:31],a[192:195],a[132:135],v[28:31]
v_exp_f32 v113,v113
v_cvt_pk_bf16_f32 v183,v110,v111
M v[44:47],a[192:195],a[136:139],v[200:203]
s_lshl_b32 s50,s40,6
s_add_u32 s50,s50,s62
s_nop 5
M v[44:47],a[196:199],a[152:155],v[44:47]
v_exp_f32 v114,v114
M v[44:47],a[200:203],a[168:171],v[44:47]
v_exp_f32 v115,v115
M v[44:47],a[204:207],a[184:187],v[44:47]
v_fma_f32 v216,-v247,v220,v216
v_cvt_pk_bf16_f32 v184,v112,v113
M v[60:63],a[204:207],a[188:191],v[204:207]
v_exp_f32 v116,v116
M v[60:63],a[200:203],a[172:175],v[60:63]
v_fma_f32 v217,-v247,v221,v217
v_fma_f32 v218,-v247,v222,v218
M v[60:63],a[196:199],a[156:159],v[60:63]
v_exp_f32 v117,v117
M v[60:63],a[192:195],a[140:143],v[60:63]
v_fma_f32 v219,-v247,v223,v219
s_waitcnt lgkmcnt(0)
MS a[236:239],v[208:211],v[152:159],v255
s_barrier
v_cvt_pk_bf16_f32 v185,v114,v115
M a[96:99],a[208:211],v[128:131],a[96:99]
ds_read_b128 a[192:195],v224 offset:0
v_mul_f32 v216,v216,v248
M a[96:99],a[212:215],v[132:135],a[96:99]
v_exp_f32 v118,v118
M a[100:103],a[212:215],v[140:143],a[100:103]
ds_read_b128 a[196:199],v225 offset:0
v_mul_f32 v217,v217,v248
M a[100:103],a[208:211],v[136:139],a[100:103]
v_exp_f32 v119,v119
M a[104:107],a[208:211],v[144:147],a[104:107]
ds_read_b128 a[200:203],v226 offset:0
v_mul_f32 v218,v218,v248
M a[104:107],a[212:215],v[148:151],a[104:107]
v_cvt_pk_bf16_f32 v186,v116,v117
v_mul_f32 v219,v219,v248
M a[108:111],a[212:215],v[156:159],a[108:111]
ds_read_b128 a[204:207],v227 offset:0
v_exp_f32 v120,v120
M a[108:111],a[208:211],v[152:155],a[108:111]
buffer_store_dwordx4 v[216:219],v246,s[32:35],s50 offen sc1
M a[124:127],a[216:219],v[152:155],a[124:127]
ds_read_b64_tr_b16 a[208:209],v228 offset:0
v_exp_f32 v121,v121
M a[124:127],a[220:223],v[156:159],a[124:127]
v_cvt_pk_bf16_f32 v187,v118,v119
v_exp_f32 v122,v122
M a[120:123],a[220:223],v[148:151],a[120:123]
ds_read_b64_tr_b16 a[210:211],v228 offset:4096
v_exp_f32 v123,v123
M a[120:123],a[216:219],v[144:147],a[120:123]
v_cvt_pk_bf16_f32 v188,v120,v121
v_exp_f32 v124,v124
M a[116:119],a[216:219],v[136:139],a[116:119]
ds_read_b64_tr_b16 a[212:213],v228 offset:8192
v_exp_f32 v125,v125
M a[116:119],a[220:223],v[140:143],a[116:119]
v_cvt_pk_bf16_f32 v189,v122,v123
v_exp_f32 v126,v126
M a[112:115],a[220:223],v[132:135],a[112:115]
ds_read_b64_tr_b16 a[214:215],v228 offset:12288
v_exp_f32 v127,v127
M a[112:115],a[216:219],v[128:131],a[112:115]
v_cvt_pk_bf16_f32 v190,v124,v125
v_cvt_pk_bf16_f32 v191,v126,v127
s_waitcnt lgkmcnt(4)
M v[64:67],a[192:195],a[128:131],v[192:195]
ds_read_b64_tr_b16 a[216:217],v229 offset:0
v_exp_f32 v0,v0
M v[64:67],a[196:199],a[144:147],v[64:67]
v_exp_f32 v1,v1
M v[64:67],a[200:203],a[160:163],v[64:67]
ds_read_b64_tr_b16 a[218:219],v229 offset:4096
v_exp_f32 v2,v2
M v[64:67],a[204:207],a[176:179],v[64:67]
v_exp_f32 v3,v3
M v[80:83],a[204:207],a[180:183],v[196:199]
ds_read_b64_tr_b16 a[220:221],v229 offset:8192
v_cvt_pk_bf16_f32 v128,v0,v1
M v[80:83],a[200:203],a[164:167],v[80:83]
v_exp_f32 v4,v4
M v[80:83],a[196:199],a[148:151],v[80:83]
ds_read_b64_tr_b16 a[222:223],v229 offset:12288
s_add_u32 m0,s48,49152
M v[80:83],a[192:195],a[132:135],v[80:83]
v_exp_f32 v5,v5
M v[96:99],a[192:195],a[136:139],v[200:203]
buffer_load_dwordx4 v236,s[12:15],s43 offen offset:0 nt lds
M v[96:99],a[196:199],a[152:155],v[96:99]
v_cvt_pk_bf16_f32 v129,v2,v3
M v[96:99],a[200:203],a[168:171],v[96:99]
buffer_load_dwordx4 v237,s[12:15],s43 offen offset:1024 nt lds
M v[96:99],a[204:207],a[184:187],v[96:99]
v_exp_f32 v6,v6
M v[112:115],a[204:207],a[188:191],v[204:207]
buffer_load_dwordx4 v238,s[12:15],s43 offen offset:2048 nt lds
M v[112:115],a[200:203],a[172:175],v[112:115]
v_exp_f32 v7,v7
M v[112:115],a[196:199],a[156:159],v[112:115]
buffer_load_dwordx4 v239,s[12:15],s43 offen offset:3072 nt lds
M v[112:115],a[192:195],a[140:143],v[112:115]
s_add_u32 s43,s43,16384
s_waitcnt lgkmcnt(0)
MS a[224:227],v[208:211],v[160:167],v255
ds_read_b128 a[192:195],v224 offset:4096
v_cvt_pk_bf16_f32 v130,v4,v5
M a[0:3],a[208:211],v[160:163],a[0:3]
v_exp_f32 v8,v8
M a[0:3],a[212:215],v[164:167],a[0:3]
ds_read_b128 a[196:199],v225 offset:4096
M a[4:7],a[212:215],v[172:175],a[4:7]
v_exp_f32 v9,v9
M a[4:7],a[208:211],v[168:171],a[4:7]
ds_read_b128 a[200:203],v226 offset:4096
v_cvt_pk_bf16_f32 v131,v6,v7
M a[8:11],a[208:211],v[176:179],a[8:11]
v_exp_f32 v10,v10
M a[8:11],a[212:215],v[180:183],a[8:11]
ds_read_b128 a[204:207],v227 offset:4096
v_exp_f32 v11,v11
M a[12:15],a[212:215],v[188:191],a[12:15]
v_cvt_pk_bf16_f32 v132,v8,v9
v_exp_f32 v12,v12
M a[12:15],a[208:211],v[184:187],a[12:15]
v_exp_f32 v13,v13
M a[28:31],a[216:219],v[184:187],a[28:31]
ds_read_b64_tr_b16 a[208:209],v230 offset:0
v_cvt_pk_bf16_f32 v133,v10,v11
M a[28:31],a[220:223],v[188:191],a[28:31]
v_exp_f32 v14,v14
M a[24:27],a[220:223],v[180:183],a[24:27]
ds_read_b64_tr_b16 a[210:211],v230 offset:4096
M a[24:27],a[216:219],v[176:179],a[24:27]
v_exp_f32 v15,v15
M a[20:23],a[216:219],v[168:171],a[20:23]
ds_read_b64_tr_b16 a[212:213],v230 offset:8192
v_cvt_pk_bf16_f32 v134,v12,v13
M a[20:23],a[220:223],v[172:175],a[20:23]
v_exp_f32 v16,v16
M a[16:19],a[220:223],v[164:167],a[16:19]
ds_read_b64_tr_b16 a[214:215],v230 offset:12288
M a[16:19],a[216:219],v[160:163],a[16:19]
v_exp_f32 v17,v17
s_waitcnt lgkmcnt(4)
M v[68:71],a[192:195],a[128:131],v[192:195]
ds_read_b64_tr_b16 a[216:217],v231 offset:0
v_cvt_pk_bf16_f32 v135,v14,v15
M v[68:71],a[196:199],a[144:147],v[68:71]
v_exp_f32 v18,v18
M v[68:71],a[200:203],a[160:163],v[68:71]
ds_read_b64_tr_b16 a[218:219],v231 offset:4096
M v[68:71],a[204:207],a[176:179],v[68:71]
v_exp_f32 v19,v19
M v[84:87],a[204:207],a[180:183],v[196:199]
ds_read_b64_tr_b16 a[220:221],v231 offset:8192
v_cvt_pk_bf16_f32 v136,v16,v17
M v[84:87],a[200:203],a[164:167],v[84:87]
v_exp_f32 v20,v20
M v[84:87],a[196:199],a[148:151],v[84:87]
ds_read_b64_tr_b16 a[222:223],v231 offset:12288
s_add_u32 m0,s48,114688
M v[84:87],a[192:195],a[132:135],v[84:87]
v_exp_f32 v21,v21
M v[100:103],a[192:195],a[136:139],v[200:203]
buffer_load_dwordx4 v240,s[16:19],s44 offen offset:0 nt lds
M v[100:103],a[196:199],a[152:155],v[100:103]
v_cvt_pk_bf16_f32 v137,v18,v19
M v[100:103],a[200:203],a[168:171],v[100:103]
buffer_load_dwordx4 v241,s[16:19],s44 offen offset:1024 nt lds
M v[100:103],a[204:207],a[184:187],v[100:103]
v_exp_f32 v22,v22
M v[116:119],a[204:207],a[188:191],v[204:207]
buffer_load_dwordx4 v240,s[16:19],s44 offen offset:2048 nt lds
M v[116:119],a[200:203],a[172:175],v[116:119]
v_exp_f32 v23,v23
M v[116:119],a[196:199],a[156:159],v[116:119]
buffer_load_dwordx4 v241,s[16:19],s44 offen offset:3072 nt lds
M v[116:119],a[192:195],a[140:143],v[116:119]
s_add_u32 s44,s44,16384
s_waitcnt lgkmcnt(0)
MS a[228:231],v[208:211],v[168:175],v255
ds_read_b128 a[192:195],v224 offset:8192
v_cvt_pk_bf16_f32 v138,v20,v21
M a[32:35],a[208:211],v[160:163],a[32:35]
v_exp_f32 v24,v24
M a[32:35],a[212:215],v[164:167],a[32:35]
ds_read_b128 a[196:199],v225 offset:8192
M a[36:39],a[212:215],v[172:175],a[36:39]
v_exp_f32 v25,v25
M a[36:39],a[208:211],v[168:171],a[36:39]
ds_read_b128 a[200:203],v226 offset:8192
v_cvt_pk_bf16_f32 v139,v22,v23
M a[40:43],a[208:211],v[176:179],a[40:43]
v_exp_f32 v26,v26
M a[40:43],a[212:215],v[180:183],a[40:43]
ds_read_b128 a[204:207],v227 offset:8192
M a[44:47],a[212:215],v[188:191],a[44:47]
v_exp_f32 v27,v27
M a[44:47],a[208:211],v[184:187],a[44:47]
v_lshlrev_b32 v244,4,v242
v_cvt_pk_bf16_f32 v140,v24,v25
M a[60:63],a[216:219],v[184:187],a[60:63]
ds_read_b64_tr_b16 a[208:209],v232 offset:0
M a[60:63],a[220:223],v[188:191],a[60:63]
v_exp_f32 v28,v28
M a[56:59],a[220:223],v[180:183],a[56:59]
ds_read_b64_tr_b16 a[210:211],v232 offset:4096
M a[56:59],a[216:219],v[176:179],a[56:59]
v_exp_f32 v29,v29
M a[52:55],a[216:219],v[168:171],a[52:55]
ds_read_b64_tr_b16 a[212:213],v232 offset:8192
M a[52:55],a[220:223],v[172:175],a[52:55]
s_lshl_b32 s51,s40,10
s_add_u32 m0,s51,153600
s_add_u32 s50,s64,s51
s_add_u32 s50,s50,0
buffer_load_dwordx4 v244,s[28:31],s50 offen nt lds
M a[48:51],a[220:223],v[164:167],a[48:51]
ds_read_b64_tr_b16 a[214:215],v232 offset:12288
M a[48:51],a[216:219],v[160:163],a[48:51]
v_cvt_pk_bf16_f32 v141,v26,v27
s_waitcnt lgkmcnt(4)
M v[72:75],a[192:195],a[128:131],v[192:195]
ds_read_b64_tr_b16 a[216:217],v233 offset:0
v_exp_f32 v30,v30
M v[72:75],a[196:199],a[144:147],v[72:75]
v_exp_f32 v31,v31
M v[72:75],a[200:203],a[160:163],v[72:75]
ds_read_b64_tr_b16 a[218:219],v233 offset:4096
v_cvt_pk_bf16_f32 v142,v28,v29
M v[72:75],a[204:207],a[176:179],v[72:75]
v_exp_f32 v32,v32
M v[88:91],a[204:207],a[180:183],v[196:199]
ds_read_b64_tr_b16 a[220:221],v233 offset:8192
M v[88:91],a[200:203],a[164:167],v[88:91]
v_exp_f32 v33,v33
M v[88:91],a[196:199],a[148:151],v[88:91]
ds_read_b64_tr_b16 a[222:223],v233 offset:12288
v_cvt_pk_bf16_f32 v143,v30,v31
M v[88:91],a[192:195],a[132:135],v[88:91]
v_exp_f32 v34,v34
M v[104:107],a[192:195],a[136:139],v[200:203]
v_exp_f32 v35,v35
M v[104:107],a[196:199],a[152:155],v[104:107]
v_cvt_pk_bf16_f32 v144,v32,v33
M v[104:107],a[200:203],a[168:171],v[104:107]
v_exp_f32 v36,v36
M v[104:107],a[204:207],a[184:187],v[104:107]
v_exp_f32 v37,v37
M v[120:123],a[204:207],a[188:191],v[204:207]
v_cvt_pk_bf16_f32 v145,v34,v35
M v[120:123],a[200:203],a[172:175],v[120:123]
v_exp_f32 v38,v38
M v[120:123],a[196:199],a[156:159],v[120:123]
v_exp_f32 v39,v39
M v[120:123],a[192:195],a[140:143],v[120:123]
v_cvt_pk_bf16_f32 v146,v36,v37
s_waitcnt lgkmcnt(0)
MS a[232:235],v[208:211],v[176:183],v255
ds_read_b128 a[192:195],v224 offset:12288
M a[64:67],a[208:211],v[160:163],a[64:67]
v_exp_f32 v40,v40
M a[64:67],a[212:215],v[164:167],a[64:67]
ds_read_b128 a[196:199],v225 offset:12288
M a[68:71],a[212:215],v[172:175],a[68:71]
s_lshl_b32 s51,s40,10
s_add_u32 m0,s51,157696
s_add_u32 s50,s64,s51
s_add_u32 s50,s50,4096
buffer_load_dwordx4 v244,s[28:31],s50 offen nt lds
M a[68:71],a[208:211],v[168:171],a[68:71]
ds_read_b128 a[200:203],v226 offset:12288
M a[72:75],a[208:211],v[176:179],a[72:75]
v_exp_f32 v41,v41
M a[72:75],a[212:215],v[180:183],a[72:75]
ds_read_b128 a[204:207],v227 offset:12288
v_cvt_pk_bf16_f32 v147,v38,v39
M a[76:79],a[212:215],v[188:191],a[76:79]
v_exp_f32 v42,v42
M a[76:79],a[208:211],v[184:187],a[76:79]
v_exp_f32 v43,v43
M a[92:95],a[216:219],v[184:187],a[92:95]
ds_read_b64_tr_b16 a[208:209],v234 offset:0
v_cvt_pk_bf16_f32 v148,v40,v41
M a[92:95],a[220:223],v[188:191],a[92:95]
v_exp_f32 v44,v44
M a[88:91],a[220:223],v[180:183],a[88:91]
ds_read_b64_tr_b16 a[210:211],v234 offset:4096
M a[88:91],a[216:219],v[176:179],a[88:91]
v_exp_f32 v45,v45
M a[84:87],a[216:219],v[168:171],a[84:87]
ds_read_b64_tr_b16 a[212:213],v234 offset:8192
v_cvt_pk_bf16_f32 v149,v42,v43
M a[84:87],a[220:223],v[172:175],a[84:87]
v_exp_f32 v46,v46
M a[80:83],a[220:223],v[164:167],a[80:83]
ds_read_b64_tr_b16 a[214:215],v234 offset:12288
M a[80:83],a[216:219],v[160:163],a[80:83]
v_exp_f32 v47,v47
s_waitcnt lgkmcnt(4)
M v[76:79],a[192:195],a[128:131],v[192:195]
ds_read_b64_tr_b16 a[216:217],v235 offset:0
v_cvt_pk_bf16_f32 v150,v44,v45
M v[76:79],a[196:199],a[144:147],v[76:79]
v_exp_f32 v48,v48
M v[76:79],a[200:203],a[160:163],v[76:79]
ds_read_b64_tr_b16 a[218:219],v235 offset:4096
M v[76:79],a[204:207],a[176:179],v[76:79]
v_exp_f32 v49,v49
M v[92:95],a[204:207],a[180:183],v[196:199]
ds_read_b64_tr_b16 a[220:221],v235 offset:8192
v_cvt_pk_bf16_f32 v151,v46,v47
M v[92:95],a[200:203],a[164:167],v[92:95]
v_exp_f32 v50,v50
M v[92:95],a[196:199],a[148:151],v[92:95]
ds_read_b64_tr_b16 a[222:223],v235 offset:12288
M v[92:95],a[192:195],a[132:135],v[92:95]
v_exp_f32 v51,v51
M v[108:111],a[192:195],a[136:139],v[200:203]
s_and_b32 s51,s40,1
s_lshl_b32 s51,s51,10
s_add_u32 m0,s51,161792
s_add_u32 s50,s64,s51
s_add_u32 s50,s50,8192
buffer_load_dwordx4 v244,s[28:31],s50 offen nt lds
M v[108:111],a[196:199],a[152:155],v[108:111]
v_cvt_pk_bf16_f32 v152,v48,v49
M v[108:111],a[200:203],a[168:171],v[108:111]
v_exp_f32 v52,v52
M v[108:111],a[204:207],a[184:187],v[108:111]
v_exp_f32 v53,v53
M v[124:127],a[204:207],a[188:191],v[204:207]
v_cvt_pk_bf16_f32 v153,v50,v51
M v[124:127],a[200:203],a[172:175],v[124:127]
v_exp_f32 v54,v54
M v[124:127],a[196:199],a[156:159],v[124:127]
v_exp_f32 v55,v55
M v[124:127],a[192:195],a[140:143],v[124:127]
s_waitcnt vmcnt(11)
s_waitcnt lgkmcnt(0)
MS a[236:239],v[208:211],v[184:191],v255
s_barrier
M a[96:99],a[208:211],v[160:163],a[96:99]
ds_read_b128 a[192:195],v224 offset:16384
v_cvt_pk_bf16_f32 v154,v52,v53
M a[96:99],a[212:215],v[164:167],a[96:99]
v_exp_f32 v56,v56
M a[100:103],a[212:215],v[172:175],a[100:103]
ds_read_b128 a[196:199],v225 offset:16384
M a[100:103],a[208:211],v[168:171],a[100:103]
v_exp_f32 v57,v57
M a[104:107],a[208:211],v[176:179],a[104:107]
ds_read_b128 a[200:203],v226 offset:16384
v_cvt_pk_bf16_f32 v155,v54,v55
M a[104:107],a[212:215],v[180:183],a[104:107]
v_exp_f32 v58,v58
M a[108:111],a[212:215],v[188:191],a[108:111]
ds_read_b128 a[204:207],v227 offset:16384
M a[108:111],a[208:211],v[184:187],a[108:111]
v_exp_f32 v59,v59
M a[124:127],a[216:219],v[184:187],a[124:127]
ds_read_b64_tr_b16 a[208:209],v228 offset:16384
v_cvt_pk_bf16_f32 v156,v56,v57
M a[124:127],a[220:223],v[188:191],a[124:127]
v_exp_f32 v60,v60
M a[120:123],a[220:223],v[180:183],a[120:123]
ds_read_b64_tr_b16 a[210:211],v228 offset:20480
M a[120:123],a[216:219],v[176:179],a[120:123]
v_exp_f32 v61,v61
M a[116:119],a[216:219],v[168:171],a[116:119]
ds_read_b64_tr_b16 a[212:213],v228 offset:24576
v_cvt_pk_bf16_f32 v157,v58,v59
M a[116:119],a[220:223],v[172:175],a[116:119]
v_exp_f32 v62,v62
M a[112:115],a[220:223],v[164:167],a[112:115]
ds_read_b64_tr_b16 a[214:215],v228 offset:28672
v_exp_f32 v63,v63
M a[112:115],a[216:219],v[160:163],a[112:115]
v_cvt_pk_bf16_f32 v158,v60,v61
v_cvt_pk_bf16_f32 v159,v62,v63
s_waitcnt lgkmcnt(4)
M v[0:3],a[192:195],a[128:131],v[192:195]
ds_read_b64_tr_b16 a[216:217],v229 offset:16384
M v[0:3],a[196:199],a[144:147],v[0:3]
v_exp_f32 v64,v64
M v[0:3],a[200:203],a[160:163],v[0:3]
ds_read_b64_tr_b16 a[218:219],v229 offset:20480
M v[0:3],a[204:207],a[176:179],v[0:3]
v_exp_f32 v65,v65
M v[16:19],a[204:207],a[180:183],v[196:199]
ds_read_b64_tr_b16 a[220:221],v229 offset:24576
v_lshlrev_b32 v252,12,v242
M v[16:19],a[200:203],a[164:167],v[16:19]
v_exp_f32 v66,v66
M v[16:19],a[196:199],a[148:151],v[16:19]
ds_read_b64_tr_b16 a[222:223],v229 offset:28672
s_add_u32 m0,s48,0
M v[16:19],a[192:195],a[132:135],v[16:19]
v_exp_f32 v67,v67
M v[32:35],a[192:195],a[136:139],v[200:203]
buffer_load_dwordx4 v236,s[12:15],s43 offen offset:0 nt lds
M v[32:35],a[196:199],a[152:155],v[32:35]
v_mov_b32 v253,1
v_cvt_pk_bf16_f32 v160,v64,v65
M v[32:35],a[200:203],a[168:171],v[32:35]
buffer_load_dwordx4 v237,s[12:15],s43 offen offset:1024 nt lds
M v[32:35],a[204:207],a[184:187],v[32:35]
v_exp_f32 v68,v68
M v[48:51],a[204:207],a[188:191],v[204:207]
buffer_load_dwordx4 v238,s[12:15],s43 offen offset:2048 nt lds
M v[48:51],a[200:203],a[172:175],v[48:51]
v_exp_f32 v69,v69
M v[48:51],a[196:199],a[156:159],v[48:51]
buffer_load_dwordx4 v239,s[12:15],s43 offen offset:3072 nt lds
M v[48:51],a[192:195],a[140:143],v[48:51]
s_add_u32 s43,s43,16384
s_waitcnt lgkmcnt(0)
MS a[224:227],v[208:211],v[128:135],v255
ds_read_b128 a[192:195],v224 offset:20480
M a[0:3],a[208:211],v[128:131],a[0:3]
s_cmp_eq_u32 s60,0
s_cselect_b32 s50,0,0x1000
buffer_atomic_add v253,v252,s[36:39],s50 offen offset:128
M a[0:3],a[212:215],v[132:135],a[0:3]
ds_read_b128 a[196:199],v225 offset:20480
v_cvt_pk_bf16_f32 v161,v66,v67
M a[4:7],a[212:215],v[140:143],a[4:7]
v_exp_f32 v70,v70
M a[4:7],a[208:211],v[136:139],a[4:7]
ds_read_b128 a[200:203],v226 offset:20480
M a[8:11],a[208:211],v[144:147],a[8:11]
v_exp_f32 v71,v71
M a[8:11],a[212:215],v[148:151],a[8:11]
ds_read_b128 a[204:207],v227 offset:20480
v_cvt_pk_bf16_f32 v162,v68,v69
M a[12:15],a[212:215],v[156:159],a[12:15]
v_exp_f32 v72,v72
M a[12:15],a[208:211],v[152:155],a[12:15]
v_exp_f32 v73,v73
M a[28:31],a[216:219],v[152:155],a[28:31]
ds_read_b64_tr_b16 a[208:209],v230 offset:16384
v_cvt_pk_bf16_f32 v163,v70,v71
M a[28:31],a[220:223],v[156:159],a[28:31]
v_exp_f32 v74,v74
M a[24:27],a[220:223],v[148:151],a[24:27]
ds_read_b64_tr_b16 a[210:211],v230 offset:20480
v_exp_f32 v75,v75
M a[24:27],a[216:219],v[144:147],a[24:27]
s_and_b32 s50,s2,1
s_lshl_b32 s50,s50,3
s_bfe_u32 s51,s2,0x30003
s_add_u32 s55,s50,s51
M a[20:23],a[216:219],v[136:139],a[20:23]
ds_read_b64_tr_b16 a[212:213],v230 offset:24576
v_cvt_pk_bf16_f32 v164,v72,v73
M a[20:23],a[220:223],v[140:143],a[20:23]
v_exp_f32 v76,v76
M a[16:19],a[220:223],v[132:135],a[16:19]
ds_read_b64_tr_b16 a[214:215],v230 offset:28672
v_exp_f32 v77,v77
M a[16:19],a[216:219],v[128:131],a[16:19]
v_cvt_pk_bf16_f32 v165,v74,v75
s_waitcnt lgkmcnt(4)
M v[4:7],a[192:195],a[128:131],v[192:195]
ds_read_b64_tr_b16 a[216:217],v231 offset:16384
M v[4:7],a[196:199],a[144:147],v[4:7]
v_exp_f32 v78,v78
M v[4:7],a[200:203],a[160:163],v[4:7]
ds_read_b64_tr_b16 a[218:219],v231 offset:20480
M v[4:7],a[204:207],a[176:179],v[4:7]
v_exp_f32 v79,v79
M v[20:23],a[204:207],a[180:183],v[196:199]
ds_read_b64_tr_b16 a[220:221],v231 offset:24576
v_cvt_pk_bf16_f32 v166,v76,v77
M v[20:23],a[200:203],a[164:167],v[20:23]
v_exp_f32 v80,v80
M v[20:23],a[196:199],a[148:151],v[20:23]
ds_read_b64_tr_b16 a[222:223],v231 offset:28672
s_add_u32 m0,s48,65536
M v[20:23],a[192:195],a[132:135],v[20:23]
v_exp_f32 v81,v81
M v[36:39],a[192:195],a[136:139],v[200:203]
buffer_load_dwordx4 v240,s[16:19],s44 offen offset:0 nt lds
M v[36:39],a[196:199],a[152:155],v[36:39]
v_cvt_pk_bf16_f32 v167,v78,v79
M v[36:39],a[200:203],a[168:171],v[36:39]
buffer_load_dwordx4 v241,s[16:19],s44 offen offset:1024 nt lds
M v[36:39],a[204:207],a[184:187],v[36:39]
s_bfe_u32 s50,s2,0x10001
s_lshl_b32 s50,s50,2
s_lshr_b32 s51,s2,6
s_add_u32 s54,s50,s51
M v[52:55],a[204:207],a[188:191],v[204:207]
buffer_load_dwordx4 v240,s[16:19],s44 offen offset:2048 nt lds
M v[52:55],a[200:203],a[172:175],v[52:55]
v_exp_f32 v82,v82
M v[52:55],a[196:199],a[156:159],v[52:55]
buffer_load_dwordx4 v241,s[16:19],s44 offen offset:3072 nt lds
M v[52:55],a[192:195],a[140:143],v[52:55]
s_add_u32 s44,s44,16384
s_waitcnt lgkmcnt(0)
MS a[228:231],v[208:211],v[136:143],v255
ds_read_b128 a[192:195],v224 offset:24576
M a[32:35],a[208:211],v[128:131],a[32:35]
v_exp_f32 v83,v83
M a[32:35],a[212:215],v[132:135],a[32:35]
ds_read_b128 a[196:199],v225 offset:24576
v_cvt_pk_bf16_f32 v168,v80,v81
M a[36:39],a[212:215],v[140:143],a[36:39]
v_exp_f32 v84,v84
M a[36:39],a[208:211],v[136:139],a[36:39]
ds_read_b128 a[200:203],v226 offset:24576
M a[40:43],a[208:211],v[144:147],a[40:43]
v_exp_f32 v85,v85
M a[40:43],a[212:215],v[148:151],a[40:43]
ds_read_b128 a[204:207],v227 offset:24576
v_cvt_pk_bf16_f32 v169,v82,v83
M a[44:47],a[212:215],v[156:159],a[44:47]
v_exp_f32 v86,v86
M a[44:47],a[208:211],v[152:155],a[44:47]
v_exp_f32 v87,v87
M a[60:63],a[216:219],v[152:155],a[60:63]
ds_read_b64_tr_b16 a[208:209],v232 offset:16384
v_cvt_pk_bf16_f32 v170,v84,v85
M a[60:63],a[220:223],v[156:159],a[60:63]
v_exp_f32 v88,v88
M a[56:59],a[220:223],v[148:151],a[56:59]
ds_read_b64_tr_b16 a[210:211],v232 offset:20480
M a[56:59],a[216:219],v[144:147],a[56:59]
s_bfe_u32 s50,s2,0x10002
s_xor_b32 s50,s50,1
s_lshl_b32 s50,s50,2
s_add_u32 s50,s50,s40
s_lshl_b32 s52,s50,4
s_lshl_b32 s50,s54,7
s_add_u32 s50,s50,s52
s_mul_i32 s46,s50,5120
s_add_u32 s46,s46,16777216
M a[52:55],a[216:219],v[136:139],a[52:55]
ds_read_b64_tr_b16 a[212:213],v232 offset:24576
M a[52:55],a[220:223],v[140:143],a[52:55]
v_exp_f32 v89,v89
M a[48:51],a[220:223],v[132:135],a[48:51]
ds_read_b64_tr_b16 a[214:215],v232 offset:28672
v_cvt_pk_bf16_f32 v171,v86,v87
M a[48:51],a[216:219],v[128:131],a[48:51]
v_exp_f32 v90,v90
s_waitcnt lgkmcnt(4)
M v[8:11],a[192:195],a[128:131],v[192:195]
ds_read_b64_tr_b16 a[216:217],v233 offset:16384
M v[8:11],a[196:199],a[144:147],v[8:11]
v_exp_f32 v91,v91
M v[8:11],a[200:203],a[160:163],v[8:11]
ds_read_b64_tr_b16 a[218:219],v233 offset:20480
v_cvt_pk_bf16_f32 v172,v88,v89
M v[8:11],a[204:207],a[176:179],v[8:11]
v_exp_f32 v92,v92
M v[24:27],a[204:207],a[180:183],v[196:199]
ds_read_b64_tr_b16 a[220:221],v233 offset:24576
M v[24:27],a[200:203],a[164:167],v[24:27]
v_exp_f32 v93,v93
M v[24:27],a[196:199],a[148:151],v[24:27]
ds_read_b64_tr_b16 a[222:223],v233 offset:28672
v_cvt_pk_bf16_f32 v173,v90,v91
M v[24:27],a[192:195],a[132:135],v[24:27]
v_exp_f32 v94,v94
M v[40:43],a[192:195],a[136:139],v[200:203]
v_exp_f32 v95,v95
M v[40:43],a[196:199],a[152:155],v[40:43]
v_cvt_pk_bf16_f32 v174,v92,v93
M v[40:43],a[200:203],a[168:171],v[40:43]
v_exp_f32 v96,v96
M v[40:43],a[204:207],a[184:187],v[40:43]
v_exp_f32 v97,v97
M v[56:59],a[204:207],a[188:191],v[204:207]
v_cvt_pk_bf16_f32 v175,v94,v95
M v[56:59],a[200:203],a[172:175],v[56:59]
v_exp_f32 v98,v98
M v[56:59],a[196:199],a[156:159],v[56:59]
v_exp_f32 v99,v99
M v[56:59],a[192:195],a[140:143],v[56:59]
v_cvt_pk_bf16_f32 v176,v96,v97
s_waitcnt lgkmcnt(0)
MS a[232:235],v[208:211],v[144:151],v255
ds_read_b128 a[192:195],v224 offset:28672
v_exp_f32 v100,v100
M a[64:67],a[208:211],v[128:131],a[64:67]
v_exp_f32 v101,v101
M a[64:67],a[212:215],v[132:135],a[64:67]
ds_read_b128 a[196:199],v225 offset:28672
v_cvt_pk_bf16_f32 v177,v98,v99
M a[68:71],a[212:215],v[140:143],a[68:71]
v_exp_f32 v102,v102
M a[68:71],a[208:211],v[136:139],a[68:71]
ds_read_b128 a[200:203],v226 offset:28672
s_and_b32 s69,s54,0
s_mul_i32 s50,s69,40960
s_sub_u32 s68,s46,s50
s_add_u32 s46,s46,s50
s_lshl_b32 s69,s69,16
M a[72:75],a[208:211],v[144:147],a[72:75]
v_exp_f32 v103,v103
M a[72:75],a[212:215],v[148:151],a[72:75]
ds_read_b128 a[204:207],v227 offset:28672
v_cvt_pk_bf16_f32 v178,v100,v101
M a[76:79],a[212:215],v[156:159],a[76:79]
v_exp_f32 v104,v104
M a[76:79],a[208:211],v[152:155],a[76:79]
v_exp_f32 v105,v105
M a[92:95],a[216:219],v[152:155],a[92:95]
ds_read_b64_tr_b16 a[208:209],v234 offset:16384
v_cvt_pk_bf16_f32 v179,v102,v103
M a[92:95],a[220:223],v[156:159],a[92:95]
v_exp_f32 v106,v106
M a[88:91],a[220:223],v[148:151],a[88:91]
ds_read_b64_tr_b16 a[210:211],v234 offset:20480
M a[88:91],a[216:219],v[144:147],a[88:91]
v_exp_f32 v107,v107
M a[84:87],a[216:219],v[136:139],a[84:87]
ds_read_b64_tr_b16 a[212:213],v234 offset:24576
v_cvt_pk_bf16_f32 v180,v104,v105
M a[84:87],a[220:223],v[140:143],a[84:87]
v_exp_f32 v108,v108
M a[80:83],a[220:223],v[132:135],a[80:83]
ds_read_b64_tr_b16 a[214:215],v234 offset:28672
v_exp_f32 v109,v109
M a[80:83],a[216:219],v[128:131],a[80:83]
v_cvt_pk_bf16_f32 v181,v106,v107
s_waitcnt lgkmcnt(4)
M v[12:15],a[192:195],a[128:131],v[192:195]
ds_read_b64_tr_b16 a[216:217],v235 offset:16384
v_exp_f32 v110,v110
M v[12:15],a[196:199],a[144:147],v[12:15]
s_lshl_b32 s53,s55,13
s_lshl_b32 s50,s52,5
s_add_u32 s53,s53,s50
s_add_u32 s53,s53,25427968
M v[12:15],a[200:203],a[160:163],v[12:15]
ds_read_b64_tr_b16 a[218:219],v235 offset:20480
M v[12:15],a[204:207],a[176:179],v[12:15]
v_exp_f32 v111,v111
M v[28:31],a[204:207],a[180:183],v[196:199]
ds_read_b64_tr_b16 a[220:221],v235 offset:24576
v_cvt_pk_bf16_f32 v182,v108,v109
M v[28:31],a[200:203],a[164:167],v[28:31]
v_exp_f32 v112,v112
M v[28:31],a[196:199],a[148:151],v[28:31]
ds_read_b64_tr_b16 a[222:223],v235 offset:28672
v_exp_f32 v113,v113
M v[28:31],a[192:195],a[132:135],v[28:31]
v_cvt_pk_bf16_f32 v183,v110,v111
M v[44:47],a[192:195],a[136:139],v[200:203]
v_exp_f32 v114,v114
M v[44:47],a[196:199],a[152:155],v[44:47]
v_exp_f32 v115,v115
M v[44:47],a[200:203],a[168:171],v[44:47]
v_cvt_pk_bf16_f32 v184,v112,v113
M v[44:47],a[204:207],a[184:187],v[44:47]
v_exp_f32 v116,v116
M v[60:63],a[204:207],a[188:191],v[204:207]
v_exp_f32 v117,v117
M v[60:63],a[200:203],a[172:175],v[60:63]
v_lshlrev_b32 v243,4,v242
v_cvt_pk_bf16_f32 v185,v114,v115
M v[60:63],a[196:199],a[156:159],v[60:63]
v_exp_f32 v118,v118
M v[60:63],a[192:195],a[140:143],v[60:63]
v_lshlrev_b32 v252,12,v242
s_waitcnt lgkmcnt(0)
MS a[236:239],v[208:211],v[152:159],v255
s_barrier
v_exp_f32 v119,v119
M a[96:99],a[208:211],v[128:131],a[96:99]
ds_read_b128 a[192:195],v224 offset:32768
v_cvt_pk_bf16_f32 v186,v116,v117
M a[96:99],a[212:215],v[132:135],a[96:99]
v_exp_f32 v120,v120
M a[100:103],a[212:215],v[140:143],a[100:103]
ds_read_b128 a[196:199],v225 offset:32768
v_mov_b32 v253,1
M a[100:103],a[208:211],v[136:139],a[100:103]
v_exp_f32 v121,v121
M a[104:107],a[208:211],v[144:147],a[104:107]
ds_read_b128 a[200:203],v226 offset:32768
v_cvt_pk_bf16_f32 v187,v118,v119
M a[104:107],a[212:215],v[148:151],a[104:107]
s_cmp_eq_u32 s60,1
s_cselect_b32 s50,0,0x1000
buffer_atomic_add v253,v252,s[36:39],s50 offen offset:128
M a[108:111],a[212:215],v[156:159],a[108:111]
ds_read_b128 a[204:207],v227 offset:32768
v_exp_f32 v122,v122
M a[108:111],a[208:211],v[152:155],a[108:111]
v_exp_f32 v123,v123
M a[124:127],a[216:219],v[152:155],a[124:127]
ds_read_b64_tr_b16 a[208:209],v228 offset:32768
v_cvt_pk_bf16_f32 v188,v120,v121
M a[124:127],a[220:223],v[156:159],a[124:127]
v_exp_f32 v124,v124
M a[120:123],a[220:223],v[148:151],a[120:123]
ds_read_b64_tr_b16 a[210:211],v228 offset:36864
M a[120:123],a[216:219],v[144:147],a[120:123]
v_exp_f32 v125,v125
M a[116:119],a[216:219],v[136:139],a[116:119]
ds_read_b64_tr_b16 a[212:213],v228 offset:40960
v_cvt_pk_bf16_f32 v189,v122,v123
M a[116:119],a[220:223],v[140:143],a[116:119]
v_exp_f32 v126,v126
M a[112:115],a[220:223],v[132:135],a[112:115]
ds_read_b64_tr_b16 a[214:215],v228 offset:45056
v_exp_f32 v127,v127
M a[112:115],a[216:219],v[128:131],a[112:115]
v_cvt_pk_bf16_f32 v190,v124,v125
v_cvt_pk_bf16_f32 v191,v126,v127
s_mov_b32 s61,5
.p2align 6
L_loop:
s_waitcnt lgkmcnt(4)
M v[64:67],a[192:195],a[128:131],v[192:195]
ds_read_b64_tr_b16 a[216:217],v229 offset:32768
M v[64:67],a[196:199],a[144:147],v[64:67]
v_exp_f32 v0,v0
M v[64:67],a[200:203],a[160:163],v[64:67]
ds_read_b64_tr_b16 a[218:219],v229 offset:36864
M v[64:67],a[204:207],a[176:179],v[64:67]
v_exp_f32 v1,v1
M v[80:83],a[204:207],a[180:183],v[196:199]
ds_read_b64_tr_b16 a[220:221],v229 offset:40960
M v[80:83],a[200:203],a[164:167],v[80:83]
v_exp_f32 v2,v2
M v[80:83],a[196:199],a[148:151],v[80:83]
ds_read_b64_tr_b16 a[222:223],v229 offset:45056
s_add_u32 m0,s48,16384
M v[80:83],a[192:195],a[132:135],v[80:83]
v_exp_f32 v3,v3
M v[96:99],a[192:195],a[136:139],v[200:203]
buffer_load_dwordx4 v236,s[12:15],s43 offen offset:0 nt lds
M v[96:99],a[196:199],a[152:155],v[96:99]
v_cvt_pk_bf16_f32 v128,v0,v1
M v[96:99],a[200:203],a[168:171],v[96:99]
buffer_load_dwordx4 v237,s[12:15],s43 offen offset:1024 nt lds
M v[96:99],a[204:207],a[184:187],v[96:99]
v_exp_f32 v4,v4
M v[112:115],a[204:207],a[188:191],v[204:207]
buffer_load_dwordx4 v238,s[12:15],s43 offen offset:2048 nt lds
M v[112:115],a[200:203],a[172:175],v[112:115]
v_exp_f32 v5,v5
M v[112:115],a[196:199],a[156:159],v[112:115]
buffer_load_dwordx4 v239,s[12:15],s43 offen offset:3072 nt lds
M v[112:115],a[192:195],a[140:143],v[112:115]
s_add_u32 s43,s43,16384
s_waitcnt lgkmcnt(0)
MS a[224:227],v[208:211],v[160:167],v255
ds_read_b128 a[192:195],v224 offset:36864
v_cvt_pk_bf16_f32 v129,v2,v3
M a[0:3],a[208:211],v[160:163],a[0:3]
v_exp_f32 v6,v6
M a[0:3],a[212:215],v[164:167],a[0:3]
ds_read_b128 a[196:199],v225 offset:36864
M a[4:7],a[212:215],v[172:175],a[4:7]
v_exp_f32 v7,v7
M a[4:7],a[208:211],v[168:171],a[4:7]
ds_read_b128 a[200:203],v226 offset:36864
v_cvt_pk_bf16_f32 v130,v4,v5
M a[8:11],a[208:211],v[176:179],a[8:11]
v_exp_f32 v8,v8
M a[8:11],a[212:215],v[180:183],a[8:11]
ds_read_b128 a[204:207],v227 offset:36864
v_exp_f32 v9,v9
M a[12:15],a[212:215],v[188:191],a[12:15]
v_cvt_pk_bf16_f32 v131,v6,v7
M a[12:15],a[208:211],v[184:187],a[12:15]
v_exp_f32 v10,v10
M a[28:31],a[216:219],v[184:187],a[28:31]
ds_read_b64_tr_b16 a[208:209],v230 offset:32768
M a[28:31],a[220:223],v[188:191],a[28:31]
v_exp_f32 v11,v11
M a[24:27],a[220:223],v[180:183],a[24:27]
ds_read_b64_tr_b16 a[210:211],v230 offset:36864
v_cvt_pk_bf16_f32 v132,v8,v9
M a[24:27],a[216:219],v[176:179],a[24:27]
v_exp_f32 v12,v12
M a[20:23],a[216:219],v[168:171],a[20:23]
ds_read_b64_tr_b16 a[212:213],v230 offset:40960
M a[20:23],a[220:223],v[172:175],a[20:23]
v_exp_f32 v13,v13
M a[16:19],a[220:223],v[164:167],a[16:19]
ds_read_b64_tr_b16 a[214:215],v230 offset:45056
v_cvt_pk_bf16_f32 v133,v10,v11
M a[16:19],a[216:219],v[160:163],a[16:19]
s_waitcnt lgkmcnt(4)
M v[68:71],a[192:195],a[128:131],v[192:195]
ds_read_b64_tr_b16 a[216:217],v231 offset:32768
M v[68:71],a[196:199],a[144:147],v[68:71]
v_exp_f32 v14,v14
M v[68:71],a[200:203],a[160:163],v[68:71]
ds_read_b64_tr_b16 a[218:219],v231 offset:36864
M v[68:71],a[204:207],a[176:179],v[68:71]
v_exp_f32 v15,v15
M v[84:87],a[204:207],a[180:183],v[196:199]
ds_read_b64_tr_b16 a[220:221],v231 offset:40960
v_cvt_pk_bf16_f32 v134,v12,v13
M v[84:87],a[200:203],a[164:167],v[84:87]
v_exp_f32 v16,v16
M v[84:87],a[196:199],a[148:151],v[84:87]
ds_read_b64_tr_b16 a[222:223],v231 offset:45056
s_add_u32 m0,s48,81920
M v[84:87],a[192:195],a[132:135],v[84:87]
v_exp_f32 v17,v17
M v[100:103],a[192:195],a[136:139],v[200:203]
buffer_load_dwordx4 v240,s[16:19],s44 offen offset:0 nt lds
M v[100:103],a[196:199],a[152:155],v[100:103]
v_cvt_pk_bf16_f32 v135,v14,v15
M v[100:103],a[200:203],a[168:171],v[100:103]
buffer_load_dwordx4 v241,s[16:19],s44 offen offset:1024 nt lds
M v[100:103],a[204:207],a[184:187],v[100:103]
v_exp_f32 v18,v18
M v[116:119],a[204:207],a[188:191],v[204:207]
buffer_load_dwordx4 v240,s[16:19],s44 offen offset:2048 nt lds
M v[116:119],a[200:203],a[172:175],v[116:119]
v_exp_f32 v19,v19
M v[116:119],a[196:199],a[156:159],v[116:119]
buffer_load_dwordx4 v241,s[16:19],s44 offen offset:3072 nt lds
M v[116:119],a[192:195],a[140:143],v[116:119]
s_add_u32 s44,s44,16384
s_waitcnt lgkmcnt(0)
MS a[228:231],v[208:211],v[168:175],v255
ds_read_b128 a[192:195],v224 offset:40960
v_cvt_pk_bf16_f32 v136,v16,v17
M a[32:35],a[208:211],v[160:163],a[32:35]
v_exp_f32 v20,v20
M a[32:35],a[212:215],v[164:167],a[32:35]
ds_read_b128 a[196:199],v225 offset:40960
M a[36:39],a[212:215],v[172:175],a[36:39]
v_exp_f32 v21,v21
M a[36:39],a[208:211],v[168:171],a[36:39]
ds_read_b128 a[200:203],v226 offset:40960
v_cvt_pk_bf16_f32 v137,v18,v19
M a[40:43],a[208:211],v[176:179],a[40:43]
v_exp_f32 v22,v22
M a[40:43],a[212:215],v[180:183],a[40:43]
ds_read_b128 a[204:207],v227 offset:40960
v_exp_f32 v23,v23
M a[44:47],a[212:215],v[188:191],a[44:47]
v_cvt_pk_bf16_f32 v138,v20,v21
M a[44:47],a[208:211],v[184:187],a[44:47]
v_exp_f32 v24,v24
M a[60:63],a[216:219],v[184:187],a[60:63]
ds_read_b64_tr_b16 a[208:209],v232 offset:32768
M a[60:63],a[220:223],v[188:191],a[60:63]
v_exp_f32 v25,v25
M a[56:59],a[220:223],v[180:183],a[56:59]
ds_read_b64_tr_b16 a[210:211],v232 offset:36864
v_cvt_pk_bf16_f32 v139,v22,v23
M a[56:59],a[216:219],v[176:179],a[56:59]
v_exp_f32 v26,v26
M a[52:55],a[216:219],v[168:171],a[52:55]
ds_read_b64_tr_b16 a[212:213],v232 offset:40960
M a[52:55],a[220:223],v[172:175],a[52:55]
v_exp_f32 v27,v27
M a[48:51],a[220:223],v[164:167],a[48:51]
ds_read_b64_tr_b16 a[214:215],v232 offset:45056
v_cvt_pk_bf16_f32 v140,v24,v25
M a[48:51],a[216:219],v[160:163],a[48:51]
s_waitcnt lgkmcnt(4)
M v[72:75],a[192:195],a[128:131],v[192:195]
ds_read_b64_tr_b16 a[216:217],v233 offset:32768
v_exp_f32 v28,v28
M v[72:75],a[196:199],a[144:147],v[72:75]
v_exp_f32 v29,v29
M v[72:75],a[200:203],a[160:163],v[72:75]
ds_read_b64_tr_b16 a[218:219],v233 offset:36864
v_cvt_pk_bf16_f32 v141,v26,v27
M v[72:75],a[204:207],a[176:179],v[72:75]
v_exp_f32 v30,v30
M v[88:91],a[204:207],a[180:183],v[196:199]
ds_read_b64_tr_b16 a[220:221],v233 offset:40960
M v[88:91],a[200:203],a[164:167],v[88:91]
v_exp_f32 v31,v31
M v[88:91],a[196:199],a[148:151],v[88:91]
ds_read_b64_tr_b16 a[222:223],v233 offset:45056
v_cvt_pk_bf16_f32 v142,v28,v29
M v[88:91],a[192:195],a[132:135],v[88:91]
v_exp_f32 v32,v32
M v[104:107],a[192:195],a[136:139],v[200:203]
v_exp_f32 v33,v33
M v[104:107],a[196:199],a[152:155],v[104:107]
v_cvt_pk_bf16_f32 v143,v30,v31
M v[104:107],a[200:203],a[168:171],v[104:107]
v_exp_f32 v34,v34
M v[104:107],a[204:207],a[184:187],v[104:107]
v_exp_f32 v35,v35
M v[120:123],a[204:207],a[188:191],v[204:207]
v_cvt_pk_bf16_f32 v144,v32,v33
M v[120:123],a[200:203],a[172:175],v[120:123]
v_exp_f32 v36,v36
M v[120:123],a[196:199],a[156:159],v[120:123]
v_exp_f32 v37,v37
M v[120:123],a[192:195],a[140:143],v[120:123]
v_cvt_pk_bf16_f32 v145,v34,v35
s_waitcnt lgkmcnt(0)
MS a[232:235],v[208:211],v[176:183],v255
ds_read_b128 a[192:195],v224 offset:45056
v_exp_f32 v38,v38
M a[64:67],a[208:211],v[160:163],a[64:67]
v_exp_f32 v39,v39
M a[64:67],a[212:215],v[164:167],a[64:67]
ds_read_b128 a[196:199],v225 offset:45056
v_cvt_pk_bf16_f32 v146,v36,v37
M a[68:71],a[212:215],v[172:175],a[68:71]
v_exp_f32 v40,v40
M a[68:71],a[208:211],v[168:171],a[68:71]
ds_read_b128 a[200:203],v226 offset:45056
M a[72:75],a[208:211],v[176:179],a[72:75]
v_exp_f32 v41,v41
M a[72:75],a[212:215],v[180:183],a[72:75]
ds_read_b128 a[204:207],v227 offset:45056
v_cvt_pk_bf16_f32 v147,v38,v39
M a[76:79],a[212:215],v[188:191],a[76:79]
v_exp_f32 v42,v42
M a[76:79],a[208:211],v[184:187],a[76:79]
v_exp_f32 v43,v43
M a[92:95],a[216:219],v[184:187],a[92:95]
ds_read_b64_tr_b16 a[208:209],v234 offset:32768
v_cvt_pk_bf16_f32 v148,v40,v41
M a[92:95],a[220:223],v[188:191],a[92:95]
v_exp_f32 v44,v44
M a[88:91],a[220:223],v[180:183],a[88:91]
ds_read_b64_tr_b16 a[210:211],v234 offset:36864
M a[88:91],a[216:219],v[176:179],a[88:91]
v_exp_f32 v45,v45
M a[84:87],a[216:219],v[168:171],a[84:87]
ds_read_b64_tr_b16 a[212:213],v234 offset:40960
v_cvt_pk_bf16_f32 v149,v42,v43
M a[84:87],a[220:223],v[172:175],a[84:87]
v_exp_f32 v46,v46
M a[80:83],a[220:223],v[164:167],a[80:83]
ds_read_b64_tr_b16 a[214:215],v234 offset:45056
M a[80:83],a[216:219],v[160:163],a[80:83]
s_waitcnt lgkmcnt(4)
M v[76:79],a[192:195],a[128:131],v[192:195]
ds_read_b64_tr_b16 a[216:217],v235 offset:32768
M v[76:79],a[196:199],a[144:147],v[76:79]
v_exp_f32 v47,v47
M v[76:79],a[200:203],a[160:163],v[76:79]
ds_read_b64_tr_b16 a[218:219],v235 offset:36864
v_cvt_pk_bf16_f32 v150,v44,v45
M v[76:79],a[204:207],a[176:179],v[76:79]
v_exp_f32 v48,v48
M v[92:95],a[204:207],a[180:183],v[196:199]
ds_read_b64_tr_b16 a[220:221],v235 offset:40960
M v[92:95],a[200:203],a[164:167],v[92:95]
v_exp_f32 v49,v49
M v[92:95],a[196:199],a[148:151],v[92:95]
ds_read_b64_tr_b16 a[222:223],v235 offset:45056
v_cvt_pk_bf16_f32 v151,v46,v47
M v[92:95],a[192:195],a[132:135],v[92:95]
v_exp_f32 v50,v50
M v[108:111],a[192:195],a[136:139],v[200:203]
v_exp_f32 v51,v51
M v[108:111],a[196:199],a[152:155],v[108:111]
v_cvt_pk_bf16_f32 v152,v48,v49
M v[108:111],a[200:203],a[168:171],v[108:111]
v_exp_f32 v52,v52
M v[108:111],a[204:207],a[184:187],v[108:111]
v_exp_f32 v53,v53
M v[124:127],a[204:207],a[188:191],v[204:207]
v_cvt_pk_bf16_f32 v153,v50,v51
M v[124:127],a[200:203],a[172:175],v[124:127]
v_exp_f32 v54,v54
M v[124:127],a[196:199],a[156:159],v[124:127]
v_exp_f32 v55,v55
M v[124:127],a[192:195],a[140:143],v[124:127]
v_cvt_pk_bf16_f32 v154,v52,v53
s_waitcnt vmcnt(16) lgkmcnt(0)
MS a[236:239],v[208:211],v[184:191],v255
s_barrier
M a[96:99],a[208:211],v[160:163],a[96:99]
ds_read_b128 a[192:195],v224 offset:49152
v_exp_f32 v56,v56
M a[96:99],a[212:215],v[164:167],a[96:99]
v_exp_f32 v57,v57
M a[100:103],a[212:215],v[172:175],a[100:103]
ds_read_b128 a[196:199],v225 offset:49152
v_cvt_pk_bf16_f32 v155,v54,v55
M a[100:103],a[208:211],v[168:171],a[100:103]
v_exp_f32 v58,v58
M a[104:107],a[208:211],v[176:179],a[104:107]
ds_read_b128 a[200:203],v226 offset:49152
M a[104:107],a[212:215],v[180:183],a[104:107]
v_exp_f32 v59,v59
M a[108:111],a[212:215],v[188:191],a[108:111]
ds_read_b128 a[204:207],v227 offset:49152
v_cvt_pk_bf16_f32 v156,v56,v57
M a[108:111],a[208:211],v[184:187],a[108:111]
v_exp_f32 v60,v60
M a[124:127],a[216:219],v[184:187],a[124:127]
ds_read_b64_tr_b16 a[208:209],v228 offset:49152
M a[124:127],a[220:223],v[188:191],a[124:127]
v_exp_f32 v61,v61
M a[120:123],a[220:223],v[180:183],a[120:123]
ds_read_b64_tr_b16 a[210:211],v228 offset:53248
v_cvt_pk_bf16_f32 v157,v58,v59
M a[120:123],a[216:219],v[176:179],a[120:123]
v_exp_f32 v62,v62
M a[116:119],a[216:219],v[168:171],a[116:119]
ds_read_b64_tr_b16 a[212:213],v228 offset:57344
M a[116:119],a[220:223],v[172:175],a[116:119]
v_exp_f32 v63,v63
M a[112:115],a[220:223],v[164:167],a[112:115]
ds_read_b64_tr_b16 a[214:215],v228 offset:61440
M a[112:115],a[216:219],v[160:163],a[112:115]
v_cvt_pk_bf16_f32 v158,v60,v61
v_cvt_pk_bf16_f32 v159,v62,v63
s_waitcnt lgkmcnt(4)
M v[0:3],a[192:195],a[128:131],v[192:195]
ds_read_b64_tr_b16 a[216:217],v229 offset:49152
M v[0:3],a[196:199],a[144:147],v[0:3]
v_exp_f32 v64,v64
M v[0:3],a[200:203],a[160:163],v[0:3]
ds_read_b64_tr_b16 a[218:219],v229 offset:53248
M v[0:3],a[204:207],a[176:179],v[0:3]
v_exp_f32 v65,v65
M v[16:19],a[204:207],a[180:183],v[196:199]
ds_read_b64_tr_b16 a[220:221],v229 offset:57344
M v[16:19],a[200:203],a[164:167],v[16:19]
v_exp_f32 v66,v66
M v[16:19],a[196:199],a[148:151],v[16:19]
ds_read_b64_tr_b16 a[222:223],v229 offset:61440
s_add_u32 m0,s48,32768
M v[16:19],a[192:195],a[132:135],v[16:19]
v_exp_f32 v67,v67
M v[32:35],a[192:195],a[136:139],v[200:203]
buffer_load_dwordx4 v236,s[12:15],s43 offen offset:0 nt lds
M v[32:35],a[196:199],a[152:155],v[32:35]
v_cvt_pk_bf16_f32 v160,v64,v65
M v[32:35],a[200:203],a[168:171],v[32:35]
buffer_load_dwordx4 v237,s[12:15],s43 offen offset:1024 nt lds
M v[32:35],a[204:207],a[184:187],v[32:35]
v_exp_f32 v68,v68
M v[48:51],a[204:207],a[188:191],v[204:207]
buffer_load_dwordx4 v238,s[12:15],s43 offen offset:2048 nt lds
M v[48:51],a[200:203],a[172:175],v[48:51]
v_exp_f32 v69,v69
M v[48:51],a[196:199],a[156:159],v[48:51]
buffer_load_dwordx4 v239,s[12:15],s43 offen offset:3072 nt lds
M v[48:51],a[192:195],a[140:143],v[48:51]
s_add_u32 s43,s43,16384
s_waitcnt lgkmcnt(0)
MS a[224:227],v[208:211],v[128:135],v255
ds_read_b128 a[192:195],v224 offset:53248
v_cvt_pk_bf16_f32 v161,v66,v67
M a[0:3],a[208:211],v[128:131],a[0:3]
v_exp_f32 v70,v70
M a[0:3],a[212:215],v[132:135],a[0:3]
ds_read_b128 a[196:199],v225 offset:53248
M a[4:7],a[212:215],v[140:143],a[4:7]
v_exp_f32 v71,v71
M a[4:7],a[208:211],v[136:139],a[4:7]
ds_read_b128 a[200:203],v226 offset:53248
v_cvt_pk_bf16_f32 v162,v68,v69
M a[8:11],a[208:211],v[144:147],a[8:11]
v_exp_f32 v72,v72
M a[8:11],a[212:215],v[148:151],a[8:11]
ds_read_b128 a[204:207],v227 offset:53248
v_exp_f32 v73,v73
M a[12:15],a[212:215],v[156:159],a[12:15]
v_cvt_pk_bf16_f32 v163,v70,v71
M a[12:15],a[208:211],v[152:155],a[12:15]
v_exp_f32 v74,v74
M a[28:31],a[216:219],v[152:155],a[28:31]
ds_read_b64_tr_b16 a[208:209],v230 offset:49152
M a[28:31],a[220:223],v[156:159],a[28:31]
v_exp_f32 v75,v75
M a[24:27],a[220:223],v[148:151],a[24:27]
ds_read_b64_tr_b16 a[210:211],v230 offset:53248
v_cvt_pk_bf16_f32 v164,v72,v73
M a[24:27],a[216:219],v[144:147],a[24:27]
v_exp_f32 v76,v76
M a[20:23],a[216:219],v[136:139],a[20:23]
ds_read_b64_tr_b16 a[212:213],v230 offset:57344
M a[20:23],a[220:223],v[140:143],a[20:23]
v_exp_f32 v77,v77
M a[16:19],a[220:223],v[132:135],a[16:19]
ds_read_b64_tr_b16 a[214:215],v230 offset:61440
v_cvt_pk_bf16_f32 v165,v74,v75
M a[16:19],a[216:219],v[128:131],a[16:19]
s_waitcnt lgkmcnt(4)
M v[4:7],a[192:195],a[128:131],v[192:195]
ds_read_b64_tr_b16 a[216:217],v231 offset:49152
M v[4:7],a[196:199],a[144:147],v[4:7]
v_exp_f32 v78,v78
M v[4:7],a[200:203],a[160:163],v[4:7]
ds_read_b64_tr_b16 a[218:219],v231 offset:53248
M v[4:7],a[204:207],a[176:179],v[4:7]
v_exp_f32 v79,v79
M v[20:23],a[204:207],a[180:183],v[196:199]
ds_read_b64_tr_b16 a[220:221],v231 offset:57344
v_cvt_pk_bf16_f32 v166,v76,v77
M v[20:23],a[200:203],a[164:167],v[20:23]
v_exp_f32 v80,v80
M v[20:23],a[196:199],a[148:151],v[20:23]
ds_read_b64_tr_b16 a[222:223],v231 offset:61440
s_add_u32 m0,s48,98304
M v[20:23],a[192:195],a[132:135],v[20:23]
v_exp_f32 v81,v81
M v[36:39],a[192:195],a[136:139],v[200:203]
buffer_load_dwordx4 v240,s[16:19],s44 offen offset:0 nt lds
M v[36:39],a[196:199],a[152:155],v[36:39]
v_cvt_pk_bf16_f32 v167,v78,v79
M v[36:39],a[200:203],a[168:171],v[36:39]
buffer_load_dwordx4 v241,s[16:19],s44 offen offset:1024 nt lds
M v[36:39],a[204:207],a[184:187],v[36:39]
v_exp_f32 v82,v82
M v[52:55],a[204:207],a[188:191],v[204:207]
buffer_load_dwordx4 v240,s[16:19],s44 offen offset:2048 nt lds
M v[52:55],a[200:203],a[172:175],v[52:55]
v_exp_f32 v83,v83
M v[52:55],a[196:199],a[156:159],v[52:55]
buffer_load_dwordx4 v241,s[16:19],s44 offen offset:3072 nt lds
M v[52:55],a[192:195],a[140:143],v[52:55]
s_add_u32 s44,s44,16384
s_waitcnt lgkmcnt(0)
MS a[228:231],v[208:211],v[136:143],v255
ds_read_b128 a[192:195],v224 offset:57344
v_cvt_pk_bf16_f32 v168,v80,v81
M a[32:35],a[208:211],v[128:131],a[32:35]
v_exp_f32 v84,v84
M a[32:35],a[212:215],v[132:135],a[32:35]
ds_read_b128 a[196:199],v225 offset:57344
M a[36:39],a[212:215],v[140:143],a[36:39]
v_exp_f32 v85,v85
M a[36:39],a[208:211],v[136:139],a[36:39]
ds_read_b128 a[200:203],v226 offset:57344
v_cvt_pk_bf16_f32 v169,v82,v83
M a[40:43],a[208:211],v[144:147],a[40:43]
v_exp_f32 v86,v86
M a[40:43],a[212:215],v[148:151],a[40:43]
ds_read_b128 a[204:207],v227 offset:57344
v_exp_f32 v87,v87
M a[44:47],a[212:215],v[156:159],a[44:47]
v_cvt_pk_bf16_f32 v170,v84,v85
M a[44:47],a[208:211],v[152:155],a[44:47]
v_exp_f32 v88,v88
M a[60:63],a[216:219],v[152:155],a[60:63]
ds_read_b64_tr_b16 a[208:209],v232 offset:49152
M a[60:63],a[220:223],v[156:159],a[60:63]
v_exp_f32 v89,v89
M a[56:59],a[220:223],v[148:151],a[56:59]
ds_read_b64_tr_b16 a[210:211],v232 offset:53248
v_cvt_pk_bf16_f32 v171,v86,v87
M a[56:59],a[216:219],v[144:147],a[56:59]
v_exp_f32 v90,v90
M a[52:55],a[216:219],v[136:139],a[52:55]
ds_read_b64_tr_b16 a[212:213],v232 offset:57344
M a[52:55],a[220:223],v[140:143],a[52:55]
v_exp_f32 v91,v91
M a[48:51],a[220:223],v[132:135],a[48:51]
ds_read_b64_tr_b16 a[214:215],v232 offset:61440
v_cvt_pk_bf16_f32 v172,v88,v89
M a[48:51],a[216:219],v[128:131],a[48:51]
s_waitcnt lgkmcnt(4)
M v[8:11],a[192:195],a[128:131],v[192:195]
ds_read_b64_tr_b16 a[216:217],v233 offset:49152
v_exp_f32 v92,v92
M v[8:11],a[196:199],a[144:147],v[8:11]
v_exp_f32 v93,v93
M v[8:11],a[200:203],a[160:163],v[8:11]
ds_read_b64_tr_b16 a[218:219],v233 offset:53248
v_cvt_pk_bf16_f32 v173,v90,v91
M v[8:11],a[204:207],a[176:179],v[8:11]
v_exp_f32 v94,v94
M v[24:27],a[204:207],a[180:183],v[196:199]
ds_read_b64_tr_b16 a[220:221],v233 offset:57344
M v[24:27],a[200:203],a[164:167],v[24:27]
v_exp_f32 v95,v95
M v[24:27],a[196:199],a[148:151],v[24:27]
ds_read_b64_tr_b16 a[222:223],v233 offset:61440
v_cvt_pk_bf16_f32 v174,v92,v93
M v[24:27],a[192:195],a[132:135],v[24:27]
v_exp_f32 v96,v96
M v[40:43],a[192:195],a[136:139],v[200:203]
v_exp_f32 v97,v97
M v[40:43],a[196:199],a[152:155],v[40:43]
v_cvt_pk_bf16_f32 v175,v94,v95
M v[40:43],a[200:203],a[168:171],v[40:43]
v_exp_f32 v98,v98
M v[40:43],a[204:207],a[184:187],v[40:43]
v_exp_f32 v99,v99
M v[56:59],a[204:207],a[188:191],v[204:207]
v_cvt_pk_bf16_f32 v176,v96,v97
M v[56:59],a[200:203],a[172:175],v[56:59]
v_exp_f32 v100,v100
M v[56:59],a[196:199],a[156:159],v[56:59]
v_exp_f32 v101,v101
M v[56:59],a[192:195],a[140:143],v[56:59]
v_cvt_pk_bf16_f32 v177,v98,v99
s_waitcnt lgkmcnt(0)
MS a[232:235],v[208:211],v[144:151],v255
ds_read_b128 a[192:195],v224 offset:61440
v_exp_f32 v102,v102
M a[64:67],a[208:211],v[128:131],a[64:67]
v_exp_f32 v103,v103
M a[64:67],a[212:215],v[132:135],a[64:67]
ds_read_b128 a[196:199],v225 offset:61440
v_cvt_pk_bf16_f32 v178,v100,v101
M a[68:71],a[212:215],v[140:143],a[68:71]
v_exp_f32 v104,v104
M a[68:71],a[208:211],v[136:139],a[68:71]
ds_read_b128 a[200:203],v226 offset:61440
M a[72:75],a[208:211],v[144:147],a[72:75]
v_exp_f32 v105,v105
M a[72:75],a[212:215],v[148:151],a[72:75]
ds_read_b128 a[204:207],v227 offset:61440
v_cvt_pk_bf16_f32 v179,v102,v103
M a[76:79],a[212:215],v[156:159],a[76:79]
v_exp_f32 v106,v106
M a[76:79],a[208:211],v[152:155],a[76:79]
v_exp_f32 v107,v107
M a[92:95],a[216:219],v[152:155],a[92:95]
ds_read_b64_tr_b16 a[208:209],v234 offset:49152
v_cvt_pk_bf16_f32 v180,v104,v105
M a[92:95],a[220:223],v[156:159],a[92:95]
v_exp_f32 v108,v108
M a[88:91],a[220:223],v[148:151],a[88:91]
ds_read_b64_tr_b16 a[210:211],v234 offset:53248
M a[88:91],a[216:219],v[144:147],a[88:91]
v_exp_f32 v109,v109
M a[84:87],a[216:219],v[136:139],a[84:87]
ds_read_b64_tr_b16 a[212:213],v234 offset:57344
v_cvt_pk_bf16_f32 v181,v106,v107
M a[84:87],a[220:223],v[140:143],a[84:87]
v_exp_f32 v110,v110
M a[80:83],a[220:223],v[132:135],a[80:83]
ds_read_b64_tr_b16 a[214:215],v234 offset:61440
M a[80:83],a[216:219],v[128:131],a[80:83]
s_waitcnt lgkmcnt(4)
M v[12:15],a[192:195],a[128:131],v[192:195]
ds_read_b64_tr_b16 a[216:217],v235 offset:49152
M v[12:15],a[196:199],a[144:147],v[12:15]
v_exp_f32 v111,v111
M v[12:15],a[200:203],a[160:163],v[12:15]
ds_read_b64_tr_b16 a[218:219],v235 offset:53248
v_cvt_pk_bf16_f32 v182,v108,v109
M v[12:15],a[204:207],a[176:179],v[12:15]
v_exp_f32 v112,v112
M v[28:31],a[204:207],a[180:183],v[196:199]
ds_read_b64_tr_b16 a[220:221],v235 offset:57344
M v[28:31],a[200:203],a[164:167],v[28:31]
v_exp_f32 v113,v113
M v[28:31],a[196:199],a[148:151],v[28:31]
ds_read_b64_tr_b16 a[222:223],v235 offset:61440
v_cvt_pk_bf16_f32 v183,v110,v111
M v[28:31],a[192:195],a[132:135],v[28:31]
v_exp_f32 v114,v114
M v[44:47],a[192:195],a[136:139],v[200:203]
v_exp_f32 v115,v115
M v[44:47],a[196:199],a[152:155],v[44:47]
v_cvt_pk_bf16_f32 v184,v112,v113
M v[44:47],a[200:203],a[168:171],v[44:47]
v_exp_f32 v116,v116
M v[44:47],a[204:207],a[184:187],v[44:47]
v_exp_f32 v117,v117
M v[60:63],a[204:207],a[188:191],v[204:207]
v_cvt_pk_bf16_f32 v185,v114,v115
M v[60:63],a[200:203],a[172:175],v[60:63]
v_exp_f32 v118,v118
M v[60:63],a[196:199],a[156:159],v[60:63]
v_exp_f32 v119,v119
M v[60:63],a[192:195],a[140:143],v[60:63]
v_cvt_pk_bf16_f32 v186,v116,v117
s_waitcnt vmcnt(16) lgkmcnt(0)
MS a[236:239],v[208:211],v[152:159],v255
s_barrier
M a[96:99],a[208:211],v[128:131],a[96:99]
ds_read_b128 a[192:195],v224 offset:0
v_exp_f32 v120,v120
M a[96:99],a[212:215],v[132:135],a[96:99]
v_exp_f32 v121,v121
M a[100:103],a[212:215],v[140:143],a[100:103]
ds_read_b128 a[196:199],v225 offset:0
v_cvt_pk_bf16_f32 v187,v118,v119
M a[100:103],a[208:211],v[136:139],a[100:103]
v_exp_f32 v122,v122
M a[104:107],a[208:211],v[144:147],a[104:107]
ds_read_b128 a[200:203],v226 offset:0
M a[104:107],a[212:215],v[148:151],a[104:107]
v_exp_f32 v123,v123
M a[108:111],a[212:215],v[156:159],a[108:111]
ds_read_b128 a[204:207],v227 offset:0
v_cvt_pk_bf16_f32 v188,v120,v121
M a[108:111],a[208:211],v[152:155],a[108:111]
v_exp_f32 v124,v124
M a[124:127],a[216:219],v[152:155],a[124:127]
ds_read_b64_tr_b16 a[208:209],v228 offset:0
M a[124:127],a[220:223],v[156:159],a[124:127]
v_exp_f32 v125,v125
M a[120:123],a[220:223],v[148:151],a[120:123]
ds_read_b64_tr_b16 a[210:211],v228 offset:4096
v_cvt_pk_bf16_f32 v189,v122,v123
M a[120:123],a[216:219],v[144:147],a[120:123]
v_exp_f32 v126,v126
M a[116:119],a[216:219],v[136:139],a[116:119]
ds_read_b64_tr_b16 a[212:213],v228 offset:8192
M a[116:119],a[220:223],v[140:143],a[116:119]
v_exp_f32 v127,v127
M a[112:115],a[220:223],v[132:135],a[112:115]
ds_read_b64_tr_b16 a[214:215],v228 offset:12288
M a[112:115],a[216:219],v[128:131],a[112:115]
v_cvt_pk_bf16_f32 v190,v124,v125
v_cvt_pk_bf16_f32 v191,v126,v127
s_waitcnt lgkmcnt(4)
M v[64:67],a[192:195],a[128:131],v[192:195]
ds_read_b64_tr_b16 a[216:217],v229 offset:0
M v[64:67],a[196:199],a[144:147],v[64:67]
v_exp_f32 v0,v0
M v[64:67],a[200:203],a[160:163],v[64:67]
ds_read_b64_tr_b16 a[218:219],v229 offset:4096
M v[64:67],a[204:207],a[176:179],v[64:67]
v_exp_f32 v1,v1
M v[80:83],a[204:207],a[180:183],v[196:199]
ds_read_b64_tr_b16 a[220:221],v229 offset:8192
M v[80:83],a[200:203],a[164:167],v[80:83]
v_exp_f32 v2,v2
M v[80:83],a[196:199],a[148:151],v[80:83]
ds_read_b64_tr_b16 a[222:223],v229 offset:12288
s_add_u32 m0,s48,49152
M v[80:83],a[192:195],a[132:135],v[80:83]
v_exp_f32 v3,v3
M v[96:99],a[192:195],a[136:139],v[200:203]
buffer_load_dwordx4 v236,s[12:15],s43 offen offset:0 nt lds
M v[96:99],a[196:199],a[152:155],v[96:99]
v_cvt_pk_bf16_f32 v128,v0,v1
M v[96:99],a[200:203],a[168:171],v[96:99]
buffer_load_dwordx4 v237,s[12:15],s43 offen offset:1024 nt lds
M v[96:99],a[204:207],a[184:187],v[96:99]
v_exp_f32 v4,v4
M v[112:115],a[204:207],a[188:191],v[204:207]
buffer_load_dwordx4 v238,s[12:15],s43 offen offset:2048 nt lds
M v[112:115],a[200:203],a[172:175],v[112:115]
v_exp_f32 v5,v5
M v[112:115],a[196:199],a[156:159],v[112:115]
buffer_load_dwordx4 v239,s[12:15],s43 offen offset:3072 nt lds
M v[112:115],a[192:195],a[140:143],v[112:115]
s_add_u32 s43,s43,16384
s_waitcnt lgkmcnt(0)
MS a[224:227],v[208:211],v[160:167],v255
ds_read_b128 a[192:195],v224 offset:4096
v_cvt_pk_bf16_f32 v129,v2,v3
M a[0:3],a[208:211],v[160:163],a[0:3]
v_exp_f32 v6,v6
M a[0:3],a[212:215],v[164:167],a[0:3]
ds_read_b128 a[196:199],v225 offset:4096
M a[4:7],a[212:215],v[172:175],a[4:7]
v_exp_f32 v7,v7
M a[4:7],a[208:211],v[168:171],a[4:7]
ds_read_b128 a[200:203],v226 offset:4096
v_cvt_pk_bf16_f32 v130,v4,v5
M a[8:11],a[208:211],v[176:179],a[8:11]
v_exp_f32 v8,v8
M a[8:11],a[212:215],v[180:183],a[8:11]
ds_read_b128 a[204:207],v227 offset:4096
v_exp_f32 v9,v9
M a[12:15],a[212:215],v[188:191],a[12:15]
v_cvt_pk_bf16_f32 v131,v6,v7
M a[12:15],a[208:211],v[184:187],a[12:15]
v_exp_f32 v10,v10
M a[28:31],a[216:219],v[184:187],a[28:31]
ds_read_b64_tr_b16 a[208:209],v230 offset:0
M a[28:31],a[220:223],v[188:191],a[28:31]
v_exp_f32 v11,v11
M a[24:27],a[220:223],v[180:183],a[24:27]
ds_read_b64_tr_b16 a[210:211],v230 offset:4096
v_cvt_pk_bf16_f32 v132,v8,v9
M a[24:27],a[216:219],v[176:179],a[24:27]
v_exp_f32 v12,v12
M a[20:23],a[216:219],v[168:171],a[20:23]
ds_read_b64_tr_b16 a[212:213],v230 offset:8192
M a[20:23],a[220:223],v[172:175],a[20:23]
v_exp_f32 v13,v13
M a[16:19],a[220:223],v[164:167],a[16:19]
ds_read_b64_tr_b16 a[214:215],v230 offset:12288
v_cvt_pk_bf16_f32 v133,v10,v11
M a[16:19],a[216:219],v[160:163],a[16:19]
s_waitcnt lgkmcnt(4)
M v[68:71],a[192:195],a[128:131],v[192:195]
ds_read_b64_tr_b16 a[216:217],v231 offset:0
M v[68:71],a[196:199],a[144:147],v[68:71]
v_exp_f32 v14,v14
M v[68:71],a[200:203],a[160:163],v[68:71]
ds_read_b64_tr_b16 a[218:219],v231 offset:4096
M v[68:71],a[204:207],a[176:179],v[68:71]
v_exp_f32 v15,v15
M v[84:87],a[204:207],a[180:183],v[196:199]
ds_read_b64_tr_b16 a[220:221],v231 offset:8192
v_cvt_pk_bf16_f32 v134,v12,v13
M v[84:87],a[200:203],a[164:167],v[84:87]
v_exp_f32 v16,v16
M v[84:87],a[196:199],a[148:151],v[84:87]
ds_read_b64_tr_b16 a[222:223],v231 offset:12288
s_add_u32 m0,s48,114688
M v[84:87],a[192:195],a[132:135],v[84:87]
v_exp_f32 v17,v17
M v[100:103],a[192:195],a[136:139],v[200:203]
buffer_load_dwordx4 v240,s[16:19],s44 offen offset:0 nt lds
M v[100:103],a[196:199],a[152:155],v[100:103]
v_cvt_pk_bf16_f32 v135,v14,v15
M v[100:103],a[200:203],a[168:171],v[100:103]
buffer_load_dwordx4 v241,s[16:19],s44 offen offset:1024 nt lds
M v[100:103],a[204:207],a[184:187],v[100:103]
v_exp_f32 v18,v18
M v[116:119],a[204:207],a[188:191],v[204:207]
buffer_load_dwordx4 v240,s[16:19],s44 offen offset:2048 nt lds
M v[116:119],a[200:203],a[172:175],v[116:119]
v_exp_f32 v19,v19
M v[116:119],a[196:199],a[156:159],v[116:119]
buffer_load_dwordx4 v241,s[16:19],s44 offen offset:3072 nt lds
M v[116:119],a[192:195],a[140:143],v[116:119]
s_add_u32 s44,s44,16384
s_waitcnt lgkmcnt(0)
MS a[228:231],v[208:211],v[168:175],v255
ds_read_b128 a[192:195],v224 offset:8192
v_cvt_pk_bf16_f32 v136,v16,v17
M a[32:35],a[208:211],v[160:163],a[32:35]
v_exp_f32 v20,v20
M a[32:35],a[212:215],v[164:167],a[32:35]
ds_read_b128 a[196:199],v225 offset:8192
M a[36:39],a[212:215],v[172:175],a[36:39]
v_exp_f32 v21,v21
M a[36:39],a[208:211],v[168:171],a[36:39]
ds_read_b128 a[200:203],v226 offset:8192
v_cvt_pk_bf16_f32 v137,v18,v19
M a[40:43],a[208:211],v[176:179],a[40:43]
v_exp_f32 v22,v22
M a[40:43],a[212:215],v[180:183],a[40:43]
ds_read_b128 a[204:207],v227 offset:8192
v_exp_f32 v23,v23
M a[44:47],a[212:215],v[188:191],a[44:47]
v_cvt_pk_bf16_f32 v138,v20,v21
M a[44:47],a[208:211],v[184:187],a[44:47]
v_exp_f32 v24,v24
M a[60:63],a[216:219],v[184:187],a[60:63]
ds_read_b64_tr_b16 a[208:209],v232 offset:0
M a[60:63],a[220:223],v[188:191],a[60:63]
v_exp_f32 v25,v25
M a[56:59],a[220:223],v[180:183],a[56:59]
ds_read_b64_tr_b16 a[210:211],v232 offset:4096
v_cvt_pk_bf16_f32 v139,v22,v23
M a[56:59],a[216:219],v[176:179],a[56:59]
v_exp_f32 v26,v26
M a[52:55],a[216:219],v[168:171],a[52:55]
ds_read_b64_tr_b16 a[212:213],v232 offset:8192
M a[52:55],a[220:223],v[172:175],a[52:55]
v_exp_f32 v27,v27
M a[48:51],a[220:223],v[164:167],a[48:51]
ds_read_b64_tr_b16 a[214:215],v232 offset:12288
v_cvt_pk_bf16_f32 v140,v24,v25
M a[48:51],a[216:219],v[160:163],a[48:51]
s_waitcnt lgkmcnt(4)
M v[72:75],a[192:195],a[128:131],v[192:195]
ds_read_b64_tr_b16 a[216:217],v233 offset:0
v_exp_f32 v28,v28
M v[72:75],a[196:199],a[144:147],v[72:75]
v_exp_f32 v29,v29
M v[72:75],a[200:203],a[160:163],v[72:75]
ds_read_b64_tr_b16 a[218:219],v233 offset:4096
v_cvt_pk_bf16_f32 v141,v26,v27
M v[72:75],a[204:207],a[176:179],v[72:75]
v_exp_f32 v30,v30
M v[88:91],a[204:207],a[180:183],v[196:199]
ds_read_b64_tr_b16 a[220:221],v233 offset:8192
M v[88:91],a[200:203],a[164:167],v[88:91]
v_exp_f32 v31,v31
M v[88:91],a[196:199],a[148:151],v[88:91]
ds_read_b64_tr_b16 a[222:223],v233 offset:12288
v_cvt_pk_bf16_f32 v142,v28,v29
M v[88:91],a[192:195],a[132:135],v[88:91]
v_exp_f32 v32,v32
M v[104:107],a[192:195],a[136:139],v[200:203]
v_exp_f32 v33,v33
M v[104:107],a[196:199],a[152:155],v[104:107]
v_cvt_pk_bf16_f32 v143,v30,v31
M v[104:107],a[200:203],a[168:171],v[104:107]
v_exp_f32 v34,v34
M v[104:107],a[204:207],a[184:187],v[104:107]
v_exp_f32 v35,v35
M v[120:123],a[204:207],a[188:191],v[204:207]
v_cvt_pk_bf16_f32 v144,v32,v33
M v[120:123],a[200:203],a[172:175],v[120:123]
v_exp_f32 v36,v36
M v[120:123],a[196:199],a[156:159],v[120:123]
v_exp_f32 v37,v37
M v[120:123],a[192:195],a[140:143],v[120:123]
v_cvt_pk_bf16_f32 v145,v34,v35
s_waitcnt lgkmcnt(0)
MS a[232:235],v[208:211],v[176:183],v255
ds_read_b128 a[192:195],v224 offset:12288
v_exp_f32 v38,v38
M a[64:67],a[208:211],v[160:163],a[64:67]
v_exp_f32 v39,v39
M a[64:67],a[212:215],v[164:167],a[64:67]
ds_read_b128 a[196:199],v225 offset:12288
v_cvt_pk_bf16_f32 v146,v36,v37
M a[68:71],a[212:215],v[172:175],a[68:71]
v_exp_f32 v40,v40
M a[68:71],a[208:211],v[168:171],a[68:71]
ds_read_b128 a[200:203],v226 offset:12288
M a[72:75],a[208:211],v[176:179],a[72:75]
v_exp_f32 v41,v41
M a[72:75],a[212:215],v[180:183],a[72:75]
ds_read_b128 a[204:207],v227 offset:12288
v_cvt_pk_bf16_f32 v147,v38,v39
M a[76:79],a[212:215],v[188:191],a[76:79]
v_exp_f32 v42,v42
M a[76:79],a[208:211],v[184:187],a[76:79]
v_exp_f32 v43,v43
M a[92:95],a[216:219],v[184:187],a[92:95]
ds_read_b64_tr_b16 a[208:209],v234 offset:0
v_cvt_pk_bf16_f32 v148,v40,v41
M a[92:95],a[220:223],v[188:191],a[92:95]
v_exp_f32 v44,v44
M a[88:91],a[220:223],v[180:183],a[88:91]
ds_read_b64_tr_b16 a[210:211],v234 offset:4096
M a[88:91],a[216:219],v[176:179],a[88:91]
v_exp_f32 v45,v45
M a[84:87],a[216:219],v[168:171],a[84:87]
ds_read_b64_tr_b16 a[212:213],v234 offset:8192
v_cvt_pk_bf16_f32 v149,v42,v43
M a[84:87],a[220:223],v[172:175],a[84:87]
v_exp_f32 v46,v46
M a[80:83],a[220:223],v[164:167],a[80:83]
ds_read_b64_tr_b16 a[214:215],v234 offset:12288
M a[80:83],a[216:219],v[160:163],a[80:83]
s_waitcnt lgkmcnt(4)
M v[76:79],a[192:195],a[128:131],v[192:195]
ds_read_b64_tr_b16 a[216:217],v235 offset:0
M v[76:79],a[196:199],a[144:147],v[76:79]
v_exp_f32 v47,v47
M v[76:79],a[200:203],a[160:163],v[76:79]
ds_read_b64_tr_b16 a[218:219],v235 offset:4096
v_cvt_pk_bf16_f32 v150,v44,v45
M v[76:79],a[204:207],a[176:179],v[76:79]
v_exp_f32 v48,v48
M v[92:95],a[204:207],a[180:183],v[196:199]
ds_read_b64_tr_b16 a[220:221],v235 offset:8192
M v[92:95],a[200:203],a[164:167],v[92:95]
v_exp_f32 v49,v49
M v[92:95],a[196:199],a[148:151],v[92:95]
ds_read_b64_tr_b16 a[222:223],v235 offset:12288
v_cvt_pk_bf16_f32 v151,v46,v47
M v[92:95],a[192:195],a[132:135],v[92:95]
v_exp_f32 v50,v50
M v[108:111],a[192:195],a[136:139],v[200:203]
v_exp_f32 v51,v51
M v[108:111],a[196:199],a[152:155],v[108:111]
v_cvt_pk_bf16_f32 v152,v48,v49
M v[108:111],a[200:203],a[168:171],v[108:111]
v_exp_f32 v52,v52
M v[108:111],a[204:207],a[184:187],v[108:111]
v_exp_f32 v53,v53
M v[124:127],a[204:207],a[188:191],v[204:207]
v_cvt_pk_bf16_f32 v153,v50,v51
M v[124:127],a[200:203],a[172:175],v[124:127]
v_exp_f32 v54,v54
M v[124:127],a[196:199],a[156:159],v[124:127]
v_exp_f32 v55,v55
M v[124:127],a[192:195],a[140:143],v[124:127]
v_cvt_pk_bf16_f32 v154,v52,v53
s_waitcnt vmcnt(16) lgkmcnt(0)
MS a[236:239],v[208:211],v[184:191],v255
s_barrier
M a[96:99],a[208:211],v[160:163],a[96:99]
ds_read_b128 a[192:195],v224 offset:16384
v_exp_f32 v56,v56
M a[96:99],a[212:215],v[164:167],a[96:99]
v_exp_f32 v57,v57
M a[100:103],a[212:215],v[172:175],a[100:103]
ds_read_b128 a[196:199],v225 offset:16384
v_cvt_pk_bf16_f32 v155,v54,v55
M a[100:103],a[208:211],v[168:171],a[100:103]
v_exp_f32 v58,v58
M a[104:107],a[208:211],v[176:179],a[104:107]
ds_read_b128 a[200:203],v226 offset:16384
M a[104:107],a[212:215],v[180:183],a[104:107]
v_exp_f32 v59,v59
M a[108:111],a[212:215],v[188:191],a[108:111]
ds_read_b128 a[204:207],v227 offset:16384
v_cvt_pk_bf16_f32 v156,v56,v57
M a[108:111],a[208:211],v[184:187],a[108:111]
v_exp_f32 v60,v60
M a[124:127],a[216:219],v[184:187],a[124:127]
ds_read_b64_tr_b16 a[208:209],v228 offset:16384
M a[124:127],a[220:223],v[188:191],a[124:127]
v_exp_f32 v61,v61
M a[120:123],a[220:223],v[180:183],a[120:123]
ds_read_b64_tr_b16 a[210:211],v228 offset:20480
v_cvt_pk_bf16_f32 v157,v58,v59
M a[120:123],a[216:219],v[176:179],a[120:123]
v_exp_f32 v62,v62
M a[116:119],a[216:219],v[168:171],a[116:119]
ds_read_b64_tr_b16 a[212:213],v228 offset:24576
M a[116:119],a[220:223],v[172:175],a[116:119]
v_exp_f32 v63,v63
M a[112:115],a[220:223],v[164:167],a[112:115]
ds_read_b64_tr_b16 a[214:215],v228 offset:28672
M a[112:115],a[216:219],v[160:163],a[112:115]
v_cvt_pk_bf16_f32 v158,v60,v61
v_cvt_pk_bf16_f32 v159,v62,v63
s_waitcnt lgkmcnt(4)
M v[0:3],a[192:195],a[128:131],v[192:195]
ds_read_b64_tr_b16 a[216:217],v229 offset:16384
M v[0:3],a[196:199],a[144:147],v[0:3]
v_exp_f32 v64,v64
M v[0:3],a[200:203],a[160:163],v[0:3]
ds_read_b64_tr_b16 a[218:219],v229 offset:20480
M v[0:3],a[204:207],a[176:179],v[0:3]
v_exp_f32 v65,v65
M v[16:19],a[204:207],a[180:183],v[196:199]
ds_read_b64_tr_b16 a[220:221],v229 offset:24576
M v[16:19],a[200:203],a[164:167],v[16:19]
v_exp_f32 v66,v66
M v[16:19],a[196:199],a[148:151],v[16:19]
ds_read_b64_tr_b16 a[222:223],v229 offset:28672
s_add_u32 m0,s48,0
M v[16:19],a[192:195],a[132:135],v[16:19]
v_exp_f32 v67,v67
M v[32:35],a[192:195],a[136:139],v[200:203]
buffer_load_dwordx4 v236,s[12:15],s43 offen offset:0 nt lds
M v[32:35],a[196:199],a[152:155],v[32:35]
v_cvt_pk_bf16_f32 v160,v64,v65
M v[32:35],a[200:203],a[168:171],v[32:35]
buffer_load_dwordx4 v237,s[12:15],s43 offen offset:1024 nt lds
M v[32:35],a[204:207],a[184:187],v[32:35]
v_exp_f32 v68,v68
M v[48:51],a[204:207],a[188:191],v[204:207]
buffer_load_dwordx4 v238,s[12:15],s43 offen offset:2048 nt lds
M v[48:51],a[200:203],a[172:175],v[48:51]
v_exp_f32 v69,v69
M v[48:51],a[196:199],a[156:159],v[48:51]
buffer_load_dwordx4 v239,s[12:15],s43 offen offset:3072 nt lds
M v[48:51],a[192:195],a[140:143],v[48:51]
s_add_u32 s43,s43,16384
s_waitcnt lgkmcnt(0)
MS a[224:227],v[208:211],v[128:135],v255
ds_read_b128 a[192:195],v224 offset:20480
v_cvt_pk_bf16_f32 v161,v66,v67
M a[0:3],a[208:211],v[128:131],a[0:3]
v_exp_f32 v70,v70
M a[0:3],a[212:215],v[132:135],a[0:3]
ds_read_b128 a[196:199],v225 offset:20480
M a[4:7],a[212:215],v[140:143],a[4:7]
v_exp_f32 v71,v71
M a[4:7],a[208:211],v[136:139],a[4:7]
ds_read_b128 a[200:203],v226 offset:20480
v_cvt_pk_bf16_f32 v162,v68,v69
M a[8:11],a[208:211],v[144:147],a[8:11]
v_exp_f32 v72,v72
M a[8:11],a[212:215],v[148:151],a[8:11]
ds_read_b128 a[204:207],v227 offset:20480
v_exp_f32 v73,v73
M a[12:15],a[212:215],v[156:159],a[12:15]
v_cvt_pk_bf16_f32 v163,v70,v71
M a[12:15],a[208:211],v[152:155],a[12:15]
v_exp_f32 v74,v74
M a[28:31],a[216:219],v[152:155],a[28:31]
ds_read_b64_tr_b16 a[208:209],v230 offset:16384
M a[28:31],a[220:223],v[156:159],a[28:31]
v_exp_f32 v75,v75
M a[24:27],a[220:223],v[148:151],a[24:27]
ds_read_b64_tr_b16 a[210:211],v230 offset:20480
v_cvt_pk_bf16_f32 v164,v72,v73
M a[24:27],a[216:219],v[144:147],a[24:27]
v_exp_f32 v76,v76
M a[20:23],a[216:219],v[136:139],a[20:23]
ds_read_b64_tr_b16 a[212:213],v230 offset:24576
M a[20:23],a[220:223],v[140:143],a[20:23]
v_exp_f32 v77,v77
M a[16:19],a[220:223],v[132:135],a[16:19]
ds_read_b64_tr_b16 a[214:215],v230 offset:28672
v_cvt_pk_bf16_f32 v165,v74,v75
M a[16:19],a[216:219],v[128:131],a[16:19]
s_waitcnt lgkmcnt(4)
M v[4:7],a[192:195],a[128:131],v[192:195]
ds_read_b64_tr_b16 a[216:217],v231 offset:16384
M v[4:7],a[196:199],a[144:147],v[4:7]
v_exp_f32 v78,v78
M v[4:7],a[200:203],a[160:163],v[4:7]
ds_read_b64_tr_b16 a[218:219],v231 offset:20480
M v[4:7],a[204:207],a[176:179],v[4:7]
v_exp_f32 v79,v79
M v[20:23],a[204:207],a[180:183],v[196:199]
ds_read_b64_tr_b16 a[220:221],v231 offset:24576
v_cvt_pk_bf16_f32 v166,v76,v77
M v[20:23],a[200:203],a[164:167],v[20:23]
v_exp_f32 v80,v80
M v[20:23],a[196:199],a[148:151],v[20:23]
ds_read_b64_tr_b16 a[222:223],v231 offset:28672
s_add_u32 m0,s48,65536
M v[20:23],a[192:195],a[132:135],v[20:23]
v_exp_f32 v81,v81
M v[36:39],a[192:195],a[136:139],v[200:203]
buffer_load_dwordx4 v240,s[16:19],s44 offen offset:0 nt lds
M v[36:39],a[196:199],a[152:155],v[36:39]
v_cvt_pk_bf16_f32 v167,v78,v79
M v[36:39],a[200:203],a[168:171],v[36:39]
buffer_load_dwordx4 v241,s[16:19],s44 offen offset:1024 nt lds
M v[36:39],a[204:207],a[184:187],v[36:39]
v_exp_f32 v82,v82
M v[52:55],a[204:207],a[188:191],v[204:207]
buffer_load_dwordx4 v240,s[16:19],s44 offen offset:2048 nt lds
M v[52:55],a[200:203],a[172:175],v[52:55]
v_exp_f32 v83,v83
M v[52:55],a[196:199],a[156:159],v[52:55]
buffer_load_dwordx4 v241,s[16:19],s44 offen offset:3072 nt lds
M v[52:55],a[192:195],a[140:143],v[52:55]
s_add_u32 s44,s44,16384
s_waitcnt lgkmcnt(0)
MS a[228:231],v[208:211],v[136:143],v255
ds_read_b128 a[192:195],v224 offset:24576
v_cvt_pk_bf16_f32 v168,v80,v81
M a[32:35],a[208:211],v[128:131],a[32:35]
v_exp_f32 v84,v84
M a[32:35],a[212:215],v[132:135],a[32:35]
ds_read_b128 a[196:199],v225 offset:24576
M a[36:39],a[212:215],v[140:143],a[36:39]
v_exp_f32 v85,v85
M a[36:39],a[208:211],v[136:139],a[36:39]
ds_read_b128 a[200:203],v226 offset:24576
v_cvt_pk_bf16_f32 v169,v82,v83
M a[40:43],a[208:211],v[144:147],a[40:43]
v_exp_f32 v86,v86
M a[40:43],a[212:215],v[148:151],a[40:43]
ds_read_b128 a[204:207],v227 offset:24576
v_exp_f32 v87,v87
M a[44:47],a[212:215],v[156:159],a[44:47]
v_cvt_pk_bf16_f32 v170,v84,v85
M a[44:47],a[208:211],v[152:155],a[44:47]
v_exp_f32 v88,v88
M a[60:63],a[216:219],v[152:155],a[60:63]
ds_read_b64_tr_b16 a[208:209],v232 offset:16384
M a[60:63],a[220:223],v[156:159],a[60:63]
v_exp_f32 v89,v89
M a[56:59],a[220:223],v[148:151],a[56:59]
ds_read_b64_tr_b16 a[210:211],v232 offset:20480
v_cvt_pk_bf16_f32 v171,v86,v87
M a[56:59],a[216:219],v[144:147],a[56:59]
v_exp_f32 v90,v90
M a[52:55],a[216:219],v[136:139],a[52:55]
ds_read_b64_tr_b16 a[212:213],v232 offset:24576
M a[52:55],a[220:223],v[140:143],a[52:55]
v_exp_f32 v91,v91
M a[48:51],a[220:223],v[132:135],a[48:51]
ds_read_b64_tr_b16 a[214:215],v232 offset:28672
v_cvt_pk_bf16_f32 v172,v88,v89
M a[48:51],a[216:219],v[128:131],a[48:51]
s_waitcnt lgkmcnt(4)
M v[8:11],a[192:195],a[128:131],v[192:195]
ds_read_b64_tr_b16 a[216:217],v233 offset:16384
v_exp_f32 v92,v92
M v[8:11],a[196:199],a[144:147],v[8:11]
v_exp_f32 v93,v93
M v[8:11],a[200:203],a[160:163],v[8:11]
ds_read_b64_tr_b16 a[218:219],v233 offset:20480
v_cvt_pk_bf16_f32 v173,v90,v91
M v[8:11],a[204:207],a[176:179],v[8:11]
v_exp_f32 v94,v94
M v[24:27],a[204:207],a[180:183],v[196:199]
ds_read_b64_tr_b16 a[220:221],v233 offset:24576
M v[24:27],a[200:203],a[164:167],v[24:27]
v_exp_f32 v95,v95
M v[24:27],a[196:199],a[148:151],v[24:27]
ds_read_b64_tr_b16 a[222:223],v233 offset:28672
v_cvt_pk_bf16_f32 v174,v92,v93
M v[24:27],a[192:195],a[132:135],v[24:27]
v_exp_f32 v96,v96
M v[40:43],a[192:195],a[136:139],v[200:203]
v_exp_f32 v97,v97
M v[40:43],a[196:199],a[152:155],v[40:43]
v_cvt_pk_bf16_f32 v175,v94,v95
M v[40:43],a[200:203],a[168:171],v[40:43]
v_exp_f32 v98,v98
M v[40:43],a[204:207],a[184:187],v[40:43]
v_exp_f32 v99,v99
M v[56:59],a[204:207],a[188:191],v[204:207]
v_cvt_pk_bf16_f32 v176,v96,v97
M v[56:59],a[200:203],a[172:175],v[56:59]
v_exp_f32 v100,v100
M v[56:59],a[196:199],a[156:159],v[56:59]
v_exp_f32 v101,v101
M v[56:59],a[192:195],a[140:143],v[56:59]
v_cvt_pk_bf16_f32 v177,v98,v99
s_waitcnt lgkmcnt(0)
MS a[232:235],v[208:211],v[144:151],v255
ds_read_b128 a[192:195],v224 offset:28672
v_exp_f32 v102,v102
M a[64:67],a[208:211],v[128:131],a[64:67]
v_exp_f32 v103,v103
M a[64:67],a[212:215],v[132:135],a[64:67]
ds_read_b128 a[196:199],v225 offset:28672
v_cvt_pk_bf16_f32 v178,v100,v101
M a[68:71],a[212:215],v[140:143],a[68:71]
v_exp_f32 v104,v104
M a[68:71],a[208:211],v[136:139],a[68:71]
ds_read_b128 a[200:203],v226 offset:28672
M a[72:75],a[208:211],v[144:147],a[72:75]
v_exp_f32 v105,v105
M a[72:75],a[212:215],v[148:151],a[72:75]
ds_read_b128 a[204:207],v227 offset:28672
v_cvt_pk_bf16_f32 v179,v102,v103
M a[76:79],a[212:215],v[156:159],a[76:79]
v_exp_f32 v106,v106
M a[76:79],a[208:211],v[152:155],a[76:79]
v_exp_f32 v107,v107
M a[92:95],a[216:219],v[152:155],a[92:95]
ds_read_b64_tr_b16 a[208:209],v234 offset:16384
v_cvt_pk_bf16_f32 v180,v104,v105
M a[92:95],a[220:223],v[156:159],a[92:95]
v_exp_f32 v108,v108
M a[88:91],a[220:223],v[148:151],a[88:91]
ds_read_b64_tr_b16 a[210:211],v234 offset:20480
M a[88:91],a[216:219],v[144:147],a[88:91]
v_exp_f32 v109,v109
M a[84:87],a[216:219],v[136:139],a[84:87]
ds_read_b64_tr_b16 a[212:213],v234 offset:24576
v_cvt_pk_bf16_f32 v181,v106,v107
M a[84:87],a[220:223],v[140:143],a[84:87]
v_exp_f32 v110,v110
M a[80:83],a[220:223],v[132:135],a[80:83]
ds_read_b64_tr_b16 a[214:215],v234 offset:28672
M a[80:83],a[216:219],v[128:131],a[80:83]
s_waitcnt lgkmcnt(4)
M v[12:15],a[192:195],a[128:131],v[192:195]
ds_read_b64_tr_b16 a[216:217],v235 offset:16384
M v[12:15],a[196:199],a[144:147],v[12:15]
v_exp_f32 v111,v111
M v[12:15],a[200:203],a[160:163],v[12:15]
ds_read_b64_tr_b16 a[218:219],v235 offset:20480
v_cvt_pk_bf16_f32 v182,v108,v109
M v[12:15],a[204:207],a[176:179],v[12:15]
v_exp_f32 v112,v112
M v[28:31],a[204:207],a[180:183],v[196:199]
ds_read_b64_tr_b16 a[220:221],v235 offset:24576
M v[28:31],a[200:203],a[164:167],v[28:31]
v_exp_f32 v113,v113
M v[28:31],a[196:199],a[148:151],v[28:31]
ds_read_b64_tr_b16 a[222:223],v235 offset:28672
v_cvt_pk_bf16_f32 v183,v110,v111
M v[28:31],a[192:195],a[132:135],v[28:31]
v_exp_f32 v114,v114
M v[44:47],a[192:195],a[136:139],v[200:203]
v_exp_f32 v115,v115
M v[44:47],a[196:199],a[152:155],v[44:47]
v_cvt_pk_bf16_f32 v184,v112,v113
M v[44:47],a[200:203],a[168:171],v[44:47]
v_exp_f32 v116,v116
M v[44:47],a[204:207],a[184:187],v[44:47]
v_exp_f32 v117,v117
M v[60:63],a[204:207],a[188:191],v[204:207]
v_cvt_pk_bf16_f32 v185,v114,v115
M v[60:63],a[200:203],a[172:175],v[60:63]
v_exp_f32 v118,v118
M v[60:63],a[196:199],a[156:159],v[60:63]
v_exp_f32 v119,v119
M v[60:63],a[192:195],a[140:143],v[60:63]
v_cvt_pk_bf16_f32 v186,v116,v117
s_waitcnt vmcnt(16) lgkmcnt(0)
MS a[236:239],v[208:211],v[152:159],v255
s_barrier
M a[96:99],a[208:211],v[128:131],a[96:99]
ds_read_b128 a[192:195],v224 offset:32768
v_exp_f32 v120,v120
M a[96:99],a[212:215],v[132:135],a[96:99]
v_exp_f32 v121,v121
M a[100:103],a[212:215],v[140:143],a[100:103]
ds_read_b128 a[196:199],v225 offset:32768
v_cvt_pk_bf16_f32 v187,v118,v119
M a[100:103],a[208:211],v[136:139],a[100:103]
v_exp_f32 v122,v122
M a[104:107],a[208:211],v[144:147],a[104:107]
ds_read_b128 a[200:203],v226 offset:32768
M a[104:107],a[212:215],v[148:151],a[104:107]
v_exp_f32 v123,v123
M a[108:111],a[212:215],v[156:159],a[108:111]
ds_read_b128 a[204:207],v227 offset:32768
v_cvt_pk_bf16_f32 v188,v120,v121
M a[108:111],a[208:211],v[152:155],a[108:111]
v_exp_f32 v124,v124
M a[124:127],a[216:219],v[152:155],a[124:127]
ds_read_b64_tr_b16 a[208:209],v228 offset:32768
M a[124:127],a[220:223],v[156:159],a[124:127]
v_exp_f32 v125,v125
M a[120:123],a[220:223],v[148:151],a[120:123]
ds_read_b64_tr_b16 a[210:211],v228 offset:36864
v_cvt_pk_bf16_f32 v189,v122,v123
M a[120:123],a[216:219],v[144:147],a[120:123]
v_exp_f32 v126,v126
M a[116:119],a[216:219],v[136:139],a[116:119]
ds_read_b64_tr_b16 a[212:213],v228 offset:40960
M a[116:119],a[220:223],v[140:143],a[116:119]
v_exp_f32 v127,v127
M a[112:115],a[220:223],v[132:135],a[112:115]
ds_read_b64_tr_b16 a[214:215],v228 offset:45056
M a[112:115],a[216:219],v[128:131],a[112:115]
v_cvt_pk_bf16_f32 v190,v124,v125
v_cvt_pk_bf16_f32 v191,v126,v127
s_sub_u32 s61,s61,1
s_cmp_lg_u32 s61,0
s_cbranch_scc1 L_loop
buffer_load_dword v213,off,s[36:39],0 offset:128
s_waitcnt lgkmcnt(4)
M v[64:67],a[192:195],a[128:131],v[192:195]
ds_read_b64_tr_b16 a[216:217],v229 offset:32768
v_exp_f32 v0,v0
M v[64:67],a[196:199],a[144:147],v[64:67]
v_exp_f32 v1,v1
M v[64:67],a[200:203],a[160:163],v[64:67]
ds_read_b64_tr_b16 a[218:219],v229 offset:36864
M v[64:67],a[204:207],a[176:179],v[64:67]
v_exp_f32 v2,v2
M v[80:83],a[204:207],a[180:183],v[196:199]
ds_read_b64_tr_b16 a[220:221],v229 offset:40960
M v[80:83],a[200:203],a[164:167],v[80:83]
v_exp_f32 v3,v3
M v[80:83],a[196:199],a[148:151],v[80:83]
ds_read_b64_tr_b16 a[222:223],v229 offset:45056
v_cvt_pk_bf16_f32 v128,v0,v1
M v[80:83],a[192:195],a[132:135],v[80:83]
v_exp_f32 v4,v4
M v[96:99],a[192:195],a[136:139],v[200:203]
v_exp_f32 v5,v5
M v[96:99],a[196:199],a[152:155],v[96:99]
v_cvt_pk_bf16_f32 v129,v2,v3
M v[96:99],a[200:203],a[168:171],v[96:99]
v_exp_f32 v6,v6
M v[96:99],a[204:207],a[184:187],v[96:99]
v_exp_f32 v7,v7
M v[112:115],a[204:207],a[188:191],v[204:207]
v_cvt_pk_bf16_f32 v130,v4,v5
M v[112:115],a[200:203],a[172:175],v[112:115]
v_exp_f32 v8,v8
M v[112:115],a[196:199],a[156:159],v[112:115]
v_exp_f32 v9,v9
M v[112:115],a[192:195],a[140:143],v[112:115]
v_cvt_pk_bf16_f32 v131,v6,v7
s_waitcnt lgkmcnt(0)
MS a[224:227],v[208:211],v[160:167],v255
ds_read_b128 a[192:195],v224 offset:36864
v_exp_f32 v10,v10
M a[0:3],a[208:211],v[160:163],a[0:3]
v_exp_f32 v11,v11
M a[0:3],a[212:215],v[164:167],a[0:3]
ds_read_b128 a[196:199],v225 offset:36864
v_cvt_pk_bf16_f32 v132,v8,v9
M a[4:7],a[212:215],v[172:175],a[4:7]
v_exp_f32 v12,v12
M a[4:7],a[208:211],v[168:171],a[4:7]
ds_read_b128 a[200:203],v226 offset:36864
M a[8:11],a[208:211],v[176:179],a[8:11]
v_exp_f32 v13,v13
M a[8:11],a[212:215],v[180:183],a[8:11]
ds_read_b128 a[204:207],v227 offset:36864
v_cvt_pk_bf16_f32 v133,v10,v11
M a[12:15],a[212:215],v[188:191],a[12:15]
v_exp_f32 v14,v14
M a[12:15],a[208:211],v[184:187],a[12:15]
v_exp_f32 v15,v15
M a[28:31],a[216:219],v[184:187],a[28:31]
ds_read_b64_tr_b16 a[208:209],v230 offset:32768
v_cvt_pk_bf16_f32 v134,v12,v13
M a[28:31],a[220:223],v[188:191],a[28:31]
v_exp_f32 v16,v16
M a[24:27],a[220:223],v[180:183],a[24:27]
ds_read_b64_tr_b16 a[210:211],v230 offset:36864
M a[24:27],a[216:219],v[176:179],a[24:27]
v_exp_f32 v17,v17
M a[20:23],a[216:219],v[168:171],a[20:23]
ds_read_b64_tr_b16 a[212:213],v230 offset:40960
v_cvt_pk_bf16_f32 v135,v14,v15
M a[20:23],a[220:223],v[172:175],a[20:23]
v_exp_f32 v18,v18
M a[16:19],a[220:223],v[164:167],a[16:19]
ds_read_b64_tr_b16 a[214:215],v230 offset:45056
v_exp_f32 v19,v19
M a[16:19],a[216:219],v[160:163],a[16:19]
v_cvt_pk_bf16_f32 v136,v16,v17
s_waitcnt lgkmcnt(4)
M v[68:71],a[192:195],a[128:131],v[192:195]
ds_read_b64_tr_b16 a[216:217],v231 offset:32768
v_exp_f32 v20,v20
M v[68:71],a[196:199],a[144:147],v[68:71]
v_exp_f32 v21,v21
M v[68:71],a[200:203],a[160:163],v[68:71]
ds_read_b64_tr_b16 a[218:219],v231 offset:36864
v_cvt_pk_bf16_f32 v137,v18,v19
M v[68:71],a[204:207],a[176:179],v[68:71]
v_exp_f32 v22,v22
M v[84:87],a[204:207],a[180:183],v[196:199]
ds_read_b64_tr_b16 a[220:221],v231 offset:40960
M v[84:87],a[200:203],a[164:167],v[84:87]
v_exp_f32 v23,v23
M v[84:87],a[196:199],a[148:151],v[84:87]
ds_read_b64_tr_b16 a[222:223],v231 offset:45056
v_cvt_pk_bf16_f32 v138,v20,v21
M v[84:87],a[192:195],a[132:135],v[84:87]
v_exp_f32 v24,v24
M v[100:103],a[192:195],a[136:139],v[200:203]
v_exp_f32 v25,v25
M v[100:103],a[196:199],a[152:155],v[100:103]
v_cvt_pk_bf16_f32 v139,v22,v23
M v[100:103],a[200:203],a[168:171],v[100:103]
v_exp_f32 v26,v26
M v[100:103],a[204:207],a[184:187],v[100:103]
v_exp_f32 v27,v27
M v[116:119],a[204:207],a[188:191],v[204:207]
s_waitcnt vmcnt(0)
v_cvt_pk_bf16_f32 v140,v24,v25
M v[116:119],a[200:203],a[172:175],v[116:119]
v_cmp_gt_u32 vcc,0x100,v213
s_cbranch_vccnz L_slow_cnt
L_ok_cnt:
M v[116:119],a[196:199],a[156:159],v[116:119]
v_exp_f32 v28,v28
M v[116:119],a[192:195],a[140:143],v[116:119]
v_lshrrev_b32 v244,4,v242
s_waitcnt lgkmcnt(0)
MS a[228:231],v[208:211],v[168:175],v255
ds_read_b128 a[192:195],v224 offset:40960
v_exp_f32 v29,v29
M a[32:35],a[208:211],v[160:163],a[32:35]
v_lshlrev_b32 v244,8,v244
v_cvt_pk_bf16_f32 v141,v26,v27
M a[32:35],a[212:215],v[164:167],a[32:35]
ds_read_b128 a[196:199],v225 offset:40960
v_bfe_u32 v245,v242,3,1
M a[36:39],a[212:215],v[172:175],a[36:39]
v_exp_f32 v30,v30
v_lshl_add_u32 v244,v245,6,v244
M a[36:39],a[208:211],v[168:171],a[36:39]
ds_read_b128 a[200:203],v226 offset:40960
v_and_b32 v245,7,v242
M a[40:43],a[208:211],v[176:179],a[40:43]
v_exp_f32 v31,v31
v_lshl_add_u32 v244,v245,2,v244
M a[40:43],a[212:215],v[180:183],a[40:43]
ds_read_b128 a[204:207],v227 offset:40960
v_cvt_pk_bf16_f32 v142,v28,v29
M a[44:47],a[212:215],v[188:191],a[44:47]
s_andn2_b32 s50,s62,0x3ff
s_bfe_u32 s47,s3,0x10001
s_lshl_b32 s47,s47,7
s_add_u32 s50,s50,s47
s_and_b32 s47,s3,1
s_lshl_b32 s47,s47,5
s_add_u32 s50,s50,s47
buffer_load_dword v215,v244,s[32:35],s50 offen sc1
M a[44:47],a[208:211],v[184:187],a[44:47]
v_exp_f32 v32,v32
M a[60:63],a[216:219],v[184:187],a[60:63]
ds_read_b64_tr_b16 a[208:209],v232 offset:32768
M a[60:63],a[220:223],v[188:191],a[60:63]
v_exp_f32 v33,v33
M a[56:59],a[220:223],v[180:183],a[56:59]
ds_read_b64_tr_b16 a[210:211],v232 offset:36864
v_cvt_pk_bf16_f32 v143,v30,v31
M a[56:59],a[216:219],v[176:179],a[56:59]
v_exp_f32 v34,v34
M a[52:55],a[216:219],v[168:171],a[52:55]
ds_read_b64_tr_b16 a[212:213],v232 offset:40960
M a[52:55],a[220:223],v[172:175],a[52:55]
v_exp_f32 v35,v35
M a[48:51],a[220:223],v[164:167],a[48:51]
ds_read_b64_tr_b16 a[214:215],v232 offset:45056
v_cvt_pk_bf16_f32 v144,v32,v33
M a[48:51],a[216:219],v[160:163],a[48:51]
s_waitcnt lgkmcnt(4)
M v[72:75],a[192:195],a[128:131],v[192:195]
ds_read_b64_tr_b16 a[216:217],v233 offset:32768
M v[72:75],a[196:199],a[144:147],v[72:75]
v_exp_f32 v36,v36
M v[72:75],a[200:203],a[160:163],v[72:75]
ds_read_b64_tr_b16 a[218:219],v233 offset:36864
M v[72:75],a[204:207],a[176:179],v[72:75]
v_exp_f32 v37,v37
M v[88:91],a[204:207],a[180:183],v[196:199]
ds_read_b64_tr_b16 a[220:221],v233 offset:40960
v_cvt_pk_bf16_f32 v145,v34,v35
M v[88:91],a[200:203],a[164:167],v[88:91]
v_exp_f32 v38,v38
M v[88:91],a[196:199],a[148:151],v[88:91]
ds_read_b64_tr_b16 a[222:223],v233 offset:45056
s_add_u32 m0,s48,131072
s_add_u32 s47,s68,45056
M v[88:91],a[192:195],a[132:135],v[88:91]
v_exp_f32 v39,v39
M v[104:107],a[192:195],a[136:139],v[200:203]
buffer_load_dwordx4 v243,s[32:35],s47 offen offset:0 sc1 lds
M v[104:107],a[196:199],a[152:155],v[104:107]
v_cvt_pk_bf16_f32 v146,v36,v37
M v[104:107],a[200:203],a[168:171],v[104:107]
buffer_load_dwordx4 v243,s[32:35],s47 offen offset:1024 sc1 lds
M v[104:107],a[204:207],a[184:187],v[104:107]
v_exp_f32 v40,v40
M v[120:123],a[204:207],a[188:191],v[204:207]
buffer_load_dwordx4 v243,s[32:35],s47 offen offset:2048 sc1 lds
M v[120:123],a[200:203],a[172:175],v[120:123]
v_exp_f32 v41,v41
M v[120:123],a[196:199],a[156:159],v[120:123]
buffer_load_dwordx4 v243,s[32:35],s47 offen offset:3072 sc1 lds
M v[120:123],a[192:195],a[140:143],v[120:123]
v_cvt_pk_bf16_f32 v147,v38,v39
s_waitcnt lgkmcnt(0)
MS a[232:235],v[208:211],v[176:183],v255
ds_read_b128 a[192:195],v224 offset:45056
v_exp_f32 v42,v42
M a[64:67],a[208:211],v[160:163],a[64:67]
v_exp_f32 v43,v43
M a[64:67],a[212:215],v[164:167],a[64:67]
ds_read_b128 a[196:199],v225 offset:45056
v_cvt_pk_bf16_f32 v148,v40,v41
M a[68:71],a[212:215],v[172:175],a[68:71]
v_exp_f32 v44,v44
M a[68:71],a[208:211],v[168:171],a[68:71]
ds_read_b128 a[200:203],v226 offset:45056
M a[72:75],a[208:211],v[176:179],a[72:75]
v_exp_f32 v45,v45
M a[72:75],a[212:215],v[180:183],a[72:75]
ds_read_b128 a[204:207],v227 offset:45056
v_cvt_pk_bf16_f32 v149,v42,v43
M a[76:79],a[212:215],v[188:191],a[76:79]
v_exp_f32 v46,v46
M a[76:79],a[208:211],v[184:187],a[76:79]
v_exp_f32 v47,v47
M a[92:95],a[216:219],v[184:187],a[92:95]
ds_read_b64_tr_b16 a[208:209],v234 offset:32768
v_cvt_pk_bf16_f32 v150,v44,v45
M a[92:95],a[220:223],v[188:191],a[92:95]
v_exp_f32 v48,v48
M a[88:91],a[220:223],v[180:183],a[88:91]
ds_read_b64_tr_b16 a[210:211],v234 offset:36864
M a[88:91],a[216:219],v[176:179],a[88:91]
v_exp_f32 v49,v49
M a[84:87],a[216:219],v[168:171],a[84:87]
ds_read_b64_tr_b16 a[212:213],v234 offset:40960
v_cvt_pk_bf16_f32 v151,v46,v47
M a[84:87],a[220:223],v[172:175],a[84:87]
v_exp_f32 v50,v50
M a[80:83],a[220:223],v[164:167],a[80:83]
ds_read_b64_tr_b16 a[214:215],v234 offset:45056
v_exp_f32 v51,v51
M a[80:83],a[216:219],v[160:163],a[80:83]
s_nop 0
s_add_u32 s51,s46,0
buffer_load_dwordx4 v[0:3],v243,s[32:35],s51 offen offset:0 sc1
s_waitcnt lgkmcnt(4)
M v[76:79],a[192:195],a[128:131],v[192:195]
ds_read_b64_tr_b16 a[216:217],v235 offset:32768
v_cvt_pk_bf16_f32 v152,v48,v49
M v[76:79],a[196:199],a[144:147],v[76:79]
v_exp_f32 v52,v52
M v[76:79],a[200:203],a[160:163],v[76:79]
ds_read_b64_tr_b16 a[218:219],v235 offset:36864
v_exp_f32 v53,v53
M v[76:79],a[204:207],a[176:179],v[76:79]
buffer_load_dwordx4 v[4:7],v243,s[32:35],s51 offen offset:1024 sc1
M v[92:95],a[204:207],a[180:183],v[196:199]
ds_read_b64_tr_b16 a[220:221],v235 offset:40960
v_cvt_pk_bf16_f32 v153,v50,v51
M v[92:95],a[200:203],a[164:167],v[92:95]
v_exp_f32 v54,v54
M v[92:95],a[196:199],a[148:151],v[92:95]
ds_read_b64_tr_b16 a[222:223],v235 offset:45056
s_add_u32 m0,s48,16384
s_add_u32 s47,s68,49152
M v[92:95],a[192:195],a[132:135],v[92:95]
v_exp_f32 v55,v55
M v[108:111],a[192:195],a[136:139],v[200:203]
buffer_load_dwordx4 v243,s[32:35],s47 offen offset:0 sc1 lds
M v[108:111],a[196:199],a[152:155],v[108:111]
buffer_load_dwordx4 v[8:11],v243,s[32:35],s51 offen offset:2048 sc1
v_cvt_pk_bf16_f32 v154,v52,v53
M v[108:111],a[200:203],a[168:171],v[108:111]
buffer_load_dwordx4 v243,s[32:35],s47 offen offset:1024 sc1 lds
M v[108:111],a[204:207],a[184:187],v[108:111]
v_exp_f32 v56,v56
M v[124:127],a[204:207],a[188:191],v[204:207]
buffer_load_dwordx4 v243,s[32:35],s47 offen offset:2048 sc1 lds
M v[124:127],a[200:203],a[172:175],v[124:127]
buffer_load_dwordx4 v[12:15],v243,s[32:35],s51 offen offset:3072 sc1
M v[124:127],a[196:199],a[156:159],v[124:127]
buffer_load_dwordx4 v243,s[32:35],s47 offen offset:3072 sc1 lds
M v[124:127],a[192:195],a[140:143],v[124:127]
v_exp_f32 v57,v57
s_waitcnt lgkmcnt(0)
MS a[236:239],v[208:211],v[184:191],v255
s_barrier
v_cvt_pk_bf16_f32 v155,v54,v55
M a[96:99],a[208:211],v[160:163],a[96:99]
ds_read_b64_tr_b16 a[192:193],v228 offset:49152
M a[96:99],a[212:215],v[164:167],a[96:99]
s_nop 0
s_add_u32 s51,s46,4096
buffer_load_dwordx4 v[16:19],v243,s[32:35],s51 offen offset:0 sc1
M a[100:103],a[212:215],v[172:175],a[100:103]
ds_read_b64_tr_b16 a[194:195],v228 offset:53248
v_exp_f32 v58,v58
M a[100:103],a[208:211],v[168:171],a[100:103]
v_exp_f32 v59,v59
M a[104:107],a[208:211],v[176:179],a[104:107]
ds_read_b64_tr_b16 a[196:197],v228 offset:57344
v_cvt_pk_bf16_f32 v156,v56,v57
M a[104:107],a[212:215],v[180:183],a[104:107]
buffer_load_dwordx4 v[20:23],v243,s[32:35],s51 offen offset:1024 sc1
M a[108:111],a[212:215],v[188:191],a[108:111]
ds_read_b64_tr_b16 a[198:199],v228 offset:61440
v_exp_f32 v60,v60
M a[108:111],a[208:211],v[184:187],a[108:111]
v_exp_f32 v61,v61
M a[124:127],a[216:219],v[184:187],a[124:127]
ds_read_b64_tr_b16 a[200:201],v229 offset:49152
M a[124:127],a[220:223],v[188:191],a[124:127]
buffer_load_dwordx4 v[24:27],v243,s[32:35],s51 offen offset:2048 sc1
M a[120:123],a[220:223],v[180:183],a[120:123]
ds_read_b64_tr_b16 a[202:203],v229 offset:53248
v_cvt_pk_bf16_f32 v157,v58,v59
M a[120:123],a[216:219],v[176:179],a[120:123]
v_exp_f32 v62,v62
M a[116:119],a[216:219],v[168:171],a[116:119]
ds_read_b64_tr_b16 a[204:205],v229 offset:57344
v_exp_f32 v63,v63
M a[116:119],a[220:223],v[172:175],a[116:119]
buffer_load_dwordx4 v[28:31],v243,s[32:35],s51 offen offset:3072 sc1
M a[112:115],a[220:223],v[164:167],a[112:115]
ds_read_b64_tr_b16 a[206:207],v229 offset:61440
M a[112:115],a[216:219],v[160:163],a[112:115]
v_cvt_pk_bf16_f32 v158,v60,v61
v_cvt_pk_bf16_f32 v159,v62,v63
s_waitcnt lgkmcnt(0)
MS a[224:227],v[208:211],v[128:135],v255
ds_read_b64_tr_b16 a[208:209],v230 offset:49152
s_add_u32 m0,s48,81920
s_add_u32 s47,s68,53248
M a[0:3],a[192:195],v[128:131],a[0:3]
buffer_load_dwordx4 v243,s[32:35],s47 offen offset:0 sc1 lds
s_nop 0
s_add_u32 s51,s46,8192
buffer_load_dwordx4 v[32:35],v243,s[32:35],s51 offen offset:0 sc1
M a[0:3],a[196:199],v[132:135],a[0:3]
ds_read_b64_tr_b16 a[210:211],v230 offset:53248
v_exp_f32 v64,v64
v_exp_f32 v65,v65
M a[4:7],a[196:199],v[140:143],a[4:7]
buffer_load_dwordx4 v243,s[32:35],s47 offen offset:1024 sc1 lds
v_min_u32 v250,39,v242
M a[4:7],a[192:195],v[136:139],a[4:7]
ds_read_b64_tr_b16 a[212:213],v230 offset:57344
s_mul_i32 s50,s40,320
s_add_u32 s50,s50,153600
v_lshl_add_u32 v250,v250,3,s50
M a[8:11],a[192:195],v[144:147],a[8:11]
buffer_load_dwordx4 v243,s[32:35],s47 offen offset:2048 sc1 lds
v_exp_f32 v66,v66
M a[8:11],a[196:199],v[148:151],a[8:11]
ds_read_b64_tr_b16 a[214:215],v230 offset:61440
s_nop 0
ds_read_b64 v[216:217],v250 offset:0
M a[12:15],a[196:199],v[156:159],a[12:15]
buffer_load_dwordx4 v243,s[32:35],s47 offen offset:3072 sc1 lds
v_exp_f32 v67,v67
M a[12:15],a[192:195],v[152:155],a[12:15]
ds_read_b64_tr_b16 a[216:217],v231 offset:49152
s_nop 0
ds_read_b64 v[218:219],v250 offset:1280
v_cvt_pk_bf16_f32 v160,v64,v65
M a[28:31],a[200:203],v[152:155],a[28:31]
ds_read_b64 v[220:221],v250 offset:2560
v_exp_f32 v68,v68
s_nop 0
ds_read_b64 v[222:223],v250 offset:3840
M a[28:31],a[204:207],v[156:159],a[28:31]
ds_read_b64_tr_b16 a[218:219],v231 offset:53248
v_exp_f32 v69,v69
s_waitcnt vmcnt(21)
M a[24:27],a[204:207],v[148:151],a[24:27]
buffer_load_dwordx4 v[36:39],v243,s[32:35],s51 offen offset:1024 sc1
v_cvt_pk_bf16_f32 v161,v66,v67
v_exp_f32 v70,v70
v_mov_b32 v248,v215
s_nop 1
v_exp_f32 v71,v71
v_permlane32_swap_b32 v215,v248
v_add_f32 v215,v215,v248
v_mov_b32 v248,v215
M a[24:27],a[200:203],v[144:147],a[24:27]
ds_read_b64_tr_b16 a[220:221],v231 offset:57344
v_cvt_pk_bf16_f32 v162,v68,v69
s_nop 1
v_exp_f32 v72,v72
v_permlane16_swap_b32 v215,v248
v_add_f32 v215,v215,v248
v_cvt_pk_bf16_f32 v215,v215,v215
v_exp_f32 v73,v73
v_lshlrev_b32 v215,16,v215
M a[20:23],a[200:203],v[136:139],a[20:23]
buffer_load_dwordx4 v[40:43],v243,s[32:35],s51 offen offset:2048 sc1
v_cvt_pk_bf16_f32 v163,v70,v71
v_exp_f32 v74,v74
v_mul_f32 v248,0xbfb8aa3b,v215
v_exp_f32 v248,v248
M a[20:23],a[204:207],v[140:143],a[20:23]
ds_read_b64_tr_b16 a[222:223],v231 offset:61440
v_exp_f32 v75,v75
v_mov_b32_dpp v249,v215 row_ror:8 row_mask:0xf bank_mask:0xf
v_add_f32 v248,1.0,v248
v_rcp_f32 v248,v248
M a[16:19],a[204:207],v[132:135],a[16:19]
v_cvt_pk_bf16_f32 v164,v72,v73
v_exp_f32 v76,v76
v_cmp_gt_u32 vcc,40,v242
v_mul_f32 v215,v215,v248
v_cvt_pk_bf16_f32 v215,v215,v215
v_exp_f32 v77,v77
M a[16:19],a[200:203],v[128:131],a[16:19]
buffer_load_dwordx4 v[44:47],v243,s[32:35],s51 offen offset:3072 sc1
v_cvt_pk_bf16_f32 v165,v74,v75
v_lshlrev_b32 v215,16,v215
v_exp_f32 v78,v78
s_waitcnt lgkmcnt(0)
MS a[228:231],v[208:211],v[136:143],v255
ds_read_b64_tr_b16 a[192:193],v232 offset:49152
v_mul_f32 v215,v215,v249
v_cvt_pk_bf16_f32 v215,v215,v215
v_lshlrev_b32 v215,16,v215
s_add_u32 m0,s48,49152
s_add_u32 s47,s68,57344
M a[32:35],a[208:211],v[128:131],a[32:35]
buffer_load_dwordx4 v243,s[32:35],s47 offen offset:0 sc1 lds
v_exp_f32 v79,v79
v_lshlrev_b32 v251,4,v242
v_readlane_b32 s84,v215,0
M a[32:35],a[212:215],v[132:135],a[32:35]
ds_read_b64_tr_b16 a[194:195],v232 offset:53248
v_cvt_pk_bf16_f32 v166,v76,v77
v_readlane_b32 s85,v215,1
v_readlane_b32 s86,v215,2
v_exp_f32 v80,v80
M a[36:39],a[212:215],v[140:143],a[36:39]
buffer_load_dwordx4 v243,s[32:35],s47 offen offset:1024 sc1 lds
v_readlane_b32 s87,v215,3
s_nop 0
s_add_u32 s51,s46,12288
buffer_load_dwordx4 v[48:51],v243,s[32:35],s51 offen offset:0 sc1
M a[36:39],a[208:211],v[136:139],a[36:39]
ds_read_b64_tr_b16 a[196:197],v232 offset:57344
v_exp_f32 v81,v81
v_cvt_pk_bf16_f32 v167,v78,v79
v_readlane_b32 s88,v215,4
v_readlane_b32 s89,v215,5
M a[40:43],a[208:211],v[144:147],a[40:43]
buffer_load_dwordx4 v243,s[32:35],s47 offen offset:2048 sc1 lds
v_exp_f32 v82,v82
v_readlane_b32 s90,v215,6
v_readlane_b32 s91,v215,7
M a[40:43],a[212:215],v[148:151],a[40:43]
ds_read_b64_tr_b16 a[198:199],v232 offset:61440
v_exp_f32 v83,v83
v_mov_b32 v252,41943040
v_cndmask_b32 v251,v252,v251,vcc
M a[44:47],a[212:215],v[156:159],a[44:47]
buffer_load_dwordx4 v243,s[32:35],s47 offen offset:3072 sc1 lds
v_cvt_pk_bf16_f32 v168,v80,v81
v_lshlrev_b32 v252,16,v216
v_exp_f32 v84,v84
v_mul_f32 v244,s84,v252
M a[44:47],a[208:211],v[152:155],a[44:47]
ds_read_b64_tr_b16 a[200:201],v233 offset:49152
v_and_b32 v252,0xffff0000,v216
v_mul_f32 v245,s84,v252
v_exp_f32 v85,v85
v_lshlrev_b32 v252,16,v217
v_mul_f32 v246,s84,v252
M a[60:63],a[216:219],v[152:155],a[60:63]
buffer_load_dwordx4 v[52:55],v243,s[32:35],s51 offen offset:1024 sc1
v_cvt_pk_bf16_f32 v169,v82,v83
v_exp_f32 v86,v86
v_and_b32 v252,0xffff0000,v217
M a[60:63],a[220:223],v[156:159],a[60:63]
ds_read_b64_tr_b16 a[202:203],v233 offset:53248
v_mul_f32 v247,s84,v252
v_exp_f32 v87,v87
v_lshlrev_b32 v252,16,v218
v_fmac_f32 v244,s85,v252
M a[56:59],a[220:223],v[148:151],a[56:59]
v_and_b32 v252,0xffff0000,v218
v_cvt_pk_bf16_f32 v170,v84,v85
v_fmac_f32 v245,s85,v252
v_exp_f32 v88,v88
v_lshlrev_b32 v252,16,v219
M a[56:59],a[216:219],v[144:147],a[56:59]
ds_read_b64_tr_b16 a[204:205],v233 offset:57344
v_fmac_f32 v246,s85,v252
v_and_b32 v252,0xffff0000,v219
v_exp_f32 v89,v89
v_fmac_f32 v247,s85,v252
M a[52:55],a[216:219],v[136:139],a[52:55]
buffer_load_dwordx4 v[56:59],v243,s[32:35],s51 offen offset:2048 sc1
v_cvt_pk_bf16_f32 v171,v86,v87
v_exp_f32 v90,v90
v_lshlrev_b32 v252,16,v220
M a[52:55],a[220:223],v[140:143],a[52:55]
ds_read_b64_tr_b16 a[206:207],v233 offset:61440
v_fmac_f32 v244,s86,v252
v_and_b32 v252,0xffff0000,v220
v_exp_f32 v91,v91
v_fmac_f32 v245,s86,v252
v_lshlrev_b32 v252,16,v221
M a[48:51],a[220:223],v[132:135],a[48:51]
v_cvt_pk_bf16_f32 v172,v88,v89
v_fmac_f32 v246,s86,v252
v_and_b32 v252,0xffff0000,v221
v_exp_f32 v92,v92
v_fmac_f32 v247,s86,v252
v_lshlrev_b32 v252,16,v222
M a[48:51],a[216:219],v[128:131],a[48:51]
buffer_load_dwordx4 v[60:63],v243,s[32:35],s51 offen offset:3072 sc1
s_waitcnt lgkmcnt(0)
MS a[232:235],v[208:211],v[144:151],v255
ds_read_b64_tr_b16 a[208:209],v234 offset:49152
s_add_u32 m0,s48,32768
s_add_u32 s47,s68,61440
M a[64:67],a[192:195],v[128:131],a[64:67]
buffer_load_dwordx4 v243,s[32:35],s47 offen offset:0 sc1 lds
v_exp_f32 v93,v93
M a[64:67],a[196:199],v[132:135],a[64:67]
ds_read_b64_tr_b16 a[210:211],v234 offset:53248
v_cvt_pk_bf16_f32 v173,v90,v91
v_fmac_f32 v244,s87,v252
v_and_b32 v252,0xffff0000,v222
M a[68:71],a[196:199],v[140:143],a[68:71]
buffer_load_dwordx4 v243,s[32:35],s47 offen offset:1024 sc1 lds
v_exp_f32 v94,v94
M a[68:71],a[192:195],v[136:139],a[68:71]
ds_read_b64_tr_b16 a[212:213],v234 offset:57344
v_fmac_f32 v245,s87,v252
v_lshlrev_b32 v252,16,v223
M a[72:75],a[192:195],v[144:147],a[72:75]
buffer_load_dwordx4 v243,s[32:35],s47 offen offset:2048 sc1 lds
v_exp_f32 v95,v95
M a[72:75],a[196:199],v[148:151],a[72:75]
ds_read_b64_tr_b16 a[214:215],v234 offset:61440
v_fmac_f32 v246,s87,v252
v_and_b32 v252,0xffff0000,v223
v_fmac_f32 v247,s87,v252
M a[76:79],a[196:199],v[156:159],a[76:79]
buffer_load_dwordx4 v243,s[32:35],s47 offen offset:3072 sc1 lds
v_cvt_pk_bf16_f32 v174,v92,v93
s_nop 0
ds_read_b64 v[216:217],v250 offset:5120
M a[76:79],a[192:195],v[152:155],a[76:79]
ds_read_b64_tr_b16 a[216:217],v235 offset:49152
v_exp_f32 v96,v96
M a[92:95],a[200:203],v[152:155],a[92:95]
ds_read_b64 v[218:219],v250 offset:6400
v_exp_f32 v97,v97
s_nop 0
s_add_u32 s51,s46,16384
buffer_load_dwordx4 a[160:163],v243,s[32:35],s51 offen offset:0 sc1
M a[92:95],a[204:207],v[156:159],a[92:95]
ds_read_b64_tr_b16 a[218:219],v235 offset:53248
v_cvt_pk_bf16_f32 v175,v94,v95
v_exp_f32 v98,v98
M a[88:91],a[204:207],v[148:151],a[88:91]
ds_read_b64 v[220:221],v250 offset:7680
s_nop 0
ds_read_b64 v[222:223],v250 offset:8960
v_exp_f32 v99,v99
M a[88:91],a[200:203],v[144:147],a[88:91]
ds_read_b64_tr_b16 a[220:221],v235 offset:57344
s_waitcnt lgkmcnt(1)
v_lshlrev_b32 v252,16,v216
v_cvt_pk_bf16_f32 v176,v96,v97
v_fmac_f32 v244,s88,v252
M a[84:87],a[200:203],v[136:139],a[84:87]
v_exp_f32 v100,v100
v_and_b32 v252,0xffff0000,v216
v_fmac_f32 v245,s88,v252
v_lshlrev_b32 v252,16,v217
M a[84:87],a[204:207],v[140:143],a[84:87]
ds_read_b64_tr_b16 a[222:223],v235 offset:61440
v_exp_f32 v101,v101
v_fmac_f32 v246,s88,v252
v_and_b32 v252,0xffff0000,v217
M a[80:83],a[204:207],v[132:135],a[80:83]
buffer_load_dwordx4 a[164:167],v243,s[32:35],s51 offen offset:1024 sc1
v_cvt_pk_bf16_f32 v177,v98,v99
v_exp_f32 v102,v102
v_fmac_f32 v247,s88,v252
M a[80:83],a[200:203],v[128:131],a[80:83]
v_lshlrev_b32 v252,16,v218
v_exp_f32 v103,v103
v_fmac_f32 v244,s89,v252
v_and_b32 v252,0xffff0000,v218
s_waitcnt lgkmcnt(0)
MS a[236:239],v[208:211],v[152:159],v255
s_barrier
v_cvt_pk_bf16_f32 v178,v100,v101
v_fmac_f32 v245,s89,v252
v_lshlrev_b32 v252,16,v219
v_exp_f32 v104,v104
M a[96:99],a[208:211],v[128:131],a[96:99]
ds_read_b64_tr_b16 a[192:193],v228 offset:0
v_fmac_f32 v246,s89,v252
v_and_b32 v252,0xffff0000,v219
v_fmac_f32 v247,s89,v252
v_exp_f32 v105,v105
M a[96:99],a[212:215],v[132:135],a[96:99]
buffer_load_dwordx4 a[168:171],v243,s[32:35],s51 offen offset:2048 sc1
v_cvt_pk_bf16_f32 v179,v102,v103
v_lshlrev_b32 v252,16,v220
v_exp_f32 v106,v106
M a[100:103],a[212:215],v[140:143],a[100:103]
ds_read_b64_tr_b16 a[194:195],v228 offset:4096
v_fmac_f32 v244,s90,v252
v_and_b32 v252,0xffff0000,v220
v_exp_f32 v107,v107
v_fmac_f32 v245,s90,v252
M a[100:103],a[208:211],v[136:139],a[100:103]
v_lshlrev_b32 v252,16,v221
v_fmac_f32 v246,s90,v252
v_cvt_pk_bf16_f32 v180,v104,v105
v_and_b32 v252,0xffff0000,v221
v_exp_f32 v108,v108
M a[104:107],a[208:211],v[144:147],a[104:107]
ds_read_b64_tr_b16 a[196:197],v228 offset:8192
v_fmac_f32 v247,s90,v252
v_lshlrev_b32 v252,16,v222
v_fmac_f32 v244,s91,v252
v_exp_f32 v109,v109
M a[104:107],a[212:215],v[148:151],a[104:107]
buffer_load_dwordx4 a[172:175],v243,s[32:35],s51 offen offset:3072 sc1
v_cvt_pk_bf16_f32 v181,v106,v107
v_and_b32 v252,0xffff0000,v222
v_exp_f32 v110,v110
v_fmac_f32 v245,s91,v252
M a[108:111],a[212:215],v[156:159],a[108:111]
ds_read_b64_tr_b16 a[198:199],v228 offset:12288
v_lshlrev_b32 v252,16,v223
v_fmac_f32 v246,s91,v252
v_exp_f32 v111,v111
v_and_b32 v252,0xffff0000,v223
v_fmac_f32 v247,s91,v252
M a[108:111],a[208:211],v[152:155],a[108:111]
buffer_store_dwordx4 v[244:247],v251,s[32:35],s80 offen sc1
v_cvt_pk_bf16_f32 v182,v108,v109
v_exp_f32 v112,v112
M a[124:127],a[216:219],v[152:155],a[124:127]
ds_read_b64_tr_b16 a[200:201],v229 offset:0
v_exp_f32 v113,v113
v_cvt_pk_bf16_f32 v183,v110,v111
M a[124:127],a[220:223],v[156:159],a[124:127]
v_exp_f32 v114,v114
v_exp_f32 v115,v115
v_cvt_pk_bf16_f32 v184,v112,v113
M a[120:123],a[220:223],v[148:151],a[120:123]
ds_read_b64_tr_b16 a[202:203],v229 offset:4096
v_exp_f32 v116,v116
v_exp_f32 v117,v117
M a[120:123],a[216:219],v[144:147],a[120:123]
v_cvt_pk_bf16_f32 v185,v114,v115
v_exp_f32 v118,v118
v_exp_f32 v119,v119
v_cvt_pk_bf16_f32 v186,v116,v117
M a[116:119],a[216:219],v[136:139],a[116:119]
ds_read_b64_tr_b16 a[204:205],v229 offset:8192
v_exp_f32 v120,v120
v_exp_f32 v121,v121
v_cvt_pk_bf16_f32 v187,v118,v119
M a[116:119],a[220:223],v[140:143],a[116:119]
v_exp_f32 v122,v122
v_exp_f32 v123,v123
v_cvt_pk_bf16_f32 v188,v120,v121
M a[112:115],a[220:223],v[132:135],a[112:115]
ds_read_b64_tr_b16 a[206:207],v229 offset:12288
v_exp_f32 v124,v124
v_exp_f32 v125,v125
v_cvt_pk_bf16_f32 v189,v122,v123
M a[112:115],a[216:219],v[128:131],a[112:115]
v_exp_f32 v126,v126
v_exp_f32 v127,v127
v_cvt_pk_bf16_f32 v190,v124,v125
v_cvt_pk_bf16_f32 v191,v126,v127
MS a[224:227],v[208:211],v[160:167],v255
ds_read_b64_tr_b16 a[208:209],v230 offset:0
MS a[228:231],v[208:211],v[168:175],v255
ds_read_b64_tr_b16 a[210:211],v230 offset:4096
MS a[232:235],v[208:211],v[176:183],v255
ds_read_b64_tr_b16 a[212:213],v230 offset:8192
MS a[236:239],v[208:211],v[184:191],v255
ds_read_b64_tr_b16 a[214:215],v230 offset:12288
s_waitcnt lgkmcnt(4)
M a[0:3],a[192:195],v[160:163],a[0:3]
ds_read_b64_tr_b16 a[216:217],v231 offset:0
M a[0:3],a[196:199],v[164:167],a[0:3]
ds_read_b64_tr_b16 a[218:219],v231 offset:4096
M a[4:7],a[196:199],v[172:175],a[4:7]
ds_read_b64_tr_b16 a[220:221],v231 offset:8192
M a[4:7],a[192:195],v[168:171],a[4:7]
ds_read_b64_tr_b16 a[222:223],v231 offset:12288
M a[8:11],a[192:195],v[176:179],a[8:11]
s_add_u32 m0,s48,0
s_add_u32 s47,s68,65536
M a[8:11],a[196:199],v[180:183],a[8:11]
buffer_load_dwordx4 v243,s[32:35],s47 offen offset:0 sc1 lds
v_accvgpr_read_b32 v216,a224
v_accvgpr_read_b32 v217,a228
v_accvgpr_read_b32 v218,a232
v_accvgpr_read_b32 v219,a236
M a[12:15],a[196:199],v[188:191],a[12:15]
buffer_load_dwordx4 v243,s[32:35],s47 offen offset:1024 sc1 lds
v_accvgpr_read_b32 v220,a225
v_accvgpr_read_b32 v221,a229
v_accvgpr_read_b32 v222,a233
v_accvgpr_read_b32 v223,a237
v_add_f32 v216,v216,v220
M a[12:15],a[192:195],v[184:187],a[12:15]
buffer_load_dwordx4 v243,s[32:35],s47 offen offset:2048 sc1 lds
v_add_f32 v217,v217,v221
v_add_f32 v218,v218,v222
v_add_f32 v219,v219,v223
v_mov_b32 v220,v216
M a[28:31],a[200:203],v[184:187],a[28:31]
buffer_load_dwordx4 v243,s[32:35],s47 offen offset:3072 sc1 lds
v_mov_b32 v221,v217
v_mov_b32 v222,v218
v_mov_b32 v223,v219
s_nop 0
M a[28:31],a[204:207],v[188:191],a[28:31]
v_permlane32_swap_b32 v216,v220
v_permlane32_swap_b32 v217,v221
s_nop 0
s_add_u32 s51,s46,20480
buffer_load_dwordx4 a[176:179],v243,s[32:35],s51 offen offset:0 sc1
M a[24:27],a[204:207],v[180:183],a[24:27]
v_permlane32_swap_b32 v218,v222
v_permlane32_swap_b32 v219,v223
v_add_f32 v216,v216,v220
v_add_f32 v217,v217,v221
v_add_f32 v218,v218,v222
v_add_f32 v219,v219,v223
v_mov_b32 v220,v216
M a[24:27],a[200:203],v[176:179],a[24:27]
v_mov_b32 v221,v217
v_mov_b32 v222,v218
v_mov_b32 v223,v219
s_nop 0
v_permlane16_swap_b32 v216,v220
v_permlane16_swap_b32 v217,v221
M a[20:23],a[200:203],v[168:171],a[20:23]
v_permlane16_swap_b32 v218,v222
v_permlane16_swap_b32 v219,v223
v_add_f32 v216,v216,v220
v_add_f32 v217,v217,v221
v_add_f32 v218,v218,v222
v_add_f32 v219,v219,v223
M a[20:23],a[204:207],v[172:175],a[20:23]
v_rcp_f32 v192,v216
v_rcp_f32 v196,v217
v_rcp_f32 v200,v218
M a[16:19],a[204:207],v[164:167],a[16:19]
v_rcp_f32 v204,v219
v_add_f32 v220,v216,v217
v_add_f32 v221,v218,v219
v_add_f32 v220,v220,v221
v_cmp_ngt_f32 vcc,0x5d800000,v220
v_lshlrev_b32 v222,2,v242
M a[16:19],a[200:203],v[160:163],a[16:19]
v_add_u32 v222,98304,v222
v_cndmask_b32 v220,0,1,vcc
s_lshl_b32 s50,s40,8
v_add_u32 v221,s50,v222
s_nop 0
ds_write_b32 v221,v220
s_waitcnt lgkmcnt(1)
s_waitcnt vmcnt(6)
M a[32:35],a[208:211],v[160:163],a[32:35]
ds_read_b64_tr_b16 a[192:193],v232 offset:0
M a[32:35],a[212:215],v[164:167],a[32:35]
ds_read_b64_tr_b16 a[194:195],v232 offset:4096
M a[36:39],a[212:215],v[172:175],a[36:39]
ds_read_b64_tr_b16 a[196:197],v232 offset:8192
M a[36:39],a[208:211],v[168:171],a[36:39]
ds_read_b64_tr_b16 a[198:199],v232 offset:12288
M a[40:43],a[208:211],v[176:179],a[40:43]
ds_read_b64_tr_b16 a[200:201],v233 offset:0
M a[40:43],a[212:215],v[180:183],a[40:43]
ds_read_b64_tr_b16 a[202:203],v233 offset:4096
s_nop 0
buffer_load_dwordx4 a[180:183],v243,s[32:35],s51 offen offset:1024 sc1
v_accvgpr_read_b32 v64,a0
v_accvgpr_read_b32 v65,a1
v_accvgpr_read_b32 v66,a2
v_accvgpr_read_b32 v67,a3
v_accvgpr_read_b32 v68,a16
v_accvgpr_read_b32 v69,a17
M a[44:47],a[212:215],v[188:191],a[44:47]
ds_read_b64_tr_b16 a[204:205],v233 offset:8192
v_accvgpr_read_b32 v70,a18
v_accvgpr_read_b32 v71,a19
v_mul_f32 v64,v64,v192
v_mul_f32 v65,v65,v192
v_mul_f32 v66,v66,v192
v_mul_f32 v67,v67,v192
v_mul_f32 v68,v68,v192
v_mul_f32 v69,v69,v192
v_mul_f32 v70,v70,v192
M a[44:47],a[208:211],v[184:187],a[44:47]
ds_read_b64_tr_b16 a[206:207],v233 offset:12288
v_mul_f32 v71,v71,v192
v_cvt_pk_bf16_f32 v96,v64,v65
v_cvt_pk_bf16_f32 v97,v66,v67
v_cvt_pk_bf16_f32 v98,v68,v69
v_cvt_pk_bf16_f32 v99,v70,v71
s_nop 0
buffer_store_dwordx4 v[96:99],v243,s[32:35],s49 offen offset:0 sc1
v_accvgpr_read_b32 v72,a4
M a[60:63],a[216:219],v[184:187],a[60:63]
v_accvgpr_read_b32 v73,a5
v_accvgpr_read_b32 v74,a6
v_accvgpr_read_b32 v75,a7
v_accvgpr_read_b32 v76,a20
v_accvgpr_read_b32 v77,a21
v_accvgpr_read_b32 v78,a22
v_accvgpr_read_b32 v79,a23
v_mul_f32 v72,v72,v196
s_add_u32 m0,s48,114688
s_add_u32 s47,s68,69632
M a[60:63],a[220:223],v[188:191],a[60:63]
buffer_load_dwordx4 v243,s[32:35],s47 offen offset:0 sc1 lds
v_mul_f32 v73,v73,v196
v_mul_f32 v74,v74,v196
v_mul_f32 v75,v75,v196
v_mul_f32 v76,v76,v196
v_mul_f32 v77,v77,v196
v_mul_f32 v78,v78,v196
v_mul_f32 v79,v79,v196
v_cvt_pk_bf16_f32 v100,v72,v73
M a[56:59],a[220:223],v[180:183],a[56:59]
buffer_load_dwordx4 v243,s[32:35],s47 offen offset:1024 sc1 lds
v_cvt_pk_bf16_f32 v101,v74,v75
v_cvt_pk_bf16_f32 v102,v76,v77
v_cvt_pk_bf16_f32 v103,v78,v79
s_nop 0
buffer_store_dwordx4 v[100:103],v243,s[32:35],s49 offen offset:1024 sc1
v_accvgpr_read_b32 v80,a8
M a[56:59],a[216:219],v[176:179],a[56:59]
buffer_load_dwordx4 v243,s[32:35],s47 offen offset:2048 sc1 lds
v_accvgpr_read_b32 v81,a9
v_accvgpr_read_b32 v82,a10
v_accvgpr_read_b32 v83,a11
v_accvgpr_read_b32 v84,a24
v_accvgpr_read_b32 v85,a25
v_accvgpr_read_b32 v86,a26
v_accvgpr_read_b32 v87,a27
v_mul_f32 v80,v80,v200
M a[52:55],a[216:219],v[168:171],a[52:55]
buffer_load_dwordx4 v243,s[32:35],s47 offen offset:3072 sc1 lds
v_mul_f32 v81,v81,v200
v_mul_f32 v82,v82,v200
v_mul_f32 v83,v83,v200
v_mul_f32 v84,v84,v200
v_mul_f32 v85,v85,v200
v_mul_f32 v86,v86,v200
v_mul_f32 v87,v87,v200
v_cvt_pk_bf16_f32 v104,v80,v81
M a[52:55],a[220:223],v[172:175],a[52:55]
v_cvt_pk_bf16_f32 v105,v82,v83
v_cvt_pk_bf16_f32 v106,v84,v85
v_cvt_pk_bf16_f32 v107,v86,v87
s_nop 0
buffer_store_dwordx4 v[104:107],v243,s[32:35],s49 offen offset:2048 sc1
v_accvgpr_read_b32 v88,a12
v_accvgpr_read_b32 v89,a13
v_accvgpr_read_b32 v90,a14
v_accvgpr_read_b32 v91,a15
M a[48:51],a[220:223],v[164:167],a[48:51]
v_accvgpr_read_b32 v92,a28
v_accvgpr_read_b32 v93,a29
v_accvgpr_read_b32 v94,a30
v_accvgpr_read_b32 v95,a31
v_mul_f32 v88,v88,v204
v_mul_f32 v89,v89,v204
v_mul_f32 v90,v90,v204
v_mul_f32 v91,v91,v204
v_mul_f32 v92,v92,v204
v_mul_f32 v93,v93,v204
M a[48:51],a[216:219],v[160:163],a[48:51]
v_mul_f32 v94,v94,v204
v_mul_f32 v95,v95,v204
v_cvt_pk_bf16_f32 v108,v88,v89
v_cvt_pk_bf16_f32 v109,v90,v91
v_cvt_pk_bf16_f32 v110,v92,v93
v_cvt_pk_bf16_f32 v111,v94,v95
s_nop 0
buffer_store_dwordx4 v[108:111],v243,s[32:35],s49 offen offset:3072 sc1
s_add_u32 s49,s49,4096
s_waitcnt lgkmcnt(0)
M a[64:67],a[192:195],v[160:163],a[64:67]
ds_read_b64_tr_b16 a[208:209],v234 offset:0
M a[64:67],a[196:199],v[164:167],a[64:67]
ds_read_b64_tr_b16 a[210:211],v234 offset:4096
M a[68:71],a[196:199],v[172:175],a[68:71]
ds_read_b64_tr_b16 a[212:213],v234 offset:8192
M a[68:71],a[192:195],v[168:171],a[68:71]
ds_read_b64_tr_b16 a[214:215],v234 offset:12288
M a[72:75],a[192:195],v[176:179],a[72:75]
ds_read_b64_tr_b16 a[216:217],v235 offset:0
M a[72:75],a[196:199],v[180:183],a[72:75]
ds_read_b64_tr_b16 a[218:219],v235 offset:4096
s_nop 0
buffer_load_dwordx4 a[184:187],v243,s[32:35],s51 offen offset:2048 sc1
v_accvgpr_read_b32 v64,a32
v_accvgpr_read_b32 v65,a33
v_accvgpr_read_b32 v66,a34
v_accvgpr_read_b32 v67,a35
v_accvgpr_read_b32 v68,a48
v_accvgpr_read_b32 v69,a49
M a[76:79],a[196:199],v[188:191],a[76:79]
ds_read_b64_tr_b16 a[220:221],v235 offset:8192
v_accvgpr_read_b32 v70,a50
v_accvgpr_read_b32 v71,a51
v_mul_f32 v64,v64,v192
v_mul_f32 v65,v65,v192
v_mul_f32 v66,v66,v192
v_mul_f32 v67,v67,v192
v_mul_f32 v68,v68,v192
v_mul_f32 v69,v69,v192
v_mul_f32 v70,v70,v192
M a[76:79],a[192:195],v[184:187],a[76:79]
ds_read_b64_tr_b16 a[222:223],v235 offset:12288
v_mul_f32 v71,v71,v192
v_cvt_pk_bf16_f32 v112,v64,v65
v_cvt_pk_bf16_f32 v113,v66,v67
v_cvt_pk_bf16_f32 v114,v68,v69
v_cvt_pk_bf16_f32 v115,v70,v71
s_nop 0
buffer_store_dwordx4 v[112:115],v243,s[32:35],s49 offen offset:0 sc1
v_accvgpr_read_b32 v72,a36
M a[92:95],a[200:203],v[184:187],a[92:95]
v_accvgpr_read_b32 v73,a37
v_accvgpr_read_b32 v74,a38
v_accvgpr_read_b32 v75,a39
v_accvgpr_read_b32 v76,a52
v_accvgpr_read_b32 v77,a53
v_accvgpr_read_b32 v78,a54
v_accvgpr_read_b32 v79,a55
v_mul_f32 v72,v72,v196
s_add_u32 m0,s48,147456
s_add_u32 s47,s68,73728
M a[92:95],a[204:207],v[188:191],a[92:95]
buffer_load_dwordx4 v243,s[32:35],s47 offen offset:0 sc1 lds
v_mul_f32 v73,v73,v196
v_mul_f32 v74,v74,v196
v_mul_f32 v75,v75,v196
v_mul_f32 v76,v76,v196
v_mul_f32 v77,v77,v196
v_mul_f32 v78,v78,v196
v_mul_f32 v79,v79,v196
v_cvt_pk_bf16_f32 v116,v72,v73
M a[88:91],a[204:207],v[180:183],a[88:91]
buffer_load_dwordx4 v243,s[32:35],s47 offen offset:1024 sc1 lds
v_cvt_pk_bf16_f32 v117,v74,v75
v_cvt_pk_bf16_f32 v118,v76,v77
v_cvt_pk_bf16_f32 v119,v78,v79
s_nop 0
buffer_store_dwordx4 v[116:119],v243,s[32:35],s49 offen offset:1024 sc1
v_accvgpr_read_b32 v80,a40
M a[88:91],a[200:203],v[176:179],a[88:91]
buffer_load_dwordx4 v243,s[32:35],s47 offen offset:2048 sc1 lds
v_accvgpr_read_b32 v81,a41
v_accvgpr_read_b32 v82,a42
v_accvgpr_read_b32 v83,a43
v_accvgpr_read_b32 v84,a56
v_accvgpr_read_b32 v85,a57
v_accvgpr_read_b32 v86,a58
v_accvgpr_read_b32 v87,a59
v_mul_f32 v80,v80,v200
M a[84:87],a[200:203],v[168:171],a[84:87]
buffer_load_dwordx4 v243,s[32:35],s47 offen offset:3072 sc1 lds
v_mul_f32 v81,v81,v200
v_mul_f32 v82,v82,v200
v_mul_f32 v83,v83,v200
v_mul_f32 v84,v84,v200
v_mul_f32 v85,v85,v200
v_mul_f32 v86,v86,v200
v_mul_f32 v87,v87,v200
v_cvt_pk_bf16_f32 v120,v80,v81
M a[84:87],a[204:207],v[172:175],a[84:87]
v_cvt_pk_bf16_f32 v121,v82,v83
v_cvt_pk_bf16_f32 v122,v84,v85
v_cvt_pk_bf16_f32 v123,v86,v87
s_nop 0
buffer_store_dwordx4 v[120:123],v243,s[32:35],s49 offen offset:2048 sc1
v_accvgpr_read_b32 v88,a44
v_accvgpr_read_b32 v89,a45
v_accvgpr_read_b32 v90,a46
v_accvgpr_read_b32 v91,a47
M a[80:83],a[204:207],v[164:167],a[80:83]
v_accvgpr_read_b32 v92,a60
v_accvgpr_read_b32 v93,a61
v_accvgpr_read_b32 v94,a62
v_accvgpr_read_b32 v95,a63
v_mul_f32 v88,v88,v204
v_mul_f32 v89,v89,v204
v_mul_f32 v90,v90,v204
v_mul_f32 v91,v91,v204
v_mul_f32 v92,v92,v204
v_mul_f32 v93,v93,v204
M a[80:83],a[200:203],v[160:163],a[80:83]
v_mul_f32 v94,v94,v204
v_mul_f32 v95,v95,v204
v_cvt_pk_bf16_f32 v124,v88,v89
v_cvt_pk_bf16_f32 v125,v90,v91
v_cvt_pk_bf16_f32 v126,v92,v93
v_cvt_pk_bf16_f32 v127,v94,v95
s_nop 0
buffer_store_dwordx4 v[124:127],v243,s[32:35],s49 offen offset:3072 sc1
s_add_u32 s49,s49,4096
s_waitcnt lgkmcnt(0)
M a[96:99],a[208:211],v[160:163],a[96:99]
M a[96:99],a[212:215],v[164:167],a[96:99]
M a[100:103],a[212:215],v[172:175],a[100:103]
M a[100:103],a[208:211],v[168:171],a[100:103]
M a[104:107],a[208:211],v[176:179],a[104:107]
M a[104:107],a[212:215],v[180:183],a[104:107]
buffer_load_dwordx4 a[188:191],v243,s[32:35],s51 offen offset:3072 sc1
v_accvgpr_read_b32 v64,a64
v_accvgpr_read_b32 v65,a65
v_accvgpr_read_b32 v66,a66
v_accvgpr_read_b32 v67,a67
v_accvgpr_read_b32 v68,a80
v_accvgpr_read_b32 v69,a81
M a[108:111],a[212:215],v[188:191],a[108:111]
v_accvgpr_read_b32 v70,a82
v_accvgpr_read_b32 v71,a83
v_mul_f32 v64,v64,v192
v_mul_f32 v65,v65,v192
v_mul_f32 v66,v66,v192
v_mul_f32 v67,v67,v192
v_mul_f32 v68,v68,v192
v_mul_f32 v69,v69,v192
M a[108:111],a[208:211],v[184:187],a[108:111]
v_mul_f32 v70,v70,v192
v_mul_f32 v71,v71,v192
v_cvt_pk_bf16_f32 v96,v64,v65
v_cvt_pk_bf16_f32 v97,v66,v67
v_cvt_pk_bf16_f32 v98,v68,v69
v_cvt_pk_bf16_f32 v99,v70,v71
s_nop 0
buffer_store_dwordx4 v[96:99],v243,s[32:35],s49 offen offset:0 sc1
M a[124:127],a[216:219],v[184:187],a[124:127]
v_accvgpr_read_b32 v72,a68
v_accvgpr_read_b32 v73,a69
v_accvgpr_read_b32 v74,a70
v_accvgpr_read_b32 v75,a71
v_accvgpr_read_b32 v76,a84
v_accvgpr_read_b32 v77,a85
v_accvgpr_read_b32 v78,a86
v_accvgpr_read_b32 v79,a87
v_mul_f32 v72,v72,v196
M a[124:127],a[220:223],v[188:191],a[124:127]
v_mul_f32 v73,v73,v196
v_mul_f32 v74,v74,v196
v_mul_f32 v75,v75,v196
v_mul_f32 v76,v76,v196
v_mul_f32 v77,v77,v196
v_mul_f32 v78,v78,v196
v_mul_f32 v79,v79,v196
v_cvt_pk_bf16_f32 v100,v72,v73
v_cvt_pk_bf16_f32 v101,v74,v75
M a[120:123],a[220:223],v[180:183],a[120:123]
v_cvt_pk_bf16_f32 v102,v76,v77
v_cvt_pk_bf16_f32 v103,v78,v79
s_nop 0
buffer_store_dwordx4 v[100:103],v243,s[32:35],s49 offen offset:1024 sc1
v_accvgpr_read_b32 v80,a72
v_accvgpr_read_b32 v81,a73
v_accvgpr_read_b32 v82,a74
M a[120:123],a[216:219],v[176:179],a[120:123]
v_accvgpr_read_b32 v83,a75
v_accvgpr_read_b32 v84,a88
v_accvgpr_read_b32 v85,a89
v_accvgpr_read_b32 v86,a90
v_accvgpr_read_b32 v87,a91
v_mul_f32 v80,v80,v200
v_mul_f32 v81,v81,v200
v_mul_f32 v82,v82,v200
v_mul_f32 v83,v83,v200
M a[116:119],a[216:219],v[168:171],a[116:119]
v_mul_f32 v84,v84,v200
v_mul_f32 v85,v85,v200
v_mul_f32 v86,v86,v200
v_mul_f32 v87,v87,v200
v_cvt_pk_bf16_f32 v104,v80,v81
v_cvt_pk_bf16_f32 v105,v82,v83
v_cvt_pk_bf16_f32 v106,v84,v85
v_cvt_pk_bf16_f32 v107,v86,v87
s_nop 0
M a[116:119],a[220:223],v[172:175],a[116:119]
buffer_store_dwordx4 v[104:107],v243,s[32:35],s49 offen offset:2048 sc1
v_accvgpr_read_b32 v88,a76
v_accvgpr_read_b32 v89,a77
v_accvgpr_read_b32 v90,a78
v_accvgpr_read_b32 v91,a79
v_accvgpr_read_b32 v92,a92
v_accvgpr_read_b32 v93,a93
v_accvgpr_read_b32 v94,a94
M a[112:115],a[220:223],v[164:167],a[112:115]
v_accvgpr_read_b32 v95,a95
v_mul_f32 v88,v88,v204
v_mul_f32 v89,v89,v204
v_mul_f32 v90,v90,v204
v_mul_f32 v91,v91,v204
v_mul_f32 v92,v92,v204
v_mul_f32 v93,v93,v204
v_mul_f32 v94,v94,v204
M a[112:115],a[216:219],v[160:163],a[112:115]
v_mul_f32 v95,v95,v204
v_cvt_pk_bf16_f32 v108,v88,v89
v_cvt_pk_bf16_f32 v109,v90,v91
v_cvt_pk_bf16_f32 v110,v92,v93
v_cvt_pk_bf16_f32 v111,v94,v95
s_nop 0
buffer_store_dwordx4 v[108:111],v243,s[32:35],s49 offen offset:3072 sc1
s_add_u32 s49,s49,4096
s_nop 7
v_accvgpr_read_b32 v64,a96
v_accvgpr_read_b32 v65,a97
v_accvgpr_read_b32 v66,a98
v_accvgpr_read_b32 v67,a99
v_accvgpr_read_b32 v68,a112
v_accvgpr_read_b32 v69,a113
v_accvgpr_read_b32 v70,a114
v_accvgpr_read_b32 v71,a115
v_pk_mul_f32 v[64:65],v[192:193],v[64:65] op_sel:[0,0] op_sel_hi:[0,1]
v_pk_mul_f32 v[66:67],v[192:193],v[66:67] op_sel:[0,0] op_sel_hi:[0,1]
v_pk_mul_f32 v[68:69],v[192:193],v[68:69] op_sel:[0,0] op_sel_hi:[0,1]
v_pk_mul_f32 v[70:71],v[192:193],v[70:71] op_sel:[0,0] op_sel_hi:[0,1]
v_cvt_pk_bf16_f32 v112,v64,v65
v_cvt_pk_bf16_f32 v113,v66,v67
v_cvt_pk_bf16_f32 v114,v68,v69
v_cvt_pk_bf16_f32 v115,v70,v71
s_nop 0
buffer_store_dwordx4 v[112:115],v243,s[32:35],s49 offen offset:0 sc1
v_accvgpr_read_b32 v72,a100
v_accvgpr_read_b32 v73,a101
v_accvgpr_read_b32 v74,a102
v_accvgpr_read_b32 v75,a103
v_accvgpr_read_b32 v76,a116
v_accvgpr_read_b32 v77,a117
v_accvgpr_read_b32 v78,a118
v_accvgpr_read_b32 v79,a119
v_pk_mul_f32 v[72:73],v[196:197],v[72:73] op_sel:[0,0] op_sel_hi:[0,1]
v_pk_mul_f32 v[74:75],v[196:197],v[74:75] op_sel:[0,0] op_sel_hi:[0,1]
v_pk_mul_f32 v[76:77],v[196:197],v[76:77] op_sel:[0,0] op_sel_hi:[0,1]
v_pk_mul_f32 v[78:79],v[196:197],v[78:79] op_sel:[0,0] op_sel_hi:[0,1]
v_cvt_pk_bf16_f32 v116,v72,v73
v_cvt_pk_bf16_f32 v117,v74,v75
v_cvt_pk_bf16_f32 v118,v76,v77
v_cvt_pk_bf16_f32 v119,v78,v79
s_nop 0
buffer_store_dwordx4 v[116:119],v243,s[32:35],s49 offen offset:1024 sc1
v_accvgpr_read_b32 v80,a104
v_accvgpr_read_b32 v81,a105
v_accvgpr_read_b32 v82,a106
v_accvgpr_read_b32 v83,a107
v_accvgpr_read_b32 v84,a120
v_accvgpr_read_b32 v85,a121
v_accvgpr_read_b32 v86,a122
v_accvgpr_read_b32 v87,a123
v_pk_mul_f32 v[80:81],v[200:201],v[80:81] op_sel:[0,0] op_sel_hi:[0,1]
v_pk_mul_f32 v[82:83],v[200:201],v[82:83] op_sel:[0,0] op_sel_hi:[0,1]
v_pk_mul_f32 v[84:85],v[200:201],v[84:85] op_sel:[0,0] op_sel_hi:[0,1]
v_pk_mul_f32 v[86:87],v[200:201],v[86:87] op_sel:[0,0] op_sel_hi:[0,1]
v_cvt_pk_bf16_f32 v120,v80,v81
v_cvt_pk_bf16_f32 v121,v82,v83
v_cvt_pk_bf16_f32 v122,v84,v85
v_cvt_pk_bf16_f32 v123,v86,v87
s_nop 0
buffer_store_dwordx4 v[120:123],v243,s[32:35],s49 offen offset:2048 sc1
v_accvgpr_read_b32 v88,a108
v_accvgpr_read_b32 v89,a109
v_accvgpr_read_b32 v90,a110
v_accvgpr_read_b32 v91,a111
v_accvgpr_read_b32 v92,a124
v_accvgpr_read_b32 v93,a125
v_accvgpr_read_b32 v94,a126
v_accvgpr_read_b32 v95,a127
v_pk_mul_f32 v[88:89],v[204:205],v[88:89] op_sel:[0,0] op_sel_hi:[0,1]
v_pk_mul_f32 v[90:91],v[204:205],v[90:91] op_sel:[0,0] op_sel_hi:[0,1]
v_pk_mul_f32 v[92:93],v[204:205],v[92:93] op_sel:[0,0] op_sel_hi:[0,1]
v_pk_mul_f32 v[94:95],v[204:205],v[94:95] op_sel:[0,0] op_sel_hi:[0,1]
v_cvt_pk_bf16_f32 v124,v88,v89
v_cvt_pk_bf16_f32 v125,v90,v91
v_cvt_pk_bf16_f32 v126,v92,v93
v_cvt_pk_bf16_f32 v127,v94,v95
s_nop 0
buffer_store_dwordx4 v[124:127],v243,s[32:35],s49 offen offset:3072 sc1
s_add_u32 s49,s49,4096
s_barrier
ds_read2st64_b32 v[216:217],v222 offset0:0 offset1:1
ds_read2st64_b32 v[218:219],v222 offset0:2 offset1:3
s_waitcnt lgkmcnt(0)
v_or3_b32 v216,v216,v217,v218
v_or_b32 v216,v216,v219
v_cmp_ne_u32 vcc,0,v216
s_cbranch_vccnz L_rerun
L_decided:
v_mul_u32_u24 v208,2560,v242
v_cmp_gt_u32 vcc,24,v242
v_mov_b32 v212,41943040
v_add_u32 v209,163840,v208
v_add_u32 v210,327680,v208
v_add_u32 v211,491520,v208
v_cndmask_b32 v211,v212,v211,vcc
buffer_load_dwordx4 v[192:195],v208,s[32:35],s63 offen sc1
buffer_load_dwordx4 v[196:199],v209,s[32:35],s63 offen sc1
buffer_load_dwordx4 v[200:203],v210,s[32:35],s63 offen sc1
buffer_load_dwordx4 v[204:207],v211,s[32:35],s63 offen sc1
s_add_u32 s51,s46,24576
buffer_load_dwordx4 v[128:131],v243,s[32:35],s51 offen offset:0 sc1
buffer_load_dwordx4 v[132:135],v243,s[32:35],s51 offen offset:1024 sc1
buffer_load_dwordx4 v[136:139],v243,s[32:35],s51 offen offset:2048 sc1
buffer_load_dwordx4 v[140:143],v243,s[32:35],s51 offen offset:3072 sc1
s_add_u32 s51,s46,28672
buffer_load_dwordx4 v[144:147],v243,s[32:35],s51 offen offset:0 sc1
buffer_load_dwordx4 v[148:151],v243,s[32:35],s51 offen offset:1024 sc1
v_mov_b32 v230,1
s_lshl_b32 s55,s55,1
s_bfe_u32 s50,s2,0x10002
s_add_u32 s55,s55,s50
s_xor_b32 s50,s55,1
s_lshl_b32 s50,s50,7
s_add_u32 s50,s50,s52
s_lshl_b32 s43,s50,12
s_lshl_b32 s50,s55,7
s_add_u32 s50,s50,s52
s_lshl_b32 s52,s50,12
s_lshr_b32 s50,s69,1
s_add_u32 s52,s52,s50
s_add_u32 s43,s43,s50
s_lshl_b32 s44,s2,2
s_add_u32 s44,s44,s40
s_mul_i32 s44,s44,5120
s_add_u32 s44,s44,28311552
s_xor_b32 s50,s2,4
s_lshl_b32 s93,s50,2
s_add_u32 s93,s93,s40
s_mul_i32 s93,s93,5120
s_add_u32 s93,s93,28311552
s_mov_b32 s20,s56
s_mov_b32 s21,s57
s_mov_b32 s22,2621440
s_mov_b32 s23,0x00020000
v_add_u32 v246,s48,v243
s_add_u32 s50,s40,0
s_and_b32 s50,s50,3
s_lshl_b32 s50,s50,10
v_add_u32 v247,s50,v243
s_add_u32 s50,s40,1
s_and_b32 s50,s50,3
s_lshl_b32 s50,s50,10
v_add_u32 v248,s50,v243
s_add_u32 s50,s40,2
s_and_b32 s50,s50,3
s_lshl_b32 s50,s50,10
v_add_u32 v249,s50,v243
s_add_u32 s50,s40,3
s_and_b32 s50,s50,3
s_lshl_b32 s50,s50,10
v_add_u32 v250,s50,v243
s_add_u32 s50,s40,3
s_and_b32 s50,s50,3
s_lshl_b32 s50,s50,12
v_add_u32 v251,s50,v243
s_add_u32 s50,s40,2
s_and_b32 s50,s50,3
s_lshl_b32 s50,s50,12
v_add_u32 v252,s50,v243
s_add_u32 s50,s40,1
s_and_b32 s50,s50,3
s_lshl_b32 s50,s50,12
v_add_u32 v253,s50,v243
s_lshl_b32 s50,s55,2
s_add_u32 s50,s50,s40
s_lshl_b32 s50,s50,4
v_and_b32 v245,15,v242
v_add_u32 v245,s50,v245
v_lshrrev_b32 v254,4,v242
v_mul_u32_u24 v254,40,v254
v_mul_u32_u24 v244,1280,v245
s_mul_i32 s54,s54,160
v_add3_u32 v244,v244,v254,s54
s_waitcnt vmcnt(10)
buffer_store_dword v230,off,s[32:35],s82 sc1
s_waitcnt vmcnt(7)
s_cmp_ge_u32 s45,41943040
s_cbranch_scc1 L_no_finish
v_max3_u32 v213,v192,v196,v200
v_max_u32 v213,v213,v204
v_cmp_eq_u32 vcc,-1,v213
s_cbranch_vccnz L_slow_yp
L_ok_yp:
v_mov_b32 v212,s101
v_ashrrev_i32 v213,31,v212
v_not_b32 v213,v213
v_or_b32 v213,0x80000000,v213
v_xor_b32 v212,v212,v213
v_and_b32 v212,0xffff0000,v212
v_mul_f32 v212,0xbfb8aa3b,v212
v_exp_f32 v212,v212
v_add_f32 v192,v192,v196
v_add_f32 v200,v200,v204
v_add_f32 v193,v193,v197
v_add_f32 v201,v201,v205
v_add_f32 v194,v194,v198
v_add_f32 v202,v202,v206
v_add_f32 v195,v195,v199
v_add_f32 v203,v203,v207
v_add_f32 v212,1.0,v212
v_rcp_f32 v212,v212
v_add_f32 v192,v192,v200
v_add_f32 v193,v193,v201
v_add_f32 v194,v194,v202
v_add_f32 v195,v195,v203
v_add_f32_dpp v192,v192,v192 row_ror:8 row_mask:0xf bank_mask:0xf
v_add_f32_dpp v193,v193,v193 row_ror:8 row_mask:0xf bank_mask:0xf
v_add_f32_dpp v194,v194,v194 row_ror:8 row_mask:0xf bank_mask:0xf
v_add_f32_dpp v195,v195,v195 row_ror:8 row_mask:0xf bank_mask:0xf
v_add_f32_dpp v192,v192,v192 row_ror:4 row_mask:0xf bank_mask:0xf
v_add_f32_dpp v193,v193,v193 row_ror:4 row_mask:0xf bank_mask:0xf
v_add_f32_dpp v194,v194,v194 row_ror:4 row_mask:0xf bank_mask:0xf
v_add_f32_dpp v195,v195,v195 row_ror:4 row_mask:0xf bank_mask:0xf
v_add_f32_dpp v192,v192,v192 row_ror:2 row_mask:0xf bank_mask:0xf
v_add_f32_dpp v193,v193,v193 row_ror:2 row_mask:0xf bank_mask:0xf
v_add_f32_dpp v194,v194,v194 row_ror:2 row_mask:0xf bank_mask:0xf
v_add_f32_dpp v195,v195,v195 row_ror:2 row_mask:0xf bank_mask:0xf
v_add_f32_dpp v192,v192,v192 row_ror:1 row_mask:0xf bank_mask:0xf
v_add_f32_dpp v193,v193,v193 row_ror:1 row_mask:0xf bank_mask:0xf
v_add_f32_dpp v194,v194,v194 row_ror:1 row_mask:0xf bank_mask:0xf
v_add_f32_dpp v195,v195,v195 row_ror:1 row_mask:0xf bank_mask:0xf
v_mov_b32 v200,v192
v_mov_b32 v201,v193
v_mov_b32 v202,v194
v_mov_b32 v203,v195
s_nop 0
v_permlane32_swap_b32 v192,v200
v_permlane32_swap_b32 v193,v201
v_permlane32_swap_b32 v194,v202
v_permlane32_swap_b32 v195,v203
v_add_f32 v192,v192,v200
v_add_f32 v193,v193,v201
v_add_f32 v194,v194,v202
v_add_f32 v195,v195,v203
v_mov_b32 v200,v192
v_mov_b32 v201,v193
v_mov_b32 v202,v194
v_mov_b32 v203,v195
s_nop 0
v_permlane16_swap_b32 v192,v200
v_permlane16_swap_b32 v193,v201
v_permlane16_swap_b32 v194,v202
v_permlane16_swap_b32 v195,v203
v_add_f32 v192,v192,v200
v_add_f32 v193,v193,v201
v_add_f32 v194,v194,v202
v_add_f32 v195,v195,v203
v_cvt_pk_bf16_f32 v212,v212,v212
v_lshlrev_b32 v212,16,v212
v_cvt_pk_bf16_f32 v192,v192,v192
v_lshlrev_b32 v192,16,v192
v_mul_f32 v214,v192,v212
v_cvt_pk_bf16_f32 v214,v214,v214
v_lshlrev_b32 v214,16,v214
v_cvt_pk_bf16_f32 v193,v193,v193
v_lshlrev_b32 v193,16,v193
v_mul_f32 v215,v193,v212
v_cvt_pk_bf16_f32 v215,v215,v215
v_lshlrev_b32 v215,16,v215
v_cvt_pk_bf16_f32 v194,v194,v194
v_lshlrev_b32 v194,16,v194
v_mul_f32 v216,v194,v212
v_cvt_pk_bf16_f32 v216,v216,v216
v_lshlrev_b32 v216,16,v216
v_cvt_pk_bf16_f32 v195,v195,v195
v_lshlrev_b32 v195,16,v195
v_mul_f32 v217,v195,v212
v_cvt_pk_bf16_f32 v217,v217,v217
v_lshlrev_b32 v217,16,v217
s_nop 0
buffer_store_dwordx4 v[214:217],off,s[32:35],s45 sc1
s_mov_b32 s45,41943040
L_no_finish:
buffer_load_dwordx4 v[152:155],v243,s[32:35],s51 offen offset:2048 sc1
buffer_load_dwordx4 v[156:159],v243,s[32:35],s51 offen offset:3072 sc1
s_add_u32 s51,s46,32768
buffer_load_dwordx4 a[192:195],v243,s[32:35],s51 offen offset:0 sc1
buffer_load_dwordx4 a[196:199],v243,s[32:35],s51 offen offset:1024 sc1
buffer_load_dwordx4 a[200:203],v243,s[32:35],s51 offen offset:2048 sc1
buffer_load_dwordx4 a[204:207],v243,s[32:35],s51 offen offset:3072 sc1
s_add_u32 s51,s46,36864
buffer_load_dwordx4 a[208:211],v243,s[32:35],s51 offen offset:0 sc1
buffer_load_dwordx4 a[212:215],v243,s[32:35],s51 offen offset:1024 sc1
v_lshlrev_b32 v226,2,v245
v_add_u32 v226,25165824,v226
v_cmp_eq_u32 vcc,s100,v245
s_lshl_b32 s50,s54,1
s_add_u32 s50,s50,25296896
v_lshl_add_u32 v254,v254,1,s50
v_mov_b32 v227,41943040
v_cndmask_b32 v254,v227,v254,vcc
v_and_b32 v231,3,v242
v_bfe_u32 v227,v242,2,1
v_lshlrev_b32 v231,7,v231
v_lshl_add_u32 v231,v227,12,v231
v_add_u32 v228,0x10000,v246
v_add_u32 v229,0x20000,v246
buffer_load_dwordx4 v[192:195],v244,s[8:11],0 offen
buffer_load_dwordx4 v[196:199],v244,s[8:11],0 offen offset:16
buffer_load_dwordx2 v[200:201],v244,s[8:11],0 offen offset:32
buffer_load_dword v245,v226,s[32:35],0 offen sc1
s_mov_b32 s65,400000
L_wait_o:
buffer_load_dword v227,v231,s[32:35],s53 offen sc1
s_sub_u32 s65,s65,1
s_cbranch_scc1 L_have_o
s_waitcnt vmcnt(0)
v_cmp_ne_u32 vcc,1,v227
s_cbranch_vccnz L_wait_o
L_have_o:
s_waitcnt vmcnt(0)
buffer_load_dwordx4 v[64:67],v247,s[32:35],s52 offen sc1
buffer_load_dwordx4 v[68:71],v248,s[32:35],s52 offen sc1
buffer_load_dwordx4 v[72:75],v249,s[32:35],s52 offen sc1
buffer_load_dwordx4 v[76:79],v250,s[32:35],s52 offen sc1
buffer_load_dwordx4 v[80:83],v247,s[32:35],s43 offen sc1
buffer_load_dwordx4 v[84:87],v248,s[32:35],s43 offen sc1
buffer_load_dwordx4 v[88:91],v249,s[32:35],s43 offen sc1
buffer_load_dwordx4 v[92:95],v250,s[32:35],s43 offen sc1
s_add_u32 s52,s52,4096
buffer_load_dwordx4 v[96:99],v247,s[32:35],s52 offen sc1
buffer_load_dwordx4 v[100:103],v248,s[32:35],s52 offen sc1
buffer_load_dwordx4 v[104:107],v249,s[32:35],s52 offen sc1
buffer_load_dwordx4 v[108:111],v250,s[32:35],s52 offen sc1
s_add_u32 s43,s43,4096
buffer_load_dwordx4 v[112:115],v247,s[32:35],s43 offen sc1
buffer_load_dwordx4 v[116:119],v248,s[32:35],s43 offen sc1
buffer_load_dwordx4 v[120:123],v249,s[32:35],s43 offen sc1
buffer_load_dwordx4 v[124:127],v250,s[32:35],s43 offen sc1
s_add_u32 s52,s52,4096
buffer_load_dwordx4 v[160:163],v247,s[32:35],s52 offen sc1
buffer_load_dwordx4 v[164:167],v248,s[32:35],s52 offen sc1
buffer_load_dwordx4 v[168:171],v249,s[32:35],s52 offen sc1
buffer_load_dwordx4 v[172:175],v250,s[32:35],s52 offen sc1
s_add_u32 s43,s43,4096
buffer_load_dwordx4 v[176:179],v247,s[32:35],s43 offen sc1
buffer_load_dwordx4 v[180:183],v248,s[32:35],s43 offen sc1
buffer_load_dwordx4 v[184:187],v249,s[32:35],s43 offen sc1
buffer_load_dwordx4 v[188:191],v250,s[32:35],s43 offen sc1
s_waitcnt vmcnt(23)
M a[0:3],v[0:3],v[64:67],0
M a[32:35],v[4:7],v[64:67],0
buffer_load_dwordx4 a[216:219],v243,s[32:35],s51 offen offset:2048 sc1
M a[64:67],v[8:11],v[64:67],0
M a[96:99],v[12:15],v[64:67],0
s_add_u32 s52,s52,4096
M a[128:131],v[16:19],v[64:67],0
buffer_load_dwordx4 v[64:67],v247,s[32:35],s52 offen sc1
s_waitcnt vmcnt(24)
M a[4:7],v[0:3],v[68:71],0
M a[36:39],v[4:7],v[68:71],0
M a[68:71],v[8:11],v[68:71],0
M a[100:103],v[12:15],v[68:71],0
M a[132:135],v[16:19],v[68:71],0
buffer_load_dwordx4 v[68:71],v248,s[32:35],s52 offen sc1
s_waitcnt vmcnt(24)
M a[8:11],v[0:3],v[72:75],0
M a[40:43],v[4:7],v[72:75],0
buffer_load_dwordx4 a[220:223],v243,s[32:35],s51 offen offset:3072 sc1
M a[72:75],v[8:11],v[72:75],0
M a[104:107],v[12:15],v[72:75],0
M a[136:139],v[16:19],v[72:75],0
buffer_load_dwordx4 v[72:75],v249,s[32:35],s52 offen sc1
s_waitcnt vmcnt(25)
M a[12:15],v[0:3],v[76:79],0
M a[44:47],v[4:7],v[76:79],0
M a[76:79],v[8:11],v[76:79],0
M a[108:111],v[12:15],v[76:79],0
M a[140:143],v[16:19],v[76:79],0
buffer_load_dwordx4 v[76:79],v250,s[32:35],s52 offen sc1
s_waitcnt vmcnt(25)
M a[16:19],v[0:3],v[80:83],0
M a[48:51],v[4:7],v[80:83],0
s_add_u32 s51,s68,40960
buffer_load_dwordx4 a[224:227],v243,s[32:35],s51 offen offset:0 sc1
M a[80:83],v[8:11],v[80:83],0
M a[112:115],v[12:15],v[80:83],0
s_add_u32 s43,s43,4096
M a[144:147],v[16:19],v[80:83],0
buffer_load_dwordx4 v[80:83],v247,s[32:35],s43 offen sc1
s_waitcnt vmcnt(26)
M a[20:23],v[0:3],v[84:87],0
M a[52:55],v[4:7],v[84:87],0
M a[84:87],v[8:11],v[84:87],0
M a[116:119],v[12:15],v[84:87],0
M a[148:151],v[16:19],v[84:87],0
buffer_load_dwordx4 v[84:87],v248,s[32:35],s43 offen sc1
s_waitcnt vmcnt(26)
M a[24:27],v[0:3],v[88:91],0
M a[56:59],v[4:7],v[88:91],0
buffer_load_dwordx4 a[228:231],v243,s[32:35],s51 offen offset:1024 sc1
M a[88:91],v[8:11],v[88:91],0
M a[120:123],v[12:15],v[88:91],0
M a[152:155],v[16:19],v[88:91],0
buffer_load_dwordx4 v[88:91],v249,s[32:35],s43 offen sc1
s_waitcnt vmcnt(27)
M a[28:31],v[0:3],v[92:95],0
ds_read_b128 v[0:3],v229 offset:0
M a[60:63],v[4:7],v[92:95],0
ds_read_b128 v[4:7],v229 offset:1024
M a[92:95],v[8:11],v[92:95],0
ds_read_b128 v[8:11],v229 offset:2048
M a[124:127],v[12:15],v[92:95],0
ds_read_b128 v[12:15],v229 offset:3072
M a[156:159],v[16:19],v[92:95],0
buffer_load_dwordx4 v[92:95],v250,s[32:35],s43 offen sc1
ds_read_b128 v[16:19],v246 offset:16384
s_waitcnt vmcnt(27)
M a[0:3],v[20:23],v[96:99],a[0:3]
M a[32:35],v[24:27],v[96:99],a[32:35]
buffer_load_dwordx4 a[232:235],v243,s[32:35],s51 offen offset:2048 sc1
M a[64:67],v[28:31],v[96:99],a[64:67]
M a[96:99],v[32:35],v[96:99],a[96:99]
s_add_u32 s52,s52,4096
M a[128:131],v[36:39],v[96:99],a[128:131]
buffer_load_dwordx4 v[96:99],v247,s[32:35],s52 offen sc1
s_waitcnt vmcnt(28)
M a[4:7],v[20:23],v[100:103],a[4:7]
M a[36:39],v[24:27],v[100:103],a[36:39]
M a[68:71],v[28:31],v[100:103],a[68:71]
M a[100:103],v[32:35],v[100:103],a[100:103]
M a[132:135],v[36:39],v[100:103],a[132:135]
buffer_load_dwordx4 v[100:103],v248,s[32:35],s52 offen sc1
s_waitcnt vmcnt(28)
M a[8:11],v[20:23],v[104:107],a[8:11]
M a[40:43],v[24:27],v[104:107],a[40:43]
buffer_load_dwordx4 a[236:239],v243,s[32:35],s51 offen offset:3072 sc1
M a[72:75],v[28:31],v[104:107],a[72:75]
M a[104:107],v[32:35],v[104:107],a[104:107]
M a[136:139],v[36:39],v[104:107],a[136:139]
buffer_load_dwordx4 v[104:107],v249,s[32:35],s52 offen sc1
s_waitcnt vmcnt(29)
M a[12:15],v[20:23],v[108:111],a[12:15]
M a[44:47],v[24:27],v[108:111],a[44:47]
M a[76:79],v[28:31],v[108:111],a[76:79]
M a[108:111],v[32:35],v[108:111],a[108:111]
M a[140:143],v[36:39],v[108:111],a[140:143]
buffer_load_dwordx4 v[108:111],v250,s[32:35],s52 offen sc1
s_waitcnt vmcnt(29)
M a[16:19],v[20:23],v[112:115],a[16:19]
M a[48:51],v[24:27],v[112:115],a[48:51]
s_add_u32 m0,s48,65536
s_add_u32 s47,s68,77824
buffer_load_dwordx4 v243,s[32:35],s47 offen offset:0 sc1 lds
buffer_load_dwordx4 v243,s[32:35],s47 offen offset:1024 sc1 lds
buffer_load_dwordx4 v243,s[32:35],s47 offen offset:2048 sc1 lds
buffer_load_dwordx4 v243,s[32:35],s47 offen offset:3072 sc1 lds
M a[80:83],v[28:31],v[112:115],a[80:83]
M a[112:115],v[32:35],v[112:115],a[112:115]
s_add_u32 s43,s43,4096
M a[144:147],v[36:39],v[112:115],a[144:147]
buffer_load_dwordx4 v[112:115],v247,s[32:35],s43 offen sc1
s_waitcnt vmcnt(33)
M a[20:23],v[20:23],v[116:119],a[20:23]
M a[52:55],v[24:27],v[116:119],a[52:55]
M a[84:87],v[28:31],v[116:119],a[84:87]
M a[116:119],v[32:35],v[116:119],a[116:119]
M a[148:151],v[36:39],v[116:119],a[148:151]
buffer_load_dwordx4 v[116:119],v248,s[32:35],s43 offen sc1
s_waitcnt vmcnt(33)
M a[24:27],v[20:23],v[120:123],a[24:27]
M a[56:59],v[24:27],v[120:123],a[56:59]
M a[88:91],v[28:31],v[120:123],a[88:91]
M a[120:123],v[32:35],v[120:123],a[120:123]
M a[152:155],v[36:39],v[120:123],a[152:155]
buffer_load_dwordx4 v[120:123],v249,s[32:35],s43 offen sc1
s_waitcnt vmcnt(33)
M a[28:31],v[20:23],v[124:127],a[28:31]
ds_read_b128 v[20:23],v246 offset:17408
M a[60:63],v[24:27],v[124:127],a[60:63]
ds_read_b128 v[24:27],v246 offset:18432
M a[92:95],v[28:31],v[124:127],a[92:95]
ds_read_b128 v[28:31],v246 offset:19456
M a[124:127],v[32:35],v[124:127],a[124:127]
ds_read_b128 v[32:35],v228 offset:16384
M a[156:159],v[36:39],v[124:127],a[156:159]
buffer_load_dwordx4 v[124:127],v250,s[32:35],s43 offen sc1
ds_read_b128 v[36:39],v228 offset:17408
s_waitcnt vmcnt(33)
M a[0:3],v[40:43],v[160:163],a[0:3]
M a[32:35],v[44:47],v[160:163],a[32:35]
M a[64:67],v[48:51],v[160:163],a[64:67]
M a[96:99],v[52:55],v[160:163],a[96:99]
s_add_u32 s52,s52,4096
M a[128:131],v[56:59],v[160:163],a[128:131]
buffer_load_dwordx4 v[160:163],v247,s[32:35],s52 offen sc1
s_waitcnt vmcnt(33)
M a[4:7],v[40:43],v[164:167],a[4:7]
M a[36:39],v[44:47],v[164:167],a[36:39]
M a[68:71],v[48:51],v[164:167],a[68:71]
M a[100:103],v[52:55],v[164:167],a[100:103]
M a[132:135],v[56:59],v[164:167],a[132:135]
buffer_load_dwordx4 v[164:167],v248,s[32:35],s52 offen sc1
s_waitcnt vmcnt(33)
M a[8:11],v[40:43],v[168:171],a[8:11]
M a[40:43],v[44:47],v[168:171],a[40:43]
M a[72:75],v[48:51],v[168:171],a[72:75]
M a[104:107],v[52:55],v[168:171],a[104:107]
M a[136:139],v[56:59],v[168:171],a[136:139]
buffer_load_dwordx4 v[168:171],v249,s[32:35],s52 offen sc1
s_waitcnt vmcnt(33)
M a[12:15],v[40:43],v[172:175],a[12:15]
M a[44:47],v[44:47],v[172:175],a[44:47]
M a[76:79],v[48:51],v[172:175],a[76:79]
M a[108:111],v[52:55],v[172:175],a[108:111]
M a[140:143],v[56:59],v[172:175],a[140:143]
buffer_load_dwordx4 v[172:175],v250,s[32:35],s52 offen sc1
s_waitcnt vmcnt(33)
M a[16:19],v[40:43],v[176:179],a[16:19]
M a[48:51],v[44:47],v[176:179],a[48:51]
M a[80:83],v[48:51],v[176:179],a[80:83]
M a[112:115],v[52:55],v[176:179],a[112:115]
s_add_u32 s43,s43,4096
M a[144:147],v[56:59],v[176:179],a[144:147]
buffer_load_dwordx4 v[176:179],v247,s[32:35],s43 offen sc1
s_waitcnt vmcnt(33)
M a[20:23],v[40:43],v[180:183],a[20:23]
M a[52:55],v[44:47],v[180:183],a[52:55]
M a[84:87],v[48:51],v[180:183],a[84:87]
M a[116:119],v[52:55],v[180:183],a[116:119]
M a[148:151],v[56:59],v[180:183],a[148:151]
buffer_load_dwordx4 v[180:183],v248,s[32:35],s43 offen sc1
s_waitcnt vmcnt(33)
M a[24:27],v[40:43],v[184:187],a[24:27]
M a[56:59],v[44:47],v[184:187],a[56:59]
M a[88:91],v[48:51],v[184:187],a[88:91]
M a[120:123],v[52:55],v[184:187],a[120:123]
M a[152:155],v[56:59],v[184:187],a[152:155]
buffer_load_dwordx4 v[184:187],v249,s[32:35],s43 offen sc1
s_waitcnt vmcnt(33)
M a[28:31],v[40:43],v[188:191],a[28:31]
ds_read_b128 v[40:43],v228 offset:18432
M a[60:63],v[44:47],v[188:191],a[60:63]
ds_read_b128 v[44:47],v228 offset:19456
M a[92:95],v[48:51],v[188:191],a[92:95]
ds_read_b128 v[48:51],v246 offset:49152
M a[124:127],v[52:55],v[188:191],a[124:127]
ds_read_b128 v[52:55],v246 offset:50176
M a[156:159],v[56:59],v[188:191],a[156:159]
buffer_load_dwordx4 v[188:191],v250,s[32:35],s43 offen sc1
ds_read_b128 v[56:59],v246 offset:51200
s_waitcnt vmcnt(32)
M a[0:3],v[60:63],v[64:67],a[0:3]
M a[32:35],a[160:163],v[64:67],a[32:35]
M a[64:67],a[164:167],v[64:67],a[64:67]
M a[96:99],a[168:171],v[64:67],a[96:99]
s_add_u32 s52,s52,4096
M a[128:131],a[172:175],v[64:67],a[128:131]
buffer_load_dwordx4 v[64:67],v247,s[32:35],s52 offen sc1
s_waitcnt vmcnt(32)
M a[4:7],v[60:63],v[68:71],a[4:7]
M a[36:39],a[160:163],v[68:71],a[36:39]
M a[68:71],a[164:167],v[68:71],a[68:71]
M a[100:103],a[168:171],v[68:71],a[100:103]
M a[132:135],a[172:175],v[68:71],a[132:135]
buffer_load_dwordx4 v[68:71],v248,s[32:35],s52 offen sc1
s_waitcnt vmcnt(31)
M a[8:11],v[60:63],v[72:75],a[8:11]
M a[40:43],a[160:163],v[72:75],a[40:43]
M a[72:75],a[164:167],v[72:75],a[72:75]
M a[104:107],a[168:171],v[72:75],a[104:107]
M a[136:139],a[172:175],v[72:75],a[136:139]
buffer_load_dwordx4 v[72:75],v249,s[32:35],s52 offen sc1
s_waitcnt vmcnt(31)
M a[12:15],v[60:63],v[76:79],a[12:15]
M a[44:47],a[160:163],v[76:79],a[44:47]
M a[76:79],a[164:167],v[76:79],a[76:79]
M a[108:111],a[168:171],v[76:79],a[108:111]
M a[140:143],a[172:175],v[76:79],a[140:143]
buffer_load_dwordx4 v[76:79],v250,s[32:35],s52 offen sc1
s_waitcnt vmcnt(30)
M a[16:19],v[60:63],v[80:83],a[16:19]
M a[48:51],a[160:163],v[80:83],a[48:51]
M a[80:83],a[164:167],v[80:83],a[80:83]
M a[112:115],a[168:171],v[80:83],a[112:115]
s_add_u32 s43,s43,4096
M a[144:147],a[172:175],v[80:83],a[144:147]
buffer_load_dwordx4 v[80:83],v247,s[32:35],s43 offen sc1
s_waitcnt vmcnt(30)
M a[20:23],v[60:63],v[84:87],a[20:23]
M a[52:55],a[160:163],v[84:87],a[52:55]
M a[84:87],a[164:167],v[84:87],a[84:87]
M a[116:119],a[168:171],v[84:87],a[116:119]
M a[148:151],a[172:175],v[84:87],a[148:151]
buffer_load_dwordx4 v[84:87],v248,s[32:35],s43 offen sc1
s_waitcnt vmcnt(29)
M a[24:27],v[60:63],v[88:91],a[24:27]
M a[56:59],a[160:163],v[88:91],a[56:59]
M a[88:91],a[164:167],v[88:91],a[88:91]
M a[120:123],a[168:171],v[88:91],a[120:123]
M a[152:155],a[172:175],v[88:91],a[152:155]
buffer_load_dwordx4 v[88:91],v249,s[32:35],s43 offen sc1
s_waitcnt vmcnt(29)
M a[28:31],v[60:63],v[92:95],a[28:31]
ds_read_b128 v[60:63],v246 offset:52224
M a[60:63],a[160:163],v[92:95],a[60:63]
ds_read_b128 a[160:163],v246 offset:32768
M a[92:95],a[164:167],v[92:95],a[92:95]
ds_read_b128 a[164:167],v246 offset:33792
M a[124:127],a[168:171],v[92:95],a[124:127]
ds_read_b128 a[168:171],v246 offset:34816
M a[156:159],a[172:175],v[92:95],a[156:159]
buffer_load_dwordx4 v[92:95],v250,s[32:35],s43 offen sc1
ds_read_b128 a[172:175],v246 offset:35840
s_waitcnt vmcnt(28)
M a[0:3],a[176:179],v[96:99],a[0:3]
M a[32:35],a[180:183],v[96:99],a[32:35]
M a[64:67],a[184:187],v[96:99],a[64:67]
M a[96:99],a[188:191],v[96:99],a[96:99]
s_add_u32 s52,s52,4096
M a[128:131],v[128:131],v[96:99],a[128:131]
buffer_load_dwordx4 v[96:99],v247,s[32:35],s52 offen sc1
s_waitcnt vmcnt(28)
M a[4:7],a[176:179],v[100:103],a[4:7]
M a[36:39],a[180:183],v[100:103],a[36:39]
M a[68:71],a[184:187],v[100:103],a[68:71]
M a[100:103],a[188:191],v[100:103],a[100:103]
M a[132:135],v[128:131],v[100:103],a[132:135]
buffer_load_dwordx4 v[100:103],v248,s[32:35],s52 offen sc1
s_waitcnt vmcnt(27)
M a[8:11],a[176:179],v[104:107],a[8:11]
M a[40:43],a[180:183],v[104:107],a[40:43]
M a[72:75],a[184:187],v[104:107],a[72:75]
M a[104:107],a[188:191],v[104:107],a[104:107]
M a[136:139],v[128:131],v[104:107],a[136:139]
buffer_load_dwordx4 v[104:107],v249,s[32:35],s52 offen sc1
s_waitcnt vmcnt(27)
M a[12:15],a[176:179],v[108:111],a[12:15]
M a[44:47],a[180:183],v[108:111],a[44:47]
M a[76:79],a[184:187],v[108:111],a[76:79]
M a[108:111],a[188:191],v[108:111],a[108:111]
M a[140:143],v[128:131],v[108:111],a[140:143]
buffer_load_dwordx4 v[108:111],v250,s[32:35],s52 offen sc1
s_waitcnt vmcnt(23)
M a[16:19],a[176:179],v[112:115],a[16:19]
M a[48:51],a[180:183],v[112:115],a[48:51]
M a[80:83],a[184:187],v[112:115],a[80:83]
M a[112:115],a[188:191],v[112:115],a[112:115]
s_add_u32 s43,s43,4096
M a[144:147],v[128:131],v[112:115],a[144:147]
buffer_load_dwordx4 v[112:115],v247,s[32:35],s43 offen sc1
s_waitcnt vmcnt(23)
M a[20:23],a[176:179],v[116:119],a[20:23]
M a[52:55],a[180:183],v[116:119],a[52:55]
M a[84:87],a[184:187],v[116:119],a[84:87]
M a[116:119],a[188:191],v[116:119],a[116:119]
M a[148:151],v[128:131],v[116:119],a[148:151]
buffer_load_dwordx4 v[116:119],v248,s[32:35],s43 offen sc1
s_waitcnt vmcnt(23)
M a[24:27],a[176:179],v[120:123],a[24:27]
M a[56:59],a[180:183],v[120:123],a[56:59]
M a[88:91],a[184:187],v[120:123],a[88:91]
M a[120:123],a[188:191],v[120:123],a[120:123]
M a[152:155],v[128:131],v[120:123],a[152:155]
buffer_load_dwordx4 v[120:123],v249,s[32:35],s43 offen sc1
s_waitcnt vmcnt(23)
M a[28:31],a[176:179],v[124:127],a[28:31]
ds_read_b128 a[176:179],v246 offset:0
M a[60:63],a[180:183],v[124:127],a[60:63]
ds_read_b128 a[180:183],v246 offset:1024
M a[92:95],a[184:187],v[124:127],a[92:95]
ds_read_b128 a[184:187],v246 offset:2048
M a[124:127],a[188:191],v[124:127],a[124:127]
ds_read_b128 a[188:191],v246 offset:3072
M a[156:159],v[128:131],v[124:127],a[156:159]
buffer_load_dwordx4 v[124:127],v250,s[32:35],s43 offen sc1
ds_read_b128 v[128:131],v228 offset:49152
s_waitcnt vmcnt(23)
M a[0:3],v[132:135],v[160:163],a[0:3]
M a[32:35],v[136:139],v[160:163],a[32:35]
M a[64:67],v[140:143],v[160:163],a[64:67]
M a[96:99],v[144:147],v[160:163],a[96:99]
s_add_u32 s43,s43,4096
s_sub_u32 s43,s43,s69
M a[128:131],v[148:151],v[160:163],a[128:131]
buffer_load_dwordx4 v[160:163],v248,s[32:35],s43 offen sc1
s_waitcnt vmcnt(23)
M a[4:7],v[132:135],v[164:167],a[4:7]
M a[36:39],v[136:139],v[164:167],a[36:39]
M a[68:71],v[140:143],v[164:167],a[68:71]
M a[100:103],v[144:147],v[164:167],a[100:103]
s_add_u32 s43,s43,4096
M a[132:135],v[148:151],v[164:167],a[132:135]
buffer_load_dwordx4 v[164:167],v248,s[32:35],s43 offen sc1
s_waitcnt vmcnt(23)
M a[8:11],v[132:135],v[168:171],a[8:11]
M a[40:43],v[136:139],v[168:171],a[40:43]
M a[72:75],v[140:143],v[168:171],a[72:75]
M a[104:107],v[144:147],v[168:171],a[104:107]
s_add_u32 s43,s43,4096
M a[136:139],v[148:151],v[168:171],a[136:139]
buffer_load_dwordx4 v[168:171],v248,s[32:35],s43 offen sc1
s_waitcnt vmcnt(23)
M a[12:15],v[132:135],v[172:175],a[12:15]
M a[44:47],v[136:139],v[172:175],a[44:47]
M a[76:79],v[140:143],v[172:175],a[76:79]
M a[108:111],v[144:147],v[172:175],a[108:111]
s_add_u32 s43,s43,4096
M a[140:143],v[148:151],v[172:175],a[140:143]
buffer_load_dwordx4 v[172:175],v248,s[32:35],s43 offen sc1
s_waitcnt vmcnt(23)
M a[16:19],v[132:135],v[176:179],a[16:19]
M a[48:51],v[136:139],v[176:179],a[48:51]
M a[80:83],v[140:143],v[176:179],a[80:83]
M a[112:115],v[144:147],v[176:179],a[112:115]
s_add_u32 s43,s43,4096
M a[144:147],v[148:151],v[176:179],a[144:147]
buffer_load_dwordx4 v[176:179],v248,s[32:35],s43 offen sc1
s_waitcnt vmcnt(23)
M a[20:23],v[132:135],v[180:183],a[20:23]
M a[52:55],v[136:139],v[180:183],a[52:55]
M a[84:87],v[140:143],v[180:183],a[84:87]
M a[116:119],v[144:147],v[180:183],a[116:119]
s_add_u32 s43,s43,4096
M a[148:151],v[148:151],v[180:183],a[148:151]
buffer_load_dwordx4 v[180:183],v248,s[32:35],s43 offen sc1
s_waitcnt vmcnt(23)
M a[24:27],v[132:135],v[184:187],a[24:27]
M a[56:59],v[136:139],v[184:187],a[56:59]
M a[88:91],v[140:143],v[184:187],a[88:91]
M a[120:123],v[144:147],v[184:187],a[120:123]
s_add_u32 s43,s43,4096
M a[152:155],v[148:151],v[184:187],a[152:155]
buffer_load_dwordx4 v[184:187],v248,s[32:35],s43 offen sc1
s_waitcnt vmcnt(23)
M a[28:31],v[132:135],v[188:191],a[28:31]
ds_read_b128 v[132:135],v228 offset:50176
M a[60:63],v[136:139],v[188:191],a[60:63]
ds_read_b128 v[136:139],v228 offset:51200
M a[92:95],v[140:143],v[188:191],a[92:95]
ds_read_b128 v[140:143],v228 offset:52224
M a[124:127],v[144:147],v[188:191],a[124:127]
ds_read_b128 v[144:147],v229 offset:16384
s_add_u32 s43,s43,4096
M a[156:159],v[148:151],v[188:191],a[156:159]
buffer_load_dwordx4 v[188:191],v248,s[32:35],s43 offen sc1
ds_read_b128 v[148:151],v229 offset:17408
s_waitcnt vmcnt(23)
M a[0:3],v[152:155],v[64:67],a[0:3]
M a[32:35],v[156:159],v[64:67],a[32:35]
M a[64:67],a[192:195],v[64:67],a[64:67]
M a[96:99],a[196:199],v[64:67],a[96:99]
s_sub_u32 s43,s43,28672
M a[128:131],a[200:203],v[64:67],a[128:131]
buffer_load_dwordx4 v[64:67],v249,s[32:35],s43 offen sc1
s_waitcnt vmcnt(23)
M a[4:7],v[152:155],v[68:71],a[4:7]
M a[36:39],v[156:159],v[68:71],a[36:39]
M a[68:71],a[192:195],v[68:71],a[68:71]
M a[100:103],a[196:199],v[68:71],a[100:103]
s_add_u32 s43,s43,4096
M a[132:135],a[200:203],v[68:71],a[132:135]
buffer_load_dwordx4 v[68:71],v249,s[32:35],s43 offen sc1
s_waitcnt vmcnt(23)
M a[8:11],v[152:155],v[72:75],a[8:11]
M a[40:43],v[156:159],v[72:75],a[40:43]
M a[72:75],a[192:195],v[72:75],a[72:75]
M a[104:107],a[196:199],v[72:75],a[104:107]
s_add_u32 s43,s43,4096
M a[136:139],a[200:203],v[72:75],a[136:139]
buffer_load_dwordx4 v[72:75],v249,s[32:35],s43 offen sc1
s_waitcnt vmcnt(23)
M a[12:15],v[152:155],v[76:79],a[12:15]
M a[44:47],v[156:159],v[76:79],a[44:47]
M a[76:79],a[192:195],v[76:79],a[76:79]
M a[108:111],a[196:199],v[76:79],a[108:111]
s_add_u32 s43,s43,4096
M a[140:143],a[200:203],v[76:79],a[140:143]
buffer_load_dwordx4 v[76:79],v249,s[32:35],s43 offen sc1
s_waitcnt vmcnt(23)
M a[16:19],v[152:155],v[80:83],a[16:19]
M a[48:51],v[156:159],v[80:83],a[48:51]
M a[80:83],a[192:195],v[80:83],a[80:83]
M a[112:115],a[196:199],v[80:83],a[112:115]
s_add_u32 s43,s43,4096
M a[144:147],a[200:203],v[80:83],a[144:147]
buffer_load_dwordx4 v[80:83],v249,s[32:35],s43 offen sc1
s_waitcnt vmcnt(23)
M a[20:23],v[152:155],v[84:87],a[20:23]
M a[52:55],v[156:159],v[84:87],a[52:55]
M a[84:87],a[192:195],v[84:87],a[84:87]
M a[116:119],a[196:199],v[84:87],a[116:119]
s_add_u32 s43,s43,4096
M a[148:151],a[200:203],v[84:87],a[148:151]
buffer_load_dwordx4 v[84:87],v249,s[32:35],s43 offen sc1
s_waitcnt vmcnt(23)
M a[24:27],v[152:155],v[88:91],a[24:27]
M a[56:59],v[156:159],v[88:91],a[56:59]
M a[88:91],a[192:195],v[88:91],a[88:91]
M a[120:123],a[196:199],v[88:91],a[120:123]
s_add_u32 s43,s43,4096
M a[152:155],a[200:203],v[88:91],a[152:155]
buffer_load_dwordx4 v[88:91],v249,s[32:35],s43 offen sc1
s_waitcnt vmcnt(23)
M a[28:31],v[152:155],v[92:95],a[28:31]
ds_read_b128 v[152:155],v229 offset:18432
M a[60:63],v[156:159],v[92:95],a[60:63]
ds_read_b128 v[156:159],v229 offset:19456
M a[92:95],a[192:195],v[92:95],a[92:95]
ds_read_b128 a[192:195],v228 offset:0
M a[124:127],a[196:199],v[92:95],a[124:127]
ds_read_b128 a[196:199],v228 offset:1024
s_add_u32 s43,s43,4096
M a[156:159],a[200:203],v[92:95],a[156:159]
buffer_load_dwordx4 v[92:95],v249,s[32:35],s43 offen sc1
ds_read_b128 a[200:203],v228 offset:2048
s_waitcnt vmcnt(23)
M a[0:3],a[204:207],v[96:99],a[0:3]
M a[32:35],a[208:211],v[96:99],a[32:35]
M a[64:67],a[212:215],v[96:99],a[64:67]
M a[96:99],a[216:219],v[96:99],a[96:99]
s_sub_u32 s43,s43,28672
M a[128:131],a[220:223],v[96:99],a[128:131]
buffer_load_dwordx4 v[96:99],v250,s[32:35],s43 offen sc1
s_waitcnt vmcnt(23)
M a[4:7],a[204:207],v[100:103],a[4:7]
M a[36:39],a[208:211],v[100:103],a[36:39]
M a[68:71],a[212:215],v[100:103],a[68:71]
M a[100:103],a[216:219],v[100:103],a[100:103]
s_add_u32 s43,s43,4096
M a[132:135],a[220:223],v[100:103],a[132:135]
buffer_load_dwordx4 v[100:103],v250,s[32:35],s43 offen sc1
s_waitcnt vmcnt(23)
M a[8:11],a[204:207],v[104:107],a[8:11]
M a[40:43],a[208:211],v[104:107],a[40:43]
M a[72:75],a[212:215],v[104:107],a[72:75]
M a[104:107],a[216:219],v[104:107],a[104:107]
s_add_u32 s43,s43,4096
M a[136:139],a[220:223],v[104:107],a[136:139]
buffer_load_dwordx4 v[104:107],v250,s[32:35],s43 offen sc1
s_waitcnt vmcnt(23)
M a[12:15],a[204:207],v[108:111],a[12:15]
M a[44:47],a[208:211],v[108:111],a[44:47]
M a[76:79],a[212:215],v[108:111],a[76:79]
M a[108:111],a[216:219],v[108:111],a[108:111]
s_add_u32 s43,s43,4096
M a[140:143],a[220:223],v[108:111],a[140:143]
buffer_load_dwordx4 v[108:111],v250,s[32:35],s43 offen sc1
s_waitcnt vmcnt(23)
M a[16:19],a[204:207],v[112:115],a[16:19]
M a[48:51],a[208:211],v[112:115],a[48:51]
M a[80:83],a[212:215],v[112:115],a[80:83]
M a[112:115],a[216:219],v[112:115],a[112:115]
s_add_u32 s43,s43,4096
M a[144:147],a[220:223],v[112:115],a[144:147]
buffer_load_dwordx4 v[112:115],v250,s[32:35],s43 offen sc1
s_waitcnt vmcnt(23)
M a[20:23],a[204:207],v[116:119],a[20:23]
M a[52:55],a[208:211],v[116:119],a[52:55]
M a[84:87],a[212:215],v[116:119],a[84:87]
M a[116:119],a[216:219],v[116:119],a[116:119]
s_add_u32 s43,s43,4096
M a[148:151],a[220:223],v[116:119],a[148:151]
buffer_load_dwordx4 v[116:119],v250,s[32:35],s43 offen sc1
s_waitcnt vmcnt(23)
M a[24:27],a[204:207],v[120:123],a[24:27]
M a[56:59],a[208:211],v[120:123],a[56:59]
M a[88:91],a[212:215],v[120:123],a[88:91]
M a[120:123],a[216:219],v[120:123],a[120:123]
s_add_u32 s43,s43,4096
M a[152:155],a[220:223],v[120:123],a[152:155]
buffer_load_dwordx4 v[120:123],v250,s[32:35],s43 offen sc1
s_waitcnt vmcnt(23)
M a[28:31],a[204:207],v[124:127],a[28:31]
ds_read_b128 a[204:207],v228 offset:3072
M a[60:63],a[208:211],v[124:127],a[60:63]
M a[92:95],a[212:215],v[124:127],a[92:95]
M a[124:127],a[216:219],v[124:127],a[124:127]
s_add_u32 s43,s43,4096
M a[156:159],a[220:223],v[124:127],a[156:159]
buffer_load_dwordx4 v[124:127],v250,s[32:35],s43 offen sc1
s_waitcnt vmcnt(23) lgkmcnt(15)
M a[20:23],a[224:227],v[160:163],a[20:23]
M a[52:55],a[228:231],v[160:163],a[52:55]
buffer_load_dwordx4 v[202:205],v254,s[32:35],0 offen offset:0 sc1
M a[84:87],a[232:235],v[160:163],a[84:87]
M a[116:119],a[236:239],v[160:163],a[116:119]
s_sub_u32 s43,s43,28672
M a[148:151],v[0:3],v[160:163],a[148:151]
buffer_load_dwordx4 v[160:163],v247,s[32:35],s43 offen sc1
s_waitcnt vmcnt(24)
M a[20:23],v[4:7],v[164:167],a[20:23]
M a[52:55],v[8:11],v[164:167],a[52:55]
buffer_load_dwordx4 v[206:209],v254,s[32:35],0 offen offset:16 sc1
M a[84:87],v[12:15],v[164:167],a[84:87]
M a[116:119],v[16:19],v[164:167],a[116:119]
s_add_u32 s43,s43,4096
M a[148:151],v[20:23],v[164:167],a[148:151]
buffer_load_dwordx4 v[164:167],v247,s[32:35],s43 offen sc1
s_waitcnt vmcnt(25)
M a[20:23],v[24:27],v[168:171],a[20:23]
M a[52:55],v[28:31],v[168:171],a[52:55]
buffer_load_dwordx4 v[210:213],v254,s[32:35],0 offen offset:32 sc1
M a[84:87],v[32:35],v[168:171],a[84:87]
M a[116:119],v[36:39],v[168:171],a[116:119]
s_add_u32 s43,s43,4096
M a[148:151],v[40:43],v[168:171],a[148:151]
buffer_load_dwordx4 v[168:171],v247,s[32:35],s43 offen sc1
s_waitcnt vmcnt(26)
M a[20:23],v[44:47],v[172:175],a[20:23]
M a[52:55],v[48:51],v[172:175],a[52:55]
buffer_load_dwordx4 v[214:217],v254,s[32:35],0 offen offset:48 sc1
M a[84:87],v[52:55],v[172:175],a[84:87]
M a[116:119],v[56:59],v[172:175],a[116:119]
s_add_u32 s43,s43,4096
M a[148:151],v[60:63],v[172:175],a[148:151]
buffer_load_dwordx4 v[172:175],v247,s[32:35],s43 offen sc1
s_waitcnt vmcnt(27)
M a[20:23],a[160:163],v[176:179],a[20:23]
M a[52:55],a[164:167],v[176:179],a[52:55]
buffer_load_dwordx4 v[218:221],v254,s[32:35],0 offen offset:64 sc1
M a[84:87],a[168:171],v[176:179],a[84:87]
M a[116:119],a[172:175],v[176:179],a[116:119]
s_add_u32 s43,s43,4096
M a[148:151],a[176:179],v[176:179],a[148:151]
buffer_load_dwordx4 v[176:179],v247,s[32:35],s43 offen sc1
s_waitcnt vmcnt(28) lgkmcnt(10)
M a[20:23],a[180:183],v[180:183],a[20:23]
M a[52:55],a[184:187],v[180:183],a[52:55]
M a[84:87],a[188:191],v[180:183],a[84:87]
M a[116:119],v[128:131],v[180:183],a[116:119]
s_add_u32 s43,s43,4096
M a[148:151],v[132:135],v[180:183],a[148:151]
buffer_load_dwordx4 v[180:183],v247,s[32:35],s43 offen sc1
s_waitcnt vmcnt(28) lgkmcnt(5)
M a[20:23],v[136:139],v[184:187],a[20:23]
M a[52:55],v[140:143],v[184:187],a[52:55]
M a[84:87],v[144:147],v[184:187],a[84:87]
M a[116:119],v[148:151],v[184:187],a[116:119]
s_add_u32 s43,s43,4096
M a[148:151],v[152:155],v[184:187],a[148:151]
buffer_load_dwordx4 v[184:187],v247,s[32:35],s43 offen sc1
s_waitcnt vmcnt(28) lgkmcnt(0)
M a[20:23],v[156:159],v[188:191],a[20:23]
M a[52:55],a[192:195],v[188:191],a[52:55]
M a[84:87],a[196:199],v[188:191],a[84:87]
M a[116:119],a[200:203],v[188:191],a[116:119]
s_add_u32 s43,s43,4096
M a[148:151],a[204:207],v[188:191],a[148:151]
buffer_load_dwordx4 v[188:191],v247,s[32:35],s43 offen sc1
s_waitcnt vmcnt(28)
M a[24:27],a[224:227],v[64:67],a[24:27]
M a[56:59],a[228:231],v[64:67],a[56:59]
M a[88:91],a[232:235],v[64:67],a[88:91]
M a[120:123],a[236:239],v[64:67],a[120:123]
s_add_u32 s52,s52,4096
s_sub_u32 s52,s52,s69
M a[152:155],v[0:3],v[64:67],a[152:155]
buffer_load_dwordx4 v[64:67],v248,s[32:35],s52 offen sc1
s_waitcnt vmcnt(28)
M a[24:27],v[4:7],v[68:71],a[24:27]
M a[56:59],v[8:11],v[68:71],a[56:59]
ds_write_b128 v246,a[20:23] offset:0
M a[88:91],v[12:15],v[68:71],a[88:91]
M a[120:123],v[16:19],v[68:71],a[120:123]
s_add_u32 s52,s52,4096
M a[152:155],v[20:23],v[68:71],a[152:155]
buffer_load_dwordx4 v[68:71],v248,s[32:35],s52 offen sc1
s_waitcnt vmcnt(28)
M a[24:27],v[24:27],v[72:75],a[24:27]
M a[56:59],v[28:31],v[72:75],a[56:59]
M a[88:91],v[32:35],v[72:75],a[88:91]
M a[120:123],v[36:39],v[72:75],a[120:123]
s_add_u32 s52,s52,4096
M a[152:155],v[40:43],v[72:75],a[152:155]
buffer_load_dwordx4 v[72:75],v248,s[32:35],s52 offen sc1
s_waitcnt vmcnt(28)
M a[24:27],v[44:47],v[76:79],a[24:27]
ds_write_b128 v246,a[52:55] offset:1024
M a[56:59],v[48:51],v[76:79],a[56:59]
M a[88:91],v[52:55],v[76:79],a[88:91]
M a[120:123],v[56:59],v[76:79],a[120:123]
s_add_u32 s52,s52,4096
M a[152:155],v[60:63],v[76:79],a[152:155]
buffer_load_dwordx4 v[76:79],v248,s[32:35],s52 offen sc1
s_waitcnt vmcnt(28)
M a[24:27],a[160:163],v[80:83],a[24:27]
M a[56:59],a[164:167],v[80:83],a[56:59]
ds_write_b128 v246,a[84:87] offset:2048
M a[88:91],a[168:171],v[80:83],a[88:91]
M a[120:123],a[172:175],v[80:83],a[120:123]
s_add_u32 s52,s52,4096
M a[152:155],a[176:179],v[80:83],a[152:155]
buffer_load_dwordx4 v[80:83],v248,s[32:35],s52 offen sc1
s_waitcnt vmcnt(28)
M a[24:27],a[180:183],v[84:87],a[24:27]
M a[56:59],a[184:187],v[84:87],a[56:59]
M a[88:91],a[188:191],v[84:87],a[88:91]
ds_write_b128 v246,a[116:119] offset:3072
M a[120:123],v[128:131],v[84:87],a[120:123]
s_add_u32 s52,s52,4096
M a[152:155],v[132:135],v[84:87],a[152:155]
buffer_load_dwordx4 v[84:87],v248,s[32:35],s52 offen sc1
s_waitcnt vmcnt(28)
M a[24:27],v[136:139],v[88:91],a[24:27]
M a[56:59],v[140:143],v[88:91],a[56:59]
M a[88:91],v[144:147],v[88:91],a[88:91]
M a[120:123],v[148:151],v[88:91],a[120:123]
s_add_u32 s52,s52,4096
M a[152:155],v[152:155],v[88:91],a[152:155]
buffer_load_dwordx4 v[88:91],v248,s[32:35],s52 offen sc1
s_waitcnt vmcnt(28)
M a[24:27],v[156:159],v[92:95],a[24:27]
M a[56:59],a[192:195],v[92:95],a[56:59]
ds_write_b128 v246,a[148:151] offset:16384
M a[88:91],a[196:199],v[92:95],a[88:91]
M a[120:123],a[200:203],v[92:95],a[120:123]
s_add_u32 s52,s52,4096
M a[152:155],a[204:207],v[92:95],a[152:155]
buffer_load_dwordx4 v[92:95],v248,s[32:35],s52 offen sc1
s_waitcnt vmcnt(28)
M a[28:31],a[224:227],v[96:99],a[28:31]
M a[60:63],a[228:231],v[96:99],a[60:63]
M a[92:95],a[232:235],v[96:99],a[92:95]
M a[124:127],a[236:239],v[96:99],a[124:127]
s_sub_u32 s52,s52,28672
M a[156:159],v[0:3],v[96:99],a[156:159]
buffer_load_dwordx4 v[96:99],v249,s[32:35],s52 offen sc1
s_waitcnt vmcnt(28)
M a[28:31],v[4:7],v[100:103],a[28:31]
M a[60:63],v[8:11],v[100:103],a[60:63]
ds_write_b128 v246,a[24:27] offset:17408
M a[92:95],v[12:15],v[100:103],a[92:95]
M a[124:127],v[16:19],v[100:103],a[124:127]
s_add_u32 s52,s52,4096
M a[156:159],v[20:23],v[100:103],a[156:159]
buffer_load_dwordx4 v[100:103],v249,s[32:35],s52 offen sc1
s_waitcnt vmcnt(28)
M a[28:31],v[24:27],v[104:107],a[28:31]
M a[60:63],v[28:31],v[104:107],a[60:63]
M a[92:95],v[32:35],v[104:107],a[92:95]
M a[124:127],v[36:39],v[104:107],a[124:127]
s_add_u32 s52,s52,4096
M a[156:159],v[40:43],v[104:107],a[156:159]
buffer_load_dwordx4 v[104:107],v249,s[32:35],s52 offen sc1
s_waitcnt vmcnt(28)
M a[28:31],v[44:47],v[108:111],a[28:31]
ds_write_b128 v246,a[56:59] offset:18432
M a[60:63],v[48:51],v[108:111],a[60:63]
M a[92:95],v[52:55],v[108:111],a[92:95]
M a[124:127],v[56:59],v[108:111],a[124:127]
s_add_u32 s52,s52,4096
M a[156:159],v[60:63],v[108:111],a[156:159]
buffer_load_dwordx4 v[108:111],v249,s[32:35],s52 offen sc1
s_waitcnt vmcnt(28)
M a[28:31],a[160:163],v[112:115],a[28:31]
M a[60:63],a[164:167],v[112:115],a[60:63]
ds_write_b128 v246,a[88:91] offset:19456
M a[92:95],a[168:171],v[112:115],a[92:95]
M a[124:127],a[172:175],v[112:115],a[124:127]
s_add_u32 s52,s52,4096
M a[156:159],a[176:179],v[112:115],a[156:159]
buffer_load_dwordx4 v[112:115],v249,s[32:35],s52 offen sc1
s_waitcnt vmcnt(28)
M a[28:31],a[180:183],v[116:119],a[28:31]
M a[60:63],a[184:187],v[116:119],a[60:63]
M a[92:95],a[188:191],v[116:119],a[92:95]
ds_write_b128 v246,a[120:123] offset:32768
M a[124:127],v[128:131],v[116:119],a[124:127]
s_add_u32 s52,s52,4096
M a[156:159],v[132:135],v[116:119],a[156:159]
buffer_load_dwordx4 v[116:119],v249,s[32:35],s52 offen sc1
s_waitcnt vmcnt(28)
M a[28:31],v[136:139],v[120:123],a[28:31]
M a[60:63],v[140:143],v[120:123],a[60:63]
M a[92:95],v[144:147],v[120:123],a[92:95]
M a[124:127],v[148:151],v[120:123],a[124:127]
s_add_u32 s52,s52,4096
M a[156:159],v[152:155],v[120:123],a[156:159]
buffer_load_dwordx4 v[120:123],v249,s[32:35],s52 offen sc1
s_waitcnt vmcnt(28)
M a[28:31],v[156:159],v[124:127],a[28:31]
M a[60:63],a[192:195],v[124:127],a[60:63]
ds_write_b128 v246,a[152:155] offset:33792
M a[92:95],a[196:199],v[124:127],a[92:95]
M a[124:127],a[200:203],v[124:127],a[124:127]
s_add_u32 s52,s52,4096
M a[156:159],a[204:207],v[124:127],a[156:159]
buffer_load_dwordx4 v[124:127],v249,s[32:35],s52 offen sc1
s_waitcnt vmcnt(27)
M a[16:19],a[224:227],v[160:163],a[16:19]
M a[48:51],a[228:231],v[160:163],a[48:51]
M a[80:83],a[232:235],v[160:163],a[80:83]
M a[112:115],a[236:239],v[160:163],a[112:115]
s_sub_u32 s52,s52,28672
M a[144:147],v[0:3],v[160:163],a[144:147]
buffer_load_dwordx4 a[20:23],v250,s[32:35],s52 offen sc1
s_waitcnt vmcnt(26)
M a[16:19],v[4:7],v[164:167],a[16:19]
ds_write_b128 v246,a[28:31] offset:34816
M a[48:51],v[8:11],v[164:167],a[48:51]
s_waitcnt vmcnt(21)
v_max3_u32 v227,v202,v206,v210
v_max3_u32 v227,v227,v214,v218
v_cmp_eq_u32 vcc,-1,v227
s_cbranch_vccnz L_slow_yv
L_ok_yv:
M a[80:83],v[12:15],v[164:167],a[80:83]
v_lshlrev_b32 v222,16,v245
v_and_b32 v223,0xffff0000,v245
M a[112:115],v[16:19],v[164:167],a[112:115]
ds_write_b128 v246,a[60:63] offset:35840
s_add_u32 s52,s52,4096
M a[144:147],v[20:23],v[164:167],a[144:147]
buffer_load_dwordx4 a[52:55],v250,s[32:35],s52 offen sc1
M a[16:19],v[24:27],v[168:171],a[16:19]
v_rcp_f32 v223,v223
v_lshlrev_b32 v224,16,v192
M a[48:51],v[28:31],v[168:171],a[48:51]
v_and_b32 v225,0xffff0000,v192
v_sub_f32 v224,v224,v222
v_sub_f32 v225,v225,v222
M a[80:83],v[32:35],v[168:171],a[80:83]
ds_write_b128 v246,a[92:95] offset:49152
M a[112:115],v[36:39],v[168:171],a[112:115]
v_fmac_f32 v202,v224,v223
s_add_u32 s52,s52,4096
M a[144:147],v[40:43],v[168:171],a[144:147]
buffer_load_dwordx4 a[84:87],v250,s[32:35],s52 offen sc1
M a[16:19],v[44:47],v[172:175],a[16:19]
v_fmac_f32 v203,v225,v223
v_cvt_pk_bf16_f32 v203,v202,v203
M a[48:51],v[48:51],v[172:175],a[48:51]
v_lshlrev_b32 v202,16,v203
v_and_b32 v203,0xffff0000,v203
v_mul_f32 v224,0xbfb8aa3b,v202
M a[80:83],v[52:55],v[172:175],a[80:83]
ds_write_b128 v246,a[124:127] offset:50176
M a[112:115],v[56:59],v[172:175],a[112:115]
v_mul_f32 v225,0xbfb8aa3b,v203
s_add_u32 s52,s52,4096
M a[144:147],v[60:63],v[172:175],a[144:147]
buffer_load_dwordx4 a[116:119],v250,s[32:35],s52 offen sc1
s_waitcnt vmcnt(23)
M a[16:19],a[160:163],v[176:179],a[16:19]
v_exp_f32 v224,v224
M a[48:51],a[164:167],v[176:179],a[48:51]
v_exp_f32 v225,v225
v_add_f32 v224,1.0,v224
M a[80:83],a[168:171],v[176:179],a[80:83]
ds_write_b128 v246,a[156:159] offset:51200
M a[112:115],a[172:175],v[176:179],a[112:115]
v_add_f32 v225,1.0,v225
v_rcp_f32 v224,v224
s_add_u32 s52,s52,4096
M a[144:147],a[176:179],v[176:179],a[144:147]
buffer_load_dwordx4 a[148:151],v250,s[32:35],s52 offen sc1
s_waitcnt vmcnt(23)
M a[16:19],a[180:183],v[180:183],a[16:19]
v_rcp_f32 v225,v225
v_mul_f32 v202,v202,v224
M a[48:51],a[184:187],v[180:183],a[48:51]
v_mul_f32 v203,v203,v225
v_lshlrev_b32 v224,16,v193
v_and_b32 v225,0xffff0000,v193
M a[80:83],a[188:191],v[180:183],a[80:83]
v_sub_f32 v224,v224,v222
v_sub_f32 v225,v225,v222
v_fmac_f32 v204,v224,v223
M a[112:115],v[128:131],v[180:183],a[112:115]
v_fmac_f32 v205,v225,v223
v_cvt_pk_bf16_f32 v205,v204,v205
s_add_u32 s52,s52,4096
M a[144:147],v[132:135],v[180:183],a[144:147]
buffer_load_dwordx4 a[24:27],v250,s[32:35],s52 offen sc1
s_waitcnt vmcnt(23)
M a[16:19],v[136:139],v[184:187],a[16:19]
v_lshlrev_b32 v204,16,v205
v_and_b32 v205,0xffff0000,v205
v_mul_f32 v224,0xbfb8aa3b,v204
M a[48:51],v[140:143],v[184:187],a[48:51]
v_mul_f32 v225,0xbfb8aa3b,v205
v_exp_f32 v224,v224
M a[80:83],v[144:147],v[184:187],a[80:83]
v_exp_f32 v225,v225
v_add_f32 v224,1.0,v224
M a[112:115],v[148:151],v[184:187],a[112:115]
v_add_f32 v225,1.0,v225
v_rcp_f32 v224,v224
s_add_u32 s52,s52,4096
M a[144:147],v[152:155],v[184:187],a[144:147]
buffer_load_dwordx4 a[56:59],v250,s[32:35],s52 offen sc1
s_waitcnt vmcnt(23)
M a[16:19],v[156:159],v[188:191],a[16:19]
v_rcp_f32 v225,v225
v_mul_f32 v204,v204,v224
M a[48:51],a[192:195],v[188:191],a[48:51]
v_mul_f32 v205,v205,v225
v_lshlrev_b32 v224,16,v194
v_and_b32 v225,0xffff0000,v194
M a[80:83],a[196:199],v[188:191],a[80:83]
v_sub_f32 v224,v224,v222
v_sub_f32 v225,v225,v222
v_fmac_f32 v206,v224,v223
M a[112:115],a[200:203],v[188:191],a[112:115]
v_fmac_f32 v207,v225,v223
s_waitcnt lgkmcnt(0)
s_add_u32 s52,s52,4096
M a[144:147],a[204:207],v[188:191],a[144:147]
buffer_load_dwordx4 a[88:91],v250,s[32:35],s52 offen sc1
s_barrier
s_waitcnt vmcnt(23)
M a[4:7],a[224:227],v[64:67],a[4:7]
M a[36:39],a[228:231],v[64:67],a[36:39]
M a[68:71],a[232:235],v[64:67],a[68:71]
M a[100:103],a[236:239],v[64:67],a[100:103]
s_sub_u32 s52,s52,28672
M a[132:135],v[0:3],v[64:67],a[132:135]
buffer_load_dwordx4 a[208:211],v247,s[32:35],s52 offen sc1
s_waitcnt vmcnt(23)
M a[4:7],v[4:7],v[68:71],a[4:7]
ds_read_b128 v[180:183],v251 offset:0
v_cvt_pk_bf16_f32 v207,v206,v207
v_lshlrev_b32 v206,16,v207
M a[36:39],v[8:11],v[68:71],a[36:39]
ds_read_b128 v[184:187],v251 offset:1024
v_and_b32 v207,0xffff0000,v207
v_mul_f32 v224,0xbfb8aa3b,v206
M a[68:71],v[12:15],v[68:71],a[68:71]
ds_read_b128 v[188:191],v251 offset:2048
v_mul_f32 v225,0xbfb8aa3b,v207
v_exp_f32 v224,v224
M a[100:103],v[16:19],v[68:71],a[100:103]
ds_read_b128 v[232:235],v251 offset:3072
v_exp_f32 v225,v225
s_add_u32 s52,s52,4096
M a[132:135],v[20:23],v[68:71],a[132:135]
buffer_load_dwordx4 a[212:215],v247,s[32:35],s52 offen sc1
s_waitcnt vmcnt(23)
M a[4:7],v[24:27],v[72:75],a[4:7]
ds_read_b128 v[236:239],v251 offset:16384
v_add_f32 v224,1.0,v224
v_accvgpr_read_b32 v160,a16
v_add_f32 v225,1.0,v225
M a[36:39],v[28:31],v[72:75],a[36:39]
v_accvgpr_read_b32 v161,a17
v_rcp_f32 v224,v224
v_accvgpr_read_b32 v162,a18
M a[68:71],v[32:35],v[72:75],a[68:71]
v_accvgpr_read_b32 v163,a19
v_rcp_f32 v225,v225
v_accvgpr_read_b32 v164,a48
M a[100:103],v[36:39],v[72:75],a[100:103]
v_accvgpr_read_b32 v165,a49
v_mul_f32 v206,v206,v224
v_accvgpr_read_b32 v166,a50
v_mul_f32 v207,v207,v225
s_add_u32 s52,s52,4096
M a[132:135],v[40:43],v[72:75],a[132:135]
buffer_load_dwordx4 a[216:219],v247,s[32:35],s52 offen sc1
v_accvgpr_read_b32 v167,a51
s_waitcnt vmcnt(23)
M a[4:7],v[44:47],v[76:79],a[4:7]
v_lshlrev_b32 v224,16,v195
v_accvgpr_read_b32 v168,a80
v_and_b32 v225,0xffff0000,v195
v_accvgpr_read_b32 v169,a81
M a[36:39],v[48:51],v[76:79],a[36:39]
v_sub_f32 v224,v224,v222
v_accvgpr_read_b32 v170,a82
v_sub_f32 v225,v225,v222
v_accvgpr_read_b32 v171,a83
M a[68:71],v[52:55],v[76:79],a[68:71]
v_fmac_f32 v208,v224,v223
v_accvgpr_read_b32 v172,a112
v_fmac_f32 v209,v225,v223
v_accvgpr_read_b32 v173,a113
v_cvt_pk_bf16_f32 v209,v208,v209
M a[100:103],v[56:59],v[76:79],a[100:103]
v_accvgpr_read_b32 v174,a114
v_lshlrev_b32 v208,16,v209
v_accvgpr_read_b32 v175,a115
s_add_u32 s52,s52,4096
M a[132:135],v[60:63],v[76:79],a[132:135]
buffer_load_dwordx4 a[220:223],v247,s[32:35],s52 offen sc1
v_and_b32 v209,0xffff0000,v209
s_waitcnt vmcnt(23)
M a[4:7],a[160:163],v[80:83],a[4:7]
v_accvgpr_read_b32 v176,a144
v_mul_f32 v224,0xbfb8aa3b,v208
v_accvgpr_read_b32 v177,a145
v_mul_f32 v225,0xbfb8aa3b,v209
v_accvgpr_read_b32 v178,a146
M a[36:39],a[164:167],v[80:83],a[36:39]
v_exp_f32 v224,v224
v_accvgpr_read_b32 v179,a147
s_waitcnt lgkmcnt(0)
M a[68:71],a[168:171],v[80:83],a[68:71]
v_exp_f32 v225,v225
v_add_f32 v160,v160,v180
v_add_f32 v161,v161,v181
M a[100:103],a[172:175],v[80:83],a[100:103]
v_add_f32 v224,1.0,v224
v_add_f32 v162,v162,v182
v_add_f32 v225,1.0,v225
s_add_u32 s52,s52,4096
M a[132:135],a[176:179],v[80:83],a[132:135]
buffer_load_dwordx4 a[240:243],v247,s[32:35],s52 offen sc1
v_add_f32 v163,v163,v183
s_waitcnt vmcnt(23)
M a[4:7],a[180:183],v[84:87],a[4:7]
v_rcp_f32 v224,v224
v_add_f32 v164,v164,v184
v_add_f32 v165,v165,v185
M a[36:39],a[184:187],v[84:87],a[36:39]
v_rcp_f32 v225,v225
v_add_f32 v166,v166,v186
v_add_f32 v167,v167,v187
v_mul_f32 v208,v208,v224
M a[68:71],a[188:191],v[84:87],a[68:71]
v_add_f32 v168,v168,v188
v_mul_f32 v209,v209,v225
v_add_f32 v169,v169,v189
v_lshlrev_b32 v224,16,v196
v_add_f32 v170,v170,v190
M a[100:103],v[128:131],v[84:87],a[100:103]
v_and_b32 v225,0xffff0000,v196
v_add_f32 v171,v171,v191
v_sub_f32 v224,v224,v222
s_add_u32 s52,s52,4096
M a[132:135],v[132:135],v[84:87],a[132:135]
buffer_load_dwordx4 a[244:247],v247,s[32:35],s52 offen sc1
v_add_f32 v172,v172,v232
s_waitcnt vmcnt(23)
M a[4:7],v[136:139],v[88:91],a[4:7]
v_sub_f32 v225,v225,v222
v_add_f32 v173,v173,v233
v_fmac_f32 v210,v224,v223
v_add_f32 v174,v174,v234
v_fmac_f32 v211,v225,v223
M a[36:39],v[140:143],v[88:91],a[36:39]
v_add_f32 v175,v175,v235
v_cvt_pk_bf16_f32 v211,v210,v211
v_add_f32 v176,v176,v236
v_lshlrev_b32 v210,16,v211
v_add_f32 v177,v177,v237
M a[68:71],v[144:147],v[88:91],a[68:71]
v_and_b32 v211,0xffff0000,v211
v_add_f32 v178,v178,v238
v_mul_f32 v224,0xbfb8aa3b,v210
v_add_f32 v179,v179,v239
v_mul_f32 v225,0xbfb8aa3b,v211
M a[100:103],v[148:151],v[88:91],a[100:103]
ds_read_b128 v[180:183],v252 offset:17408
v_exp_f32 v224,v224
s_add_u32 s52,s52,4096
M a[132:135],v[152:155],v[88:91],a[132:135]
buffer_load_dwordx4 a[248:251],v247,s[32:35],s52 offen sc1
s_waitcnt vmcnt(23)
M a[4:7],v[156:159],v[92:95],a[4:7]
ds_read_b128 v[184:187],v252 offset:18432
v_exp_f32 v225,v225
M a[36:39],a[192:195],v[92:95],a[36:39]
ds_read_b128 v[188:191],v252 offset:19456
v_add_f32 v224,1.0,v224
v_add_f32 v225,1.0,v225
M a[68:71],a[196:199],v[92:95],a[68:71]
ds_read_b128 v[232:235],v252 offset:32768
v_rcp_f32 v224,v224
M a[100:103],a[200:203],v[92:95],a[100:103]
ds_read_b128 v[236:239],v252 offset:33792
v_rcp_f32 v225,v225
s_add_u32 s52,s52,4096
M a[132:135],a[204:207],v[92:95],a[132:135]
buffer_load_dwordx4 a[252:255],v247,s[32:35],s52 offen sc1
s_waitcnt lgkmcnt(0)
s_waitcnt vmcnt(23)
M a[8:11],a[224:227],v[96:99],a[8:11]
M a[40:43],a[228:231],v[96:99],a[40:43]
M a[72:75],a[232:235],v[96:99],a[72:75]
M a[104:107],a[236:239],v[96:99],a[104:107]
M a[136:139],v[0:3],v[96:99],a[136:139]
s_waitcnt vmcnt(22)
M a[8:11],v[4:7],v[100:103],a[8:11]
v_add_f32 v160,v160,v180
v_mul_f32 v210,v210,v224
v_add_f32 v161,v161,v181
v_mul_f32 v211,v211,v225
v_add_f32 v162,v162,v182
M a[40:43],v[8:11],v[100:103],a[40:43]
v_add_f32 v163,v163,v183
v_lshlrev_b32 v224,16,v197
v_add_f32 v164,v164,v184
v_add_f32 v165,v165,v185
M a[72:75],v[12:15],v[100:103],a[72:75]
v_and_b32 v225,0xffff0000,v197
v_add_f32 v166,v166,v186
v_sub_f32 v224,v224,v222
v_add_f32 v167,v167,v187
M a[104:107],v[16:19],v[100:103],a[104:107]
v_add_f32 v168,v168,v188
v_sub_f32 v225,v225,v222
v_add_f32 v169,v169,v189
v_add_f32 v170,v170,v190
M a[136:139],v[20:23],v[100:103],a[136:139]
v_fmac_f32 v212,v224,v223
v_add_f32 v171,v171,v191
v_fmac_f32 v213,v225,v223
s_waitcnt vmcnt(21)
M a[8:11],v[24:27],v[104:107],a[8:11]
v_add_f32 v172,v172,v232
v_add_f32 v173,v173,v233
v_cvt_pk_bf16_f32 v213,v212,v213
v_add_f32 v174,v174,v234
M a[40:43],v[28:31],v[104:107],a[40:43]
v_add_f32 v175,v175,v235
v_lshlrev_b32 v212,16,v213
v_add_f32 v176,v176,v236
v_and_b32 v213,0xffff0000,v213
M a[72:75],v[32:35],v[104:107],a[72:75]
v_add_f32 v177,v177,v237
v_add_f32 v178,v178,v238
v_mul_f32 v224,0xbfb8aa3b,v212
v_add_f32 v179,v179,v239
M a[104:107],v[36:39],v[104:107],a[104:107]
ds_read_b128 v[180:183],v253 offset:34816
v_mul_f32 v225,0xbfb8aa3b,v213
v_exp_f32 v224,v224
M a[136:139],v[40:43],v[104:107],a[136:139]
ds_read_b128 v[184:187],v253 offset:35840
s_waitcnt vmcnt(20)
M a[8:11],v[44:47],v[108:111],a[8:11]
ds_write_b128 v228,a[4:7] offset:0
M a[40:43],v[48:51],v[108:111],a[40:43]
ds_read_b128 v[188:191],v253 offset:49152
v_exp_f32 v225,v225
s_nop 0
ds_read_b128 v[232:235],v253 offset:50176
M a[72:75],v[52:55],v[108:111],a[72:75]
ds_read_b128 v[236:239],v253 offset:51200
v_add_f32 v224,1.0,v224
s_waitcnt lgkmcnt(0)
v_add_f32 v225,1.0,v225
M a[104:107],v[56:59],v[108:111],a[104:107]
v_add_f32 v160,v160,v180
v_rcp_f32 v224,v224
M a[136:139],v[60:63],v[108:111],a[136:139]
v_add_f32 v161,v161,v181
v_add_f32 v162,v162,v182
s_waitcnt vmcnt(19)
M a[8:11],a[160:163],v[112:115],a[8:11]
ds_write_b128 v228,a[36:39] offset:1024
M a[40:43],a[164:167],v[112:115],a[40:43]
v_add_f32 v163,v163,v183
v_add_f32 v164,v164,v184
v_rcp_f32 v225,v225
v_add_f32 v165,v165,v185
M a[72:75],a[168:171],v[112:115],a[72:75]
v_add_f32 v166,v166,v186
v_add_f32 v167,v167,v187
v_mul_f32 v212,v212,v224
v_add_f32 v168,v168,v188
v_add_f32 v169,v169,v189
M a[104:107],a[172:175],v[112:115],a[104:107]
v_mul_f32 v213,v213,v225
v_add_f32 v170,v170,v190
v_lshlrev_b32 v224,16,v198
v_add_f32 v171,v171,v191
M a[136:139],a[176:179],v[112:115],a[136:139]
v_add_f32 v172,v172,v232
v_and_b32 v225,0xffff0000,v198
v_add_f32 v173,v173,v233
s_waitcnt vmcnt(18)
M a[8:11],a[180:183],v[116:119],a[8:11]
ds_write_b128 v228,a[68:71] offset:2048
M a[40:43],a[184:187],v[116:119],a[40:43]
v_add_f32 v174,v174,v234
v_sub_f32 v224,v224,v222
v_add_f32 v175,v175,v235
v_add_f32 v176,v176,v236
v_sub_f32 v225,v225,v222
v_add_f32 v177,v177,v237
M a[72:75],a[188:191],v[116:119],a[72:75]
v_fmac_f32 v214,v224,v223
v_add_f32 v178,v178,v238
v_add_f32 v179,v179,v239
v_fmac_f32 v215,v225,v223
s_add_u32 s50,s93,4096
M a[104:107],v[128:131],v[116:119],a[104:107]
buffer_store_dwordx4 v[160:163],v243,s[32:35],s93 offen offset:0 sc1
v_cvt_pk_bf16_f32 v215,v214,v215
v_lshlrev_b32 v214,16,v215
M a[136:139],v[132:135],v[116:119],a[136:139]
buffer_store_dwordx4 v[164:167],v243,s[32:35],s93 offen offset:1024 sc1
s_waitcnt vmcnt(19)
M a[8:11],v[136:139],v[120:123],a[8:11]
ds_write_b128 v228,a[100:103] offset:3072
M a[40:43],v[140:143],v[120:123],a[40:43]
v_and_b32 v215,0xffff0000,v215
v_mul_f32 v224,0xbfb8aa3b,v214
M a[72:75],v[144:147],v[120:123],a[72:75]
buffer_store_dwordx4 v[168:171],v243,s[32:35],s93 offen offset:2048 sc1
v_mul_f32 v225,0xbfb8aa3b,v215
v_exp_f32 v224,v224
M a[104:107],v[148:151],v[120:123],a[104:107]
buffer_store_dwordx4 v[172:175],v243,s[32:35],s93 offen offset:3072 sc1
v_exp_f32 v225,v225
M a[136:139],v[152:155],v[120:123],a[136:139]
buffer_store_dwordx4 v[176:179],v243,s[32:35],s50 offen offset:0 sc1
s_waitcnt vmcnt(21)
M a[8:11],v[156:159],v[124:127],a[8:11]
ds_write_b128 v228,a[132:135] offset:16384
M a[40:43],a[192:195],v[124:127],a[40:43]
v_add_f32 v224,1.0,v224
v_add_f32 v225,1.0,v225
v_rcp_f32 v224,v224
M a[72:75],a[196:199],v[124:127],a[72:75]
v_rcp_f32 v225,v225
v_mul_f32 v214,v214,v224
v_mul_f32 v215,v215,v225
M a[104:107],a[200:203],v[124:127],a[104:107]
v_lshlrev_b32 v224,16,v199
v_and_b32 v225,0xffff0000,v199
v_sub_f32 v224,v224,v222
v_sub_f32 v225,v225,v222
M a[136:139],a[204:207],v[124:127],a[136:139]
v_fmac_f32 v216,v224,v223
v_fmac_f32 v217,v225,v223
v_cvt_pk_bf16_f32 v217,v216,v217
v_lshlrev_b32 v216,16,v217
v_and_b32 v217,0xffff0000,v217
s_waitcnt vmcnt(20)
M a[12:15],a[224:227],a[20:23],a[12:15]
M a[44:47],a[228:231],a[20:23],a[44:47]
M a[76:79],a[232:235],a[20:23],a[76:79]
M a[108:111],a[236:239],a[20:23],a[108:111]
M a[140:143],v[0:3],a[20:23],a[140:143]
s_waitcnt vmcnt(19)
M a[12:15],v[4:7],a[52:55],a[12:15]
ds_write_b128 v228,a[8:11] offset:17408
M a[44:47],v[8:11],a[52:55],a[44:47]
v_mul_f32 v224,0xbfb8aa3b,v216
v_mul_f32 v225,0xbfb8aa3b,v217
M a[76:79],v[12:15],a[52:55],a[76:79]
v_exp_f32 v224,v224
M a[108:111],v[16:19],a[52:55],a[108:111]
v_exp_f32 v225,v225
M a[140:143],v[20:23],a[52:55],a[140:143]
v_add_f32 v224,1.0,v224
s_waitcnt vmcnt(18)
M a[12:15],v[24:27],a[84:87],a[12:15]
v_add_f32 v225,1.0,v225
v_rcp_f32 v224,v224
M a[44:47],v[28:31],a[84:87],a[44:47]
v_rcp_f32 v225,v225
v_mul_f32 v216,v216,v224
M a[76:79],v[32:35],a[84:87],a[76:79]
ds_write_b128 v228,a[40:43] offset:18432
M a[108:111],v[36:39],a[84:87],a[108:111]
v_mul_f32 v217,v217,v225
v_lshlrev_b32 v224,16,v200
M a[140:143],v[40:43],a[84:87],a[140:143]
v_and_b32 v225,0xffff0000,v200
s_waitcnt vmcnt(17)
M a[12:15],v[44:47],a[116:119],a[12:15]
v_sub_f32 v224,v224,v222
v_sub_f32 v225,v225,v222
M a[44:47],v[48:51],a[116:119],a[44:47]
v_fmac_f32 v218,v224,v223
v_fmac_f32 v219,v225,v223
M a[76:79],v[52:55],a[116:119],a[76:79]
v_cvt_pk_bf16_f32 v219,v218,v219
v_lshlrev_b32 v218,16,v219
M a[108:111],v[56:59],a[116:119],a[108:111]
v_and_b32 v219,0xffff0000,v219
v_mul_f32 v224,0xbfb8aa3b,v218
M a[140:143],v[60:63],a[116:119],a[140:143]
v_mul_f32 v225,0xbfb8aa3b,v219
s_waitcnt vmcnt(16)
M a[12:15],a[160:163],a[148:151],a[12:15]
v_exp_f32 v224,v224
M a[44:47],a[164:167],a[148:151],a[44:47]
ds_write_b128 v228,a[72:75] offset:19456
M a[76:79],a[168:171],a[148:151],a[76:79]
v_exp_f32 v225,v225
M a[108:111],a[172:175],a[148:151],a[108:111]
v_add_f32 v224,1.0,v224
v_add_f32 v225,1.0,v225
M a[140:143],a[176:179],a[148:151],a[140:143]
v_rcp_f32 v224,v224
s_waitcnt vmcnt(15)
M a[12:15],a[180:183],a[24:27],a[12:15]
v_rcp_f32 v225,v225
v_mul_f32 v218,v218,v224
M a[44:47],a[184:187],a[24:27],a[44:47]
v_mul_f32 v219,v219,v225
v_lshlrev_b32 v224,16,v201
M a[76:79],a[188:191],a[24:27],a[76:79]
ds_write_b128 v228,a[104:107] offset:32768
M a[108:111],v[128:131],a[24:27],a[108:111]
v_and_b32 v225,0xffff0000,v201
v_sub_f32 v224,v224,v222
M a[140:143],v[132:135],a[24:27],a[140:143]
v_sub_f32 v225,v225,v222
s_waitcnt vmcnt(14)
M a[12:15],v[136:139],a[56:59],a[12:15]
v_fmac_f32 v220,v224,v223
v_fmac_f32 v221,v225,v223
v_cvt_pk_bf16_f32 v221,v220,v221
M a[44:47],v[140:143],a[56:59],a[44:47]
v_lshlrev_b32 v220,16,v221
v_and_b32 v221,0xffff0000,v221
M a[76:79],v[144:147],a[56:59],a[76:79]
v_mul_f32 v224,0xbfb8aa3b,v220
v_mul_f32 v225,0xbfb8aa3b,v221
M a[108:111],v[148:151],a[56:59],a[108:111]
v_exp_f32 v224,v224
M a[140:143],v[152:155],a[56:59],a[140:143]
v_exp_f32 v225,v225
s_waitcnt vmcnt(13)
M a[12:15],v[156:159],a[88:91],a[12:15]
ds_write_b128 v228,a[136:139] offset:33792
M a[44:47],a[192:195],a[88:91],a[44:47]
v_add_f32 v224,1.0,v224
v_add_f32 v225,1.0,v225
M a[76:79],a[196:199],a[88:91],a[76:79]
v_rcp_f32 v224,v224
v_rcp_f32 v225,v225
M a[108:111],a[200:203],a[88:91],a[108:111]
v_mul_f32 v220,v220,v224
v_mul_f32 v221,v221,v225
M a[140:143],a[204:207],a[88:91],a[140:143]
v_add_u32 v251,0x10000,v251
v_add_u32 v252,0x10000,v252
v_add_u32 v253,0x10000,v253
s_waitcnt vmcnt(12)
M a[0:3],a[224:227],a[208:211],a[0:3]
M a[32:35],a[228:231],a[208:211],a[32:35]
M a[64:67],a[232:235],a[208:211],a[64:67]
M a[96:99],a[236:239],a[208:211],a[96:99]
M a[128:131],v[0:3],a[208:211],a[128:131]
s_waitcnt vmcnt(11)
M a[0:3],v[4:7],a[212:215],a[0:3]
M a[32:35],v[8:11],a[212:215],a[32:35]
ds_write_b128 v228,a[12:15] offset:34816
M a[64:67],v[12:15],a[212:215],a[64:67]
M a[96:99],v[16:19],a[212:215],a[96:99]
M a[128:131],v[20:23],a[212:215],a[128:131]
s_waitcnt vmcnt(10)
M a[0:3],v[24:27],a[216:219],a[0:3]
ds_write_b128 v228,a[44:47] offset:35840
M a[32:35],v[28:31],a[216:219],a[32:35]
M a[64:67],v[32:35],a[216:219],a[64:67]
M a[96:99],v[36:39],a[216:219],a[96:99]
ds_write_b128 v228,a[76:79] offset:49152
M a[128:131],v[40:43],a[216:219],a[128:131]
s_waitcnt vmcnt(9)
M a[0:3],v[44:47],a[220:223],a[0:3]
M a[32:35],v[48:51],a[220:223],a[32:35]
M a[64:67],v[52:55],a[220:223],a[64:67]
ds_write_b128 v228,a[108:111] offset:50176
M a[96:99],v[56:59],a[220:223],a[96:99]
M a[128:131],v[60:63],a[220:223],a[128:131]
s_waitcnt vmcnt(8)
M a[0:3],a[160:163],a[240:243],a[0:3]
M a[32:35],a[164:167],a[240:243],a[32:35]
ds_write_b128 v228,a[140:143] offset:51200
M a[64:67],a[168:171],a[240:243],a[64:67]
M a[96:99],a[172:175],a[240:243],a[96:99]
s_waitcnt lgkmcnt(0)
s_barrier
M a[128:131],a[176:179],a[240:243],a[128:131]
s_waitcnt vmcnt(7)
M a[0:3],a[180:183],a[244:247],a[0:3]
ds_read_b128 v[96:99],v251 offset:0
M a[32:35],a[184:187],a[244:247],a[32:35]
ds_read_b128 v[100:103],v251 offset:1024
M a[64:67],a[188:191],a[244:247],a[64:67]
ds_read_b128 v[104:107],v251 offset:2048
M a[96:99],v[128:131],a[244:247],a[96:99]
ds_read_b128 v[108:111],v251 offset:3072
M a[128:131],v[132:135],a[244:247],a[128:131]
ds_read_b128 v[112:115],v251 offset:16384
s_waitcnt vmcnt(6)
M a[0:3],v[136:139],a[248:251],a[0:3]
ds_read_b128 v[64:67],v252 offset:17408
M a[32:35],v[140:143],a[248:251],a[32:35]
ds_read_b128 v[68:71],v252 offset:18432
M a[64:67],v[144:147],a[248:251],a[64:67]
ds_read_b128 v[72:75],v252 offset:19456
M a[96:99],v[148:151],a[248:251],a[96:99]
ds_read_b128 v[76:79],v252 offset:32768
M a[128:131],v[152:155],a[248:251],a[128:131]
ds_read_b128 v[80:83],v252 offset:33792
s_waitcnt vmcnt(5)
M a[0:3],v[156:159],a[252:255],a[0:3]
ds_read_b128 v[116:119],v253 offset:34816
M a[32:35],a[192:195],a[252:255],a[32:35]
ds_read_b128 v[120:123],v253 offset:35840
M a[64:67],a[196:199],a[252:255],a[64:67]
ds_read_b128 v[124:127],v253 offset:49152
M a[96:99],a[200:203],a[252:255],a[96:99]
ds_read_b128 v[84:87],v253 offset:50176
M a[128:131],a[204:207],a[252:255],a[128:131]
ds_read_b128 v[88:91],v253 offset:51200
s_add_u32 s51,s44,4096
buffer_load_dwordx4 v[20:23],v243,s[32:35],s44 offen offset:0 sc1
buffer_load_dwordx4 v[24:27],v243,s[32:35],s44 offen offset:1024 sc1
buffer_load_dwordx4 v[28:31],v243,s[32:35],s44 offen offset:2048 sc1
buffer_load_dwordx4 v[32:35],v243,s[32:35],s44 offen offset:3072 sc1
buffer_load_dwordx4 v[36:39],v243,s[32:35],s51 offen offset:0 sc1
v_lshlrev_b32 v40,16,v192
v_and_b32 v41,0xffff0000,v192
v_lshlrev_b32 v42,16,v193
v_and_b32 v43,0xffff0000,v193
v_lshlrev_b32 v44,16,v194
v_and_b32 v45,0xffff0000,v194
v_lshlrev_b32 v46,16,v195
v_and_b32 v47,0xffff0000,v195
v_lshlrev_b32 v48,16,v196
v_and_b32 v49,0xffff0000,v196
v_lshlrev_b32 v50,16,v197
v_and_b32 v51,0xffff0000,v197
v_lshlrev_b32 v52,16,v198
v_and_b32 v53,0xffff0000,v198
v_lshlrev_b32 v54,16,v199
v_and_b32 v55,0xffff0000,v199
v_lshlrev_b32 v56,16,v200
v_and_b32 v57,0xffff0000,v200
v_lshlrev_b32 v58,16,v201
v_and_b32 v59,0xffff0000,v201
v_accvgpr_read_b32 v0,a0
v_accvgpr_read_b32 v1,a1
v_accvgpr_read_b32 v2,a2
v_accvgpr_read_b32 v3,a3
v_accvgpr_read_b32 v4,a32
v_accvgpr_read_b32 v5,a33
v_accvgpr_read_b32 v6,a34
v_accvgpr_read_b32 v7,a35
v_accvgpr_read_b32 v8,a64
v_accvgpr_read_b32 v9,a65
v_accvgpr_read_b32 v10,a66
v_accvgpr_read_b32 v11,a67
v_accvgpr_read_b32 v12,a96
v_accvgpr_read_b32 v13,a97
v_accvgpr_read_b32 v14,a98
v_accvgpr_read_b32 v15,a99
v_accvgpr_read_b32 v16,a128
v_accvgpr_read_b32 v17,a129
v_accvgpr_read_b32 v18,a130
v_accvgpr_read_b32 v19,a131
s_waitcnt lgkmcnt(10)
v_pk_add_f32 v[0:1],v[0:1],v[96:97]
v_pk_add_f32 v[2:3],v[2:3],v[98:99]
v_pk_add_f32 v[4:5],v[4:5],v[100:101]
v_pk_add_f32 v[6:7],v[6:7],v[102:103]
v_pk_add_f32 v[8:9],v[8:9],v[104:105]
v_pk_add_f32 v[10:11],v[10:11],v[106:107]
v_pk_add_f32 v[12:13],v[12:13],v[108:109]
v_pk_add_f32 v[14:15],v[14:15],v[110:111]
v_pk_add_f32 v[16:17],v[16:17],v[112:113]
v_pk_add_f32 v[18:19],v[18:19],v[114:115]
s_waitcnt lgkmcnt(5)
v_pk_add_f32 v[0:1],v[0:1],v[64:65]
v_pk_add_f32 v[2:3],v[2:3],v[66:67]
v_pk_add_f32 v[4:5],v[4:5],v[68:69]
v_pk_add_f32 v[6:7],v[6:7],v[70:71]
v_pk_add_f32 v[8:9],v[8:9],v[72:73]
v_pk_add_f32 v[10:11],v[10:11],v[74:75]
v_pk_add_f32 v[12:13],v[12:13],v[76:77]
v_pk_add_f32 v[14:15],v[14:15],v[78:79]
v_pk_add_f32 v[16:17],v[16:17],v[80:81]
v_pk_add_f32 v[18:19],v[18:19],v[82:83]
s_waitcnt lgkmcnt(0)
v_pk_add_f32 v[0:1],v[0:1],v[116:117]
v_pk_add_f32 v[2:3],v[2:3],v[118:119]
v_pk_add_f32 v[4:5],v[4:5],v[120:121]
v_pk_add_f32 v[6:7],v[6:7],v[122:123]
v_pk_add_f32 v[8:9],v[8:9],v[124:125]
v_pk_add_f32 v[10:11],v[10:11],v[126:127]
v_pk_add_f32 v[12:13],v[12:13],v[84:85]
v_pk_add_f32 v[14:15],v[14:15],v[86:87]
v_pk_add_f32 v[16:17],v[16:17],v[88:89]
v_pk_add_f32 v[18:19],v[18:19],v[90:91]
s_mov_b32 s65,400000
L_wait_x:
s_waitcnt vmcnt(0)
v_max3_u32 v227,v20,v24,v28
v_max3_u32 v227,v227,v32,v36
v_cmp_eq_u32 vcc,-1,v227
s_cbranch_vccz L_have_x
buffer_load_dwordx4 v[20:23],v243,s[32:35],s44 offen offset:0 sc1
buffer_load_dwordx4 v[24:27],v243,s[32:35],s44 offen offset:1024 sc1
buffer_load_dwordx4 v[28:31],v243,s[32:35],s44 offen offset:2048 sc1
buffer_load_dwordx4 v[32:35],v243,s[32:35],s44 offen offset:3072 sc1
buffer_load_dwordx4 v[36:39],v243,s[32:35],s51 offen offset:0 sc1
s_sub_u32 s65,s65,1
s_cbranch_scc0 L_wait_x
s_waitcnt vmcnt(0)
L_have_x:
v_pk_add_f32 v[0:1],v[0:1],v[20:21]
v_pk_add_f32 v[2:3],v[2:3],v[22:23]
v_pk_add_f32 v[4:5],v[4:5],v[24:25]
v_pk_add_f32 v[6:7],v[6:7],v[26:27]
v_pk_add_f32 v[8:9],v[8:9],v[28:29]
v_pk_add_f32 v[10:11],v[10:11],v[30:31]
v_pk_add_f32 v[12:13],v[12:13],v[32:33]
v_pk_add_f32 v[14:15],v[14:15],v[34:35]
v_pk_add_f32 v[16:17],v[16:17],v[36:37]
v_pk_add_f32 v[18:19],v[18:19],v[38:39]
v_pk_fma_f32 v[0:1],v[0:1],v[202:203],v[40:41]
v_pk_fma_f32 v[2:3],v[2:3],v[204:205],v[42:43]
v_pk_fma_f32 v[4:5],v[4:5],v[206:207],v[44:45]
v_pk_fma_f32 v[6:7],v[6:7],v[208:209],v[46:47]
v_pk_fma_f32 v[8:9],v[8:9],v[210:211],v[48:49]
v_pk_fma_f32 v[10:11],v[10:11],v[212:213],v[50:51]
v_pk_fma_f32 v[12:13],v[12:13],v[214:215],v[52:53]
v_pk_fma_f32 v[14:15],v[14:15],v[216:217],v[54:55]
v_pk_fma_f32 v[16:17],v[16:17],v[218:219],v[56:57]
v_pk_fma_f32 v[18:19],v[18:19],v[220:221],v[58:59]
v_cvt_pk_bf16_f32 v80,v0,v1
v_cvt_pk_bf16_f32 v81,v2,v3
v_cvt_pk_bf16_f32 v82,v4,v5
v_cvt_pk_bf16_f32 v83,v6,v7
v_cvt_pk_bf16_f32 v84,v8,v9
v_cvt_pk_bf16_f32 v85,v10,v11
v_cvt_pk_bf16_f32 v86,v12,v13
v_cvt_pk_bf16_f32 v87,v14,v15
v_cvt_pk_bf16_f32 v88,v16,v17
v_cvt_pk_bf16_f32 v89,v18,v19
s_nop 0
buffer_store_dwordx4 v[80:83],v244,s[20:23],0 offen
buffer_store_dwordx4 v[84:87],v244,s[20:23],0 offen offset:16
buffer_store_dwordx2 v[88:89],v244,s[20:23],0 offen offset:32
s_endpgm
L_slow_key:
s_mov_b32 s65,200000
L_spin_key:
buffer_load_dword v213,v214,s[36:39],0 offen sc0 sc1
s_waitcnt vmcnt(0)
v_cmp_eq_u32 vcc,0,v213
s_cbranch_vccz L_ok_key
s_sleep 4
s_sub_u32 s65,s65,1
s_cmp_lg_u32 s65,0
s_cbranch_scc1 L_spin_key
s_branch L_ok_key
L_slow_cnt:
s_mov_b32 s65,200000
L_spin_cnt:
buffer_load_dword v213,off,s[36:39],0 offset:128 sc0 sc1
s_waitcnt vmcnt(0)
v_cmp_gt_u32 vcc,0x100,v213
s_cbranch_vccz L_ok_cnt
s_sleep 4
s_sub_u32 s65,s65,1
s_cmp_lg_u32 s65,0
s_cbranch_scc1 L_spin_cnt
s_branch L_ok_cnt
L_slow_yp:
s_mov_b32 s65,200000
L_spin_yp:
buffer_load_dwordx4 v[192:195],v208,s[32:35],s63 offen sc0 sc1
buffer_load_dwordx4 v[196:199],v209,s[32:35],s63 offen sc0 sc1
buffer_load_dwordx4 v[200:203],v210,s[32:35],s63 offen sc0 sc1
buffer_load_dwordx4 v[204:207],v211,s[32:35],s63 offen sc0 sc1
s_waitcnt vmcnt(0)
v_max3_u32 v213,v192,v196,v200
v_max_u32 v213,v213,v204
v_cmp_eq_u32 vcc,-1,v213
s_cbranch_vccz L_ok_yp
s_sleep 4
s_sub_u32 s65,s65,1
s_cmp_lg_u32 s65,0
s_cbranch_scc1 L_spin_yp
s_branch L_ok_yp
L_slow_yv:
s_mov_b32 s65,200000
L_spin_yv:
buffer_load_dwordx4 v[202:205],v254,s[32:35],0 offen offset:0 sc0 sc1
buffer_load_dwordx4 v[206:209],v254,s[32:35],0 offen offset:16 sc0 sc1
buffer_load_dwordx4 v[210:213],v254,s[32:35],0 offen offset:32 sc0 sc1
buffer_load_dwordx4 v[214:217],v254,s[32:35],0 offen offset:48 sc0 sc1
buffer_load_dwordx4 v[218:221],v254,s[32:35],0 offen offset:64 sc0 sc1
s_waitcnt vmcnt(0)
v_max3_u32 v227,v202,v206,v210
v_max3_u32 v227,v227,v214,v218
v_cmp_eq_u32 vcc,-1,v227
s_cbranch_vccz L_ok_yv
s_sleep 4
s_sub_u32 s65,s65,1
s_cmp_lg_u32 s65,0
s_cbranch_scc1 L_spin_yv
s_branch L_ok_yv
L_rerun:
s_waitcnt vmcnt(0) lgkmcnt(0)
s_barrier
s_mov_b32 s81,1
s_lshl_b32 s50,s40,6
v_add_u32 v0,s50,v242
s_branch L_go
L_exact:
s_waitcnt vmcnt(0) lgkmcnt(0)
s_barrier
s_lshl_b32 s43,s41,19
s_mov_b32 s44,s43
s_and_b32 s50,s2,1
s_lshl_b32 s50,s50,3
s_bfe_u32 s51,s2,0x30003
s_add_u32 s55,s50,s51
s_bfe_u32 s50,s2,0x10001
s_lshl_b32 s50,s50,2
s_lshr_b32 s51,s2,6
s_add_u32 s54,s50,s51
s_bfe_u32 s50,s2,0x10002
s_xor_b32 s50,s50,1
s_lshl_b32 s50,s50,2
s_add_u32 s50,s50,s40
s_lshl_b32 s52,s50,4
s_lshl_b32 s50,s54,7
s_add_u32 s50,s50,s52
s_mul_i32 s46,s50,5120
s_add_u32 s46,s46,16777216
s_and_b32 s69,s54,0
s_mul_i32 s50,s69,40960
s_sub_u32 s68,s46,s50
s_add_u32 s46,s46,s50
s_lshl_b32 s69,s69,16
s_lshl_b32 s53,s55,13
s_lshl_b32 s50,s52,5
s_add_u32 s53,s53,s50
s_add_u32 s53,s53,25427968
v_lshlrev_b32 v243,4,v242
v_accvgpr_write_b32 a0,0
v_accvgpr_write_b32 a1,0
v_accvgpr_write_b32 a2,0
v_accvgpr_write_b32 a3,0
v_accvgpr_write_b32 a4,0
v_accvgpr_write_b32 a5,0
v_accvgpr_write_b32 a6,0
v_accvgpr_write_b32 a7,0
v_accvgpr_write_b32 a8,0
v_accvgpr_write_b32 a9,0
v_accvgpr_write_b32 a10,0
v_accvgpr_write_b32 a11,0
v_accvgpr_write_b32 a12,0
v_accvgpr_write_b32 a13,0
v_accvgpr_write_b32 a14,0
v_accvgpr_write_b32 a15,0
v_accvgpr_write_b32 a16,0
v_accvgpr_write_b32 a17,0
v_accvgpr_write_b32 a18,0
v_accvgpr_write_b32 a19,0
v_accvgpr_write_b32 a20,0
v_accvgpr_write_b32 a21,0
v_accvgpr_write_b32 a22,0
v_accvgpr_write_b32 a23,0
v_accvgpr_write_b32 a24,0
v_accvgpr_write_b32 a25,0
v_accvgpr_write_b32 a26,0
v_accvgpr_write_b32 a27,0
v_accvgpr_write_b32 a28,0
v_accvgpr_write_b32 a29,0
v_accvgpr_write_b32 a30,0
v_accvgpr_write_b32 a31,0
v_accvgpr_write_b32 a32,0
v_accvgpr_write_b32 a33,0
v_accvgpr_write_b32 a34,0
v_accvgpr_write_b32 a35,0
v_accvgpr_write_b32 a36,0
v_accvgpr_write_b32 a37,0
v_accvgpr_write_b32 a38,0
v_accvgpr_write_b32 a39,0
v_accvgpr_write_b32 a40,0
v_accvgpr_write_b32 a41,0
v_accvgpr_write_b32 a42,0
v_accvgpr_write_b32 a43,0
v_accvgpr_write_b32 a44,0
v_accvgpr_write_b32 a45,0
v_accvgpr_write_b32 a46,0
v_accvgpr_write_b32 a47,0
v_accvgpr_write_b32 a48,0
v_accvgpr_write_b32 a49,0
v_accvgpr_write_b32 a50,0
v_accvgpr_write_b32 a51,0
v_accvgpr_write_b32 a52,0
v_accvgpr_write_b32 a53,0
v_accvgpr_write_b32 a54,0
v_accvgpr_write_b32 a55,0
v_accvgpr_write_b32 a56,0
v_accvgpr_write_b32 a57,0
v_accvgpr_write_b32 a58,0
v_accvgpr_write_b32 a59,0
v_accvgpr_write_b32 a60,0
v_accvgpr_write_b32 a61,0
v_accvgpr_write_b32 a62,0
v_accvgpr_write_b32 a63,0
v_accvgpr_write_b32 a64,0
v_accvgpr_write_b32 a65,0
v_accvgpr_write_b32 a66,0
v_accvgpr_write_b32 a67,0
v_accvgpr_write_b32 a68,0
v_accvgpr_write_b32 a69,0
v_accvgpr_write_b32 a70,0
v_accvgpr_write_b32 a71,0
v_accvgpr_write_b32 a72,0
v_accvgpr_write_b32 a73,0
v_accvgpr_write_b32 a74,0
v_accvgpr_write_b32 a75,0
v_accvgpr_write_b32 a76,0
v_accvgpr_write_b32 a77,0
v_accvgpr_write_b32 a78,0
v_accvgpr_write_b32 a79,0
v_accvgpr_write_b32 a80,0
v_accvgpr_write_b32 a81,0
v_accvgpr_write_b32 a82,0
v_accvgpr_write_b32 a83,0
v_accvgpr_write_b32 a84,0
v_accvgpr_write_b32 a85,0
v_accvgpr_write_b32 a86,0
v_accvgpr_write_b32 a87,0
v_accvgpr_write_b32 a88,0
v_accvgpr_write_b32 a89,0
v_accvgpr_write_b32 a90,0
v_accvgpr_write_b32 a91,0
v_accvgpr_write_b32 a92,0
v_accvgpr_write_b32 a93,0
v_accvgpr_write_b32 a94,0
v_accvgpr_write_b32 a95,0
v_accvgpr_write_b32 a96,0
v_accvgpr_write_b32 a97,0
v_accvgpr_write_b32 a98,0
v_accvgpr_write_b32 a99,0
v_accvgpr_write_b32 a100,0
v_accvgpr_write_b32 a101,0
v_accvgpr_write_b32 a102,0
v_accvgpr_write_b32 a103,0
v_accvgpr_write_b32 a104,0
v_accvgpr_write_b32 a105,0
v_accvgpr_write_b32 a106,0
v_accvgpr_write_b32 a107,0
v_accvgpr_write_b32 a108,0
v_accvgpr_write_b32 a109,0
v_accvgpr_write_b32 a110,0
v_accvgpr_write_b32 a111,0
v_accvgpr_write_b32 a112,0
v_accvgpr_write_b32 a113,0
v_accvgpr_write_b32 a114,0
v_accvgpr_write_b32 a115,0
v_accvgpr_write_b32 a116,0
v_accvgpr_write_b32 a117,0
v_accvgpr_write_b32 a118,0
v_accvgpr_write_b32 a119,0
v_accvgpr_write_b32 a120,0
v_accvgpr_write_b32 a121,0
v_accvgpr_write_b32 a122,0
v_accvgpr_write_b32 a123,0
v_accvgpr_write_b32 a124,0
v_accvgpr_write_b32 a125,0
v_accvgpr_write_b32 a126,0
v_accvgpr_write_b32 a127,0
v_mov_b32 v212,0
v_mov_b32 v192,0
v_mov_b32 v193,0
v_mov_b32 v194,0
v_mov_b32 v195,0
v_mov_b32 v213,0
v_mov_b32 v196,0
v_mov_b32 v197,0
v_mov_b32 v198,0
v_mov_b32 v199,0
v_mov_b32 v214,0
v_mov_b32 v200,0
v_mov_b32 v201,0
v_mov_b32 v202,0
v_mov_b32 v203,0
v_mov_b32 v215,0
v_mov_b32 v204,0
v_mov_b32 v205,0
v_mov_b32 v206,0
v_mov_b32 v207,0
v_mov_b32 v219,0xff800000
s_mov_b32 s65,32
L_exact_loop:
s_add_u32 m0,s48,0
s_nop 0
buffer_load_dwordx4 v236,s[12:15],s43 offen offset:0 nt lds
buffer_load_dwordx4 v237,s[12:15],s43 offen offset:1024 nt lds
buffer_load_dwordx4 v238,s[12:15],s43 offen offset:2048 nt lds
buffer_load_dwordx4 v239,s[12:15],s43 offen offset:3072 nt lds
s_add_u32 s43,s43,16384
s_add_u32 m0,s48,65536
s_nop 0
buffer_load_dwordx4 v240,s[16:19],s44 offen offset:0 nt lds
buffer_load_dwordx4 v241,s[16:19],s44 offen offset:1024 nt lds
buffer_load_dwordx4 v240,s[16:19],s44 offen offset:2048 nt lds
buffer_load_dwordx4 v241,s[16:19],s44 offen offset:3072 nt lds
s_add_u32 s44,s44,16384
s_waitcnt vmcnt(0) lgkmcnt(0)
s_barrier
ds_read_b128 a[192:195],v224 offset:0
ds_read_b128 a[196:199],v225 offset:0
ds_read_b128 a[200:203],v226 offset:0
ds_read_b128 a[204:207],v227 offset:0
s_waitcnt lgkmcnt(0)
M v[0:3],a[192:195],a[128:131],v[192:195]
M v[0:3],a[196:199],a[144:147],v[0:3]
M v[0:3],a[200:203],a[160:163],v[0:3]
M v[0:3],a[204:207],a[176:179],v[0:3]
M v[16:19],a[204:207],a[180:183],v[196:199]
M v[16:19],a[200:203],a[164:167],v[16:19]
M v[16:19],a[196:199],a[148:151],v[16:19]
M v[16:19],a[192:195],a[132:135],v[16:19]
M v[32:35],a[192:195],a[136:139],v[200:203]
M v[32:35],a[196:199],a[152:155],v[32:35]
M v[32:35],a[200:203],a[168:171],v[32:35]
M v[32:35],a[204:207],a[184:187],v[32:35]
M v[48:51],a[204:207],a[188:191],v[204:207]
M v[48:51],a[200:203],a[172:175],v[48:51]
M v[48:51],a[196:199],a[156:159],v[48:51]
M v[48:51],a[192:195],a[140:143],v[48:51]
ds_read_b128 a[192:195],v224 offset:4096
ds_read_b128 a[196:199],v225 offset:4096
ds_read_b128 a[200:203],v226 offset:4096
ds_read_b128 a[204:207],v227 offset:4096
s_waitcnt lgkmcnt(0)
M v[4:7],a[192:195],a[128:131],v[192:195]
M v[4:7],a[196:199],a[144:147],v[4:7]
M v[4:7],a[200:203],a[160:163],v[4:7]
M v[4:7],a[204:207],a[176:179],v[4:7]
M v[20:23],a[204:207],a[180:183],v[196:199]
M v[20:23],a[200:203],a[164:167],v[20:23]
M v[20:23],a[196:199],a[148:151],v[20:23]
M v[20:23],a[192:195],a[132:135],v[20:23]
M v[36:39],a[192:195],a[136:139],v[200:203]
M v[36:39],a[196:199],a[152:155],v[36:39]
M v[36:39],a[200:203],a[168:171],v[36:39]
M v[36:39],a[204:207],a[184:187],v[36:39]
M v[52:55],a[204:207],a[188:191],v[204:207]
M v[52:55],a[200:203],a[172:175],v[52:55]
M v[52:55],a[196:199],a[156:159],v[52:55]
M v[52:55],a[192:195],a[140:143],v[52:55]
ds_read_b128 a[192:195],v224 offset:8192
ds_read_b128 a[196:199],v225 offset:8192
ds_read_b128 a[200:203],v226 offset:8192
ds_read_b128 a[204:207],v227 offset:8192
s_waitcnt lgkmcnt(0)
M v[8:11],a[192:195],a[128:131],v[192:195]
M v[8:11],a[196:199],a[144:147],v[8:11]
M v[8:11],a[200:203],a[160:163],v[8:11]
M v[8:11],a[204:207],a[176:179],v[8:11]
M v[24:27],a[204:207],a[180:183],v[196:199]
M v[24:27],a[200:203],a[164:167],v[24:27]
M v[24:27],a[196:199],a[148:151],v[24:27]
M v[24:27],a[192:195],a[132:135],v[24:27]
M v[40:43],a[192:195],a[136:139],v[200:203]
M v[40:43],a[196:199],a[152:155],v[40:43]
M v[40:43],a[200:203],a[168:171],v[40:43]
M v[40:43],a[204:207],a[184:187],v[40:43]
M v[56:59],a[204:207],a[188:191],v[204:207]
M v[56:59],a[200:203],a[172:175],v[56:59]
M v[56:59],a[196:199],a[156:159],v[56:59]
M v[56:59],a[192:195],a[140:143],v[56:59]
ds_read_b128 a[192:195],v224 offset:12288
ds_read_b128 a[196:199],v225 offset:12288
ds_read_b128 a[200:203],v226 offset:12288
ds_read_b128 a[204:207],v227 offset:12288
s_waitcnt lgkmcnt(0)
M v[12:15],a[192:195],a[128:131],v[192:195]
M v[12:15],a[196:199],a[144:147],v[12:15]
M v[12:15],a[200:203],a[160:163],v[12:15]
M v[12:15],a[204:207],a[176:179],v[12:15]
M v[28:31],a[204:207],a[180:183],v[196:199]
M v[28:31],a[200:203],a[164:167],v[28:31]
M v[28:31],a[196:199],a[148:151],v[28:31]
M v[28:31],a[192:195],a[132:135],v[28:31]
M v[44:47],a[192:195],a[136:139],v[200:203]
M v[44:47],a[196:199],a[152:155],v[44:47]
M v[44:47],a[200:203],a[168:171],v[44:47]
M v[44:47],a[204:207],a[184:187],v[44:47]
M v[60:63],a[204:207],a[188:191],v[204:207]
M v[60:63],a[200:203],a[172:175],v[60:63]
M v[60:63],a[196:199],a[156:159],v[60:63]
M v[60:63],a[192:195],a[140:143],v[60:63]
s_nop 7
s_nop 7
v_max3_f32 v216,v0,v1,v2
v_max3_f32 v216,v216,v3,v4
v_max3_f32 v216,v216,v5,v6
v_max3_f32 v216,v216,v7,v8
v_max3_f32 v216,v216,v9,v10
v_max3_f32 v216,v216,v11,v12
v_max3_f32 v216,v216,v13,v14
v_max3_f32 v216,v216,v15,v219
v_mov_b32 v218,v216
s_nop 1
v_permlane32_swap_b32 v216,v218
v_max_f32 v216,v216,v218
v_mov_b32 v218,v216
s_nop 1
v_permlane16_swap_b32 v216,v218
v_max_f32 v216,v216,v218
v_max_f32 v217,0,v216
v_exp_f32_e64 v217,-v217
v_sub_f32 v0,v0,v216
v_sub_f32 v1,v1,v216
v_sub_f32 v2,v2,v216
v_sub_f32 v3,v3,v216
v_sub_f32 v4,v4,v216
v_sub_f32 v5,v5,v216
v_sub_f32 v6,v6,v216
v_sub_f32 v7,v7,v216
v_sub_f32 v8,v8,v216
v_sub_f32 v9,v9,v216
v_sub_f32 v10,v10,v216
v_sub_f32 v11,v11,v216
v_sub_f32 v12,v12,v216
v_sub_f32 v13,v13,v216
v_sub_f32 v14,v14,v216
v_sub_f32 v15,v15,v216
v_sub_f32 v192,v192,v216
v_sub_f32 v193,v193,v216
v_sub_f32 v194,v194,v216
v_sub_f32 v195,v195,v216
v_mul_f32 v212,v212,v217
v_accvgpr_read_b32 v220,a0
v_accvgpr_read_b32 v221,a1
v_accvgpr_read_b32 v222,a2
v_accvgpr_read_b32 v223,a3
v_mul_f32 v220,v220,v217
v_mul_f32 v221,v221,v217
v_mul_f32 v222,v222,v217
v_mul_f32 v223,v223,v217
v_accvgpr_write_b32 a0,v220
v_accvgpr_write_b32 a1,v221
v_accvgpr_write_b32 a2,v222
v_accvgpr_write_b32 a3,v223
v_accvgpr_read_b32 v220,a16
v_accvgpr_read_b32 v221,a17
v_accvgpr_read_b32 v222,a18
v_accvgpr_read_b32 v223,a19
v_mul_f32 v220,v220,v217
v_mul_f32 v221,v221,v217
v_mul_f32 v222,v222,v217
v_mul_f32 v223,v223,v217
v_accvgpr_write_b32 a16,v220
v_accvgpr_write_b32 a17,v221
v_accvgpr_write_b32 a18,v222
v_accvgpr_write_b32 a19,v223
v_accvgpr_read_b32 v220,a32
v_accvgpr_read_b32 v221,a33
v_accvgpr_read_b32 v222,a34
v_accvgpr_read_b32 v223,a35
v_mul_f32 v220,v220,v217
v_mul_f32 v221,v221,v217
v_mul_f32 v222,v222,v217
v_mul_f32 v223,v223,v217
v_accvgpr_write_b32 a32,v220
v_accvgpr_write_b32 a33,v221
v_accvgpr_write_b32 a34,v222
v_accvgpr_write_b32 a35,v223
v_accvgpr_read_b32 v220,a48
v_accvgpr_read_b32 v221,a49
v_accvgpr_read_b32 v222,a50
v_accvgpr_read_b32 v223,a51
v_mul_f32 v220,v220,v217
v_mul_f32 v221,v221,v217
v_mul_f32 v222,v222,v217
v_mul_f32 v223,v223,v217
v_accvgpr_write_b32 a48,v220
v_accvgpr_write_b32 a49,v221
v_accvgpr_write_b32 a50,v222
v_accvgpr_write_b32 a51,v223
v_accvgpr_read_b32 v220,a64
v_accvgpr_read_b32 v221,a65
v_accvgpr_read_b32 v222,a66
v_accvgpr_read_b32 v223,a67
v_mul_f32 v220,v220,v217
v_mul_f32 v221,v221,v217
v_mul_f32 v222,v222,v217
v_mul_f32 v223,v223,v217
v_accvgpr_write_b32 a64,v220
v_accvgpr_write_b32 a65,v221
v_accvgpr_write_b32 a66,v222
v_accvgpr_write_b32 a67,v223
v_accvgpr_read_b32 v220,a80
v_accvgpr_read_b32 v221,a81
v_accvgpr_read_b32 v222,a82
v_accvgpr_read_b32 v223,a83
v_mul_f32 v220,v220,v217
v_mul_f32 v221,v221,v217
v_mul_f32 v222,v222,v217
v_mul_f32 v223,v223,v217
v_accvgpr_write_b32 a80,v220
v_accvgpr_write_b32 a81,v221
v_accvgpr_write_b32 a82,v222
v_accvgpr_write_b32 a83,v223
v_accvgpr_read_b32 v220,a96
v_accvgpr_read_b32 v221,a97
v_accvgpr_read_b32 v222,a98
v_accvgpr_read_b32 v223,a99
v_mul_f32 v220,v220,v217
v_mul_f32 v221,v221,v217
v_mul_f32 v222,v222,v217
v_mul_f32 v223,v223,v217
v_accvgpr_write_b32 a96,v220
v_accvgpr_write_b32 a97,v221
v_accvgpr_write_b32 a98,v222
v_accvgpr_write_b32 a99,v223
v_accvgpr_read_b32 v220,a112
v_accvgpr_read_b32 v221,a113
v_accvgpr_read_b32 v222,a114
v_accvgpr_read_b32 v223,a115
v_mul_f32 v220,v220,v217
v_mul_f32 v221,v221,v217
v_mul_f32 v222,v222,v217
v_mul_f32 v223,v223,v217
v_accvgpr_write_b32 a112,v220
v_accvgpr_write_b32 a113,v221
v_accvgpr_write_b32 a114,v222
v_accvgpr_write_b32 a115,v223
v_exp_f32 v0,v0
v_exp_f32 v1,v1
v_exp_f32 v2,v2
v_exp_f32 v3,v3
v_exp_f32 v4,v4
v_exp_f32 v5,v5
v_exp_f32 v6,v6
v_exp_f32 v7,v7
v_exp_f32 v8,v8
v_exp_f32 v9,v9
v_exp_f32 v10,v10
v_exp_f32 v11,v11
v_exp_f32 v12,v12
v_exp_f32 v13,v13
v_exp_f32 v14,v14
v_exp_f32 v15,v15
s_nop 0
v_add_f32 v212,v212,v0
v_add_f32 v212,v212,v1
v_add_f32 v212,v212,v2
v_add_f32 v212,v212,v3
v_add_f32 v212,v212,v4
v_add_f32 v212,v212,v5
v_add_f32 v212,v212,v6
v_add_f32 v212,v212,v7
v_add_f32 v212,v212,v8
v_add_f32 v212,v212,v9
v_add_f32 v212,v212,v10
v_add_f32 v212,v212,v11
v_add_f32 v212,v212,v12
v_add_f32 v212,v212,v13
v_add_f32 v212,v212,v14
v_add_f32 v212,v212,v15
v_cvt_pk_bf16_f32 v128,v0,v1
v_cvt_pk_bf16_f32 v129,v2,v3
v_cvt_pk_bf16_f32 v130,v4,v5
v_cvt_pk_bf16_f32 v131,v6,v7
v_cvt_pk_bf16_f32 v132,v8,v9
v_cvt_pk_bf16_f32 v133,v10,v11
v_cvt_pk_bf16_f32 v134,v12,v13
v_cvt_pk_bf16_f32 v135,v14,v15
v_max3_f32 v216,v16,v17,v18
v_max3_f32 v216,v216,v19,v20
v_max3_f32 v216,v216,v21,v22
v_max3_f32 v216,v216,v23,v24
v_max3_f32 v216,v216,v25,v26
v_max3_f32 v216,v216,v27,v28
v_max3_f32 v216,v216,v29,v30
v_max3_f32 v216,v216,v31,v219
v_mov_b32 v218,v216
s_nop 1
v_permlane32_swap_b32 v216,v218
v_max_f32 v216,v216,v218
v_mov_b32 v218,v216
s_nop 1
v_permlane16_swap_b32 v216,v218
v_max_f32 v216,v216,v218
v_max_f32 v217,0,v216
v_exp_f32_e64 v217,-v217
v_sub_f32 v16,v16,v216
v_sub_f32 v17,v17,v216
v_sub_f32 v18,v18,v216
v_sub_f32 v19,v19,v216
v_sub_f32 v20,v20,v216
v_sub_f32 v21,v21,v216
v_sub_f32 v22,v22,v216
v_sub_f32 v23,v23,v216
v_sub_f32 v24,v24,v216
v_sub_f32 v25,v25,v216
v_sub_f32 v26,v26,v216
v_sub_f32 v27,v27,v216
v_sub_f32 v28,v28,v216
v_sub_f32 v29,v29,v216
v_sub_f32 v30,v30,v216
v_sub_f32 v31,v31,v216
v_sub_f32 v196,v196,v216
v_sub_f32 v197,v197,v216
v_sub_f32 v198,v198,v216
v_sub_f32 v199,v199,v216
v_mul_f32 v213,v213,v217
v_accvgpr_read_b32 v220,a4
v_accvgpr_read_b32 v221,a5
v_accvgpr_read_b32 v222,a6
v_accvgpr_read_b32 v223,a7
v_mul_f32 v220,v220,v217
v_mul_f32 v221,v221,v217
v_mul_f32 v222,v222,v217
v_mul_f32 v223,v223,v217
v_accvgpr_write_b32 a4,v220
v_accvgpr_write_b32 a5,v221
v_accvgpr_write_b32 a6,v222
v_accvgpr_write_b32 a7,v223
v_accvgpr_read_b32 v220,a20
v_accvgpr_read_b32 v221,a21
v_accvgpr_read_b32 v222,a22
v_accvgpr_read_b32 v223,a23
v_mul_f32 v220,v220,v217
v_mul_f32 v221,v221,v217
v_mul_f32 v222,v222,v217
v_mul_f32 v223,v223,v217
v_accvgpr_write_b32 a20,v220
v_accvgpr_write_b32 a21,v221
v_accvgpr_write_b32 a22,v222
v_accvgpr_write_b32 a23,v223
v_accvgpr_read_b32 v220,a36
v_accvgpr_read_b32 v221,a37
v_accvgpr_read_b32 v222,a38
v_accvgpr_read_b32 v223,a39
v_mul_f32 v220,v220,v217
v_mul_f32 v221,v221,v217
v_mul_f32 v222,v222,v217
v_mul_f32 v223,v223,v217
v_accvgpr_write_b32 a36,v220
v_accvgpr_write_b32 a37,v221
v_accvgpr_write_b32 a38,v222
v_accvgpr_write_b32 a39,v223
v_accvgpr_read_b32 v220,a52
v_accvgpr_read_b32 v221,a53
v_accvgpr_read_b32 v222,a54
v_accvgpr_read_b32 v223,a55
v_mul_f32 v220,v220,v217
v_mul_f32 v221,v221,v217
v_mul_f32 v222,v222,v217
v_mul_f32 v223,v223,v217
v_accvgpr_write_b32 a52,v220
v_accvgpr_write_b32 a53,v221
v_accvgpr_write_b32 a54,v222
v_accvgpr_write_b32 a55,v223
v_accvgpr_read_b32 v220,a68
v_accvgpr_read_b32 v221,a69
v_accvgpr_read_b32 v222,a70
v_accvgpr_read_b32 v223,a71
v_mul_f32 v220,v220,v217
v_mul_f32 v221,v221,v217
v_mul_f32 v222,v222,v217
v_mul_f32 v223,v223,v217
v_accvgpr_write_b32 a68,v220
v_accvgpr_write_b32 a69,v221
v_accvgpr_write_b32 a70,v222
v_accvgpr_write_b32 a71,v223
v_accvgpr_read_b32 v220,a84
v_accvgpr_read_b32 v221,a85
v_accvgpr_read_b32 v222,a86
v_accvgpr_read_b32 v223,a87
v_mul_f32 v220,v220,v217
v_mul_f32 v221,v221,v217
v_mul_f32 v222,v222,v217
v_mul_f32 v223,v223,v217
v_accvgpr_write_b32 a84,v220
v_accvgpr_write_b32 a85,v221
v_accvgpr_write_b32 a86,v222
v_accvgpr_write_b32 a87,v223
v_accvgpr_read_b32 v220,a100
v_accvgpr_read_b32 v221,a101
v_accvgpr_read_b32 v222,a102
v_accvgpr_read_b32 v223,a103
v_mul_f32 v220,v220,v217
v_mul_f32 v221,v221,v217
v_mul_f32 v222,v222,v217
v_mul_f32 v223,v223,v217
v_accvgpr_write_b32 a100,v220
v_accvgpr_write_b32 a101,v221
v_accvgpr_write_b32 a102,v222
v_accvgpr_write_b32 a103,v223
v_accvgpr_read_b32 v220,a116
v_accvgpr_read_b32 v221,a117
v_accvgpr_read_b32 v222,a118
v_accvgpr_read_b32 v223,a119
v_mul_f32 v220,v220,v217
v_mul_f32 v221,v221,v217
v_mul_f32 v222,v222,v217
v_mul_f32 v223,v223,v217
v_accvgpr_write_b32 a116,v220
v_accvgpr_write_b32 a117,v221
v_accvgpr_write_b32 a118,v222
v_accvgpr_write_b32 a119,v223
v_exp_f32 v16,v16
v_exp_f32 v17,v17
v_exp_f32 v18,v18
v_exp_f32 v19,v19
v_exp_f32 v20,v20
v_exp_f32 v21,v21
v_exp_f32 v22,v22
v_exp_f32 v23,v23
v_exp_f32 v24,v24
v_exp_f32 v25,v25
v_exp_f32 v26,v26
v_exp_f32 v27,v27
v_exp_f32 v28,v28
v_exp_f32 v29,v29
v_exp_f32 v30,v30
v_exp_f32 v31,v31
s_nop 0
v_add_f32 v213,v213,v16
v_add_f32 v213,v213,v17
v_add_f32 v213,v213,v18
v_add_f32 v213,v213,v19
v_add_f32 v213,v213,v20
v_add_f32 v213,v213,v21
v_add_f32 v213,v213,v22
v_add_f32 v213,v213,v23
v_add_f32 v213,v213,v24
v_add_f32 v213,v213,v25
v_add_f32 v213,v213,v26
v_add_f32 v213,v213,v27
v_add_f32 v213,v213,v28
v_add_f32 v213,v213,v29
v_add_f32 v213,v213,v30
v_add_f32 v213,v213,v31
v_cvt_pk_bf16_f32 v136,v16,v17
v_cvt_pk_bf16_f32 v137,v18,v19
v_cvt_pk_bf16_f32 v138,v20,v21
v_cvt_pk_bf16_f32 v139,v22,v23
v_cvt_pk_bf16_f32 v140,v24,v25
v_cvt_pk_bf16_f32 v141,v26,v27
v_cvt_pk_bf16_f32 v142,v28,v29
v_cvt_pk_bf16_f32 v143,v30,v31
v_max3_f32 v216,v32,v33,v34
v_max3_f32 v216,v216,v35,v36
v_max3_f32 v216,v216,v37,v38
v_max3_f32 v216,v216,v39,v40
v_max3_f32 v216,v216,v41,v42
v_max3_f32 v216,v216,v43,v44
v_max3_f32 v216,v216,v45,v46
v_max3_f32 v216,v216,v47,v219
v_mov_b32 v218,v216
s_nop 1
v_permlane32_swap_b32 v216,v218
v_max_f32 v216,v216,v218
v_mov_b32 v218,v216
s_nop 1
v_permlane16_swap_b32 v216,v218
v_max_f32 v216,v216,v218
v_max_f32 v217,0,v216
v_exp_f32_e64 v217,-v217
v_sub_f32 v32,v32,v216
v_sub_f32 v33,v33,v216
v_sub_f32 v34,v34,v216
v_sub_f32 v35,v35,v216
v_sub_f32 v36,v36,v216
v_sub_f32 v37,v37,v216
v_sub_f32 v38,v38,v216
v_sub_f32 v39,v39,v216
v_sub_f32 v40,v40,v216
v_sub_f32 v41,v41,v216
v_sub_f32 v42,v42,v216
v_sub_f32 v43,v43,v216
v_sub_f32 v44,v44,v216
v_sub_f32 v45,v45,v216
v_sub_f32 v46,v46,v216
v_sub_f32 v47,v47,v216
v_sub_f32 v200,v200,v216
v_sub_f32 v201,v201,v216
v_sub_f32 v202,v202,v216
v_sub_f32 v203,v203,v216
v_mul_f32 v214,v214,v217
v_accvgpr_read_b32 v220,a8
v_accvgpr_read_b32 v221,a9
v_accvgpr_read_b32 v222,a10
v_accvgpr_read_b32 v223,a11
v_mul_f32 v220,v220,v217
v_mul_f32 v221,v221,v217
v_mul_f32 v222,v222,v217
v_mul_f32 v223,v223,v217
v_accvgpr_write_b32 a8,v220
v_accvgpr_write_b32 a9,v221
v_accvgpr_write_b32 a10,v222
v_accvgpr_write_b32 a11,v223
v_accvgpr_read_b32 v220,a24
v_accvgpr_read_b32 v221,a25
v_accvgpr_read_b32 v222,a26
v_accvgpr_read_b32 v223,a27
v_mul_f32 v220,v220,v217
v_mul_f32 v221,v221,v217
v_mul_f32 v222,v222,v217
v_mul_f32 v223,v223,v217
v_accvgpr_write_b32 a24,v220
v_accvgpr_write_b32 a25,v221
v_accvgpr_write_b32 a26,v222
v_accvgpr_write_b32 a27,v223
v_accvgpr_read_b32 v220,a40
v_accvgpr_read_b32 v221,a41
v_accvgpr_read_b32 v222,a42
v_accvgpr_read_b32 v223,a43
v_mul_f32 v220,v220,v217
v_mul_f32 v221,v221,v217
v_mul_f32 v222,v222,v217
v_mul_f32 v223,v223,v217
v_accvgpr_write_b32 a40,v220
v_accvgpr_write_b32 a41,v221
v_accvgpr_write_b32 a42,v222
v_accvgpr_write_b32 a43,v223
v_accvgpr_read_b32 v220,a56
v_accvgpr_read_b32 v221,a57
v_accvgpr_read_b32 v222,a58
v_accvgpr_read_b32 v223,a59
v_mul_f32 v220,v220,v217
v_mul_f32 v221,v221,v217
v_mul_f32 v222,v222,v217
v_mul_f32 v223,v223,v217
v_accvgpr_write_b32 a56,v220
v_accvgpr_write_b32 a57,v221
v_accvgpr_write_b32 a58,v222
v_accvgpr_write_b32 a59,v223
v_accvgpr_read_b32 v220,a72
v_accvgpr_read_b32 v221,a73
v_accvgpr_read_b32 v222,a74
v_accvgpr_read_b32 v223,a75
v_mul_f32 v220,v220,v217
v_mul_f32 v221,v221,v217
v_mul_f32 v222,v222,v217
v_mul_f32 v223,v223,v217
v_accvgpr_write_b32 a72,v220
v_accvgpr_write_b32 a73,v221
v_accvgpr_write_b32 a74,v222
v_accvgpr_write_b32 a75,v223
v_accvgpr_read_b32 v220,a88
v_accvgpr_read_b32 v221,a89
v_accvgpr_read_b32 v222,a90
v_accvgpr_read_b32 v223,a91
v_mul_f32 v220,v220,v217
v_mul_f32 v221,v221,v217
v_mul_f32 v222,v222,v217
v_mul_f32 v223,v223,v217
v_accvgpr_write_b32 a88,v220
v_accvgpr_write_b32 a89,v221
v_accvgpr_write_b32 a90,v222
v_accvgpr_write_b32 a91,v223
v_accvgpr_read_b32 v220,a104
v_accvgpr_read_b32 v221,a105
v_accvgpr_read_b32 v222,a106
v_accvgpr_read_b32 v223,a107
v_mul_f32 v220,v220,v217
v_mul_f32 v221,v221,v217
v_mul_f32 v222,v222,v217
v_mul_f32 v223,v223,v217
v_accvgpr_write_b32 a104,v220
v_accvgpr_write_b32 a105,v221
v_accvgpr_write_b32 a106,v222
v_accvgpr_write_b32 a107,v223
v_accvgpr_read_b32 v220,a120
v_accvgpr_read_b32 v221,a121
v_accvgpr_read_b32 v222,a122
v_accvgpr_read_b32 v223,a123
v_mul_f32 v220,v220,v217
v_mul_f32 v221,v221,v217
v_mul_f32 v222,v222,v217
v_mul_f32 v223,v223,v217
v_accvgpr_write_b32 a120,v220
v_accvgpr_write_b32 a121,v221
v_accvgpr_write_b32 a122,v222
v_accvgpr_write_b32 a123,v223
v_exp_f32 v32,v32
v_exp_f32 v33,v33
v_exp_f32 v34,v34
v_exp_f32 v35,v35
v_exp_f32 v36,v36
v_exp_f32 v37,v37
v_exp_f32 v38,v38
v_exp_f32 v39,v39
v_exp_f32 v40,v40
v_exp_f32 v41,v41
v_exp_f32 v42,v42
v_exp_f32 v43,v43
v_exp_f32 v44,v44
v_exp_f32 v45,v45
v_exp_f32 v46,v46
v_exp_f32 v47,v47
s_nop 0
v_add_f32 v214,v214,v32
v_add_f32 v214,v214,v33
v_add_f32 v214,v214,v34
v_add_f32 v214,v214,v35
v_add_f32 v214,v214,v36
v_add_f32 v214,v214,v37
v_add_f32 v214,v214,v38
v_add_f32 v214,v214,v39
v_add_f32 v214,v214,v40
v_add_f32 v214,v214,v41
v_add_f32 v214,v214,v42
v_add_f32 v214,v214,v43
v_add_f32 v214,v214,v44
v_add_f32 v214,v214,v45
v_add_f32 v214,v214,v46
v_add_f32 v214,v214,v47
v_cvt_pk_bf16_f32 v144,v32,v33
v_cvt_pk_bf16_f32 v145,v34,v35
v_cvt_pk_bf16_f32 v146,v36,v37
v_cvt_pk_bf16_f32 v147,v38,v39
v_cvt_pk_bf16_f32 v148,v40,v41
v_cvt_pk_bf16_f32 v149,v42,v43
v_cvt_pk_bf16_f32 v150,v44,v45
v_cvt_pk_bf16_f32 v151,v46,v47
v_max3_f32 v216,v48,v49,v50
v_max3_f32 v216,v216,v51,v52
v_max3_f32 v216,v216,v53,v54
v_max3_f32 v216,v216,v55,v56
v_max3_f32 v216,v216,v57,v58
v_max3_f32 v216,v216,v59,v60
v_max3_f32 v216,v216,v61,v62
v_max3_f32 v216,v216,v63,v219
v_mov_b32 v218,v216
s_nop 1
v_permlane32_swap_b32 v216,v218
v_max_f32 v216,v216,v218
v_mov_b32 v218,v216
s_nop 1
v_permlane16_swap_b32 v216,v218
v_max_f32 v216,v216,v218
v_max_f32 v217,0,v216
v_exp_f32_e64 v217,-v217
v_sub_f32 v48,v48,v216
v_sub_f32 v49,v49,v216
v_sub_f32 v50,v50,v216
v_sub_f32 v51,v51,v216
v_sub_f32 v52,v52,v216
v_sub_f32 v53,v53,v216
v_sub_f32 v54,v54,v216
v_sub_f32 v55,v55,v216
v_sub_f32 v56,v56,v216
v_sub_f32 v57,v57,v216
v_sub_f32 v58,v58,v216
v_sub_f32 v59,v59,v216
v_sub_f32 v60,v60,v216
v_sub_f32 v61,v61,v216
v_sub_f32 v62,v62,v216
v_sub_f32 v63,v63,v216
v_sub_f32 v204,v204,v216
v_sub_f32 v205,v205,v216
v_sub_f32 v206,v206,v216
v_sub_f32 v207,v207,v216
v_mul_f32 v215,v215,v217
v_accvgpr_read_b32 v220,a12
v_accvgpr_read_b32 v221,a13
v_accvgpr_read_b32 v222,a14
v_accvgpr_read_b32 v223,a15
v_mul_f32 v220,v220,v217
v_mul_f32 v221,v221,v217
v_mul_f32 v222,v222,v217
v_mul_f32 v223,v223,v217
v_accvgpr_write_b32 a12,v220
v_accvgpr_write_b32 a13,v221
v_accvgpr_write_b32 a14,v222
v_accvgpr_write_b32 a15,v223
v_accvgpr_read_b32 v220,a28
v_accvgpr_read_b32 v221,a29
v_accvgpr_read_b32 v222,a30
v_accvgpr_read_b32 v223,a31
v_mul_f32 v220,v220,v217
v_mul_f32 v221,v221,v217
v_mul_f32 v222,v222,v217
v_mul_f32 v223,v223,v217
v_accvgpr_write_b32 a28,v220
v_accvgpr_write_b32 a29,v221
v_accvgpr_write_b32 a30,v222
v_accvgpr_write_b32 a31,v223
v_accvgpr_read_b32 v220,a44
v_accvgpr_read_b32 v221,a45
v_accvgpr_read_b32 v222,a46
v_accvgpr_read_b32 v223,a47
v_mul_f32 v220,v220,v217
v_mul_f32 v221,v221,v217
v_mul_f32 v222,v222,v217
v_mul_f32 v223,v223,v217
v_accvgpr_write_b32 a44,v220
v_accvgpr_write_b32 a45,v221
v_accvgpr_write_b32 a46,v222
v_accvgpr_write_b32 a47,v223
v_accvgpr_read_b32 v220,a60
v_accvgpr_read_b32 v221,a61
v_accvgpr_read_b32 v222,a62
v_accvgpr_read_b32 v223,a63
v_mul_f32 v220,v220,v217
v_mul_f32 v221,v221,v217
v_mul_f32 v222,v222,v217
v_mul_f32 v223,v223,v217
v_accvgpr_write_b32 a60,v220
v_accvgpr_write_b32 a61,v221
v_accvgpr_write_b32 a62,v222
v_accvgpr_write_b32 a63,v223
v_accvgpr_read_b32 v220,a76
v_accvgpr_read_b32 v221,a77
v_accvgpr_read_b32 v222,a78
v_accvgpr_read_b32 v223,a79
v_mul_f32 v220,v220,v217
v_mul_f32 v221,v221,v217
v_mul_f32 v222,v222,v217
v_mul_f32 v223,v223,v217
v_accvgpr_write_b32 a76,v220
v_accvgpr_write_b32 a77,v221
v_accvgpr_write_b32 a78,v222
v_accvgpr_write_b32 a79,v223
v_accvgpr_read_b32 v220,a92
v_accvgpr_read_b32 v221,a93
v_accvgpr_read_b32 v222,a94
v_accvgpr_read_b32 v223,a95
v_mul_f32 v220,v220,v217
v_mul_f32 v221,v221,v217
v_mul_f32 v222,v222,v217
v_mul_f32 v223,v223,v217
v_accvgpr_write_b32 a92,v220
v_accvgpr_write_b32 a93,v221
v_accvgpr_write_b32 a94,v222
v_accvgpr_write_b32 a95,v223
v_accvgpr_read_b32 v220,a108
v_accvgpr_read_b32 v221,a109
v_accvgpr_read_b32 v222,a110
v_accvgpr_read_b32 v223,a111
v_mul_f32 v220,v220,v217
v_mul_f32 v221,v221,v217
v_mul_f32 v222,v222,v217
v_mul_f32 v223,v223,v217
v_accvgpr_write_b32 a108,v220
v_accvgpr_write_b32 a109,v221
v_accvgpr_write_b32 a110,v222
v_accvgpr_write_b32 a111,v223
v_accvgpr_read_b32 v220,a124
v_accvgpr_read_b32 v221,a125
v_accvgpr_read_b32 v222,a126
v_accvgpr_read_b32 v223,a127
v_mul_f32 v220,v220,v217
v_mul_f32 v221,v221,v217
v_mul_f32 v222,v222,v217
v_mul_f32 v223,v223,v217
v_accvgpr_write_b32 a124,v220
v_accvgpr_write_b32 a125,v221
v_accvgpr_write_b32 a126,v222
v_accvgpr_write_b32 a127,v223
v_exp_f32 v48,v48
v_exp_f32 v49,v49
v_exp_f32 v50,v50
v_exp_f32 v51,v51
v_exp_f32 v52,v52
v_exp_f32 v53,v53
v_exp_f32 v54,v54
v_exp_f32 v55,v55
v_exp_f32 v56,v56
v_exp_f32 v57,v57
v_exp_f32 v58,v58
v_exp_f32 v59,v59
v_exp_f32 v60,v60
v_exp_f32 v61,v61
v_exp_f32 v62,v62
v_exp_f32 v63,v63
s_nop 0
v_add_f32 v215,v215,v48
v_add_f32 v215,v215,v49
v_add_f32 v215,v215,v50
v_add_f32 v215,v215,v51
v_add_f32 v215,v215,v52
v_add_f32 v215,v215,v53
v_add_f32 v215,v215,v54
v_add_f32 v215,v215,v55
v_add_f32 v215,v215,v56
v_add_f32 v215,v215,v57
v_add_f32 v215,v215,v58
v_add_f32 v215,v215,v59
v_add_f32 v215,v215,v60
v_add_f32 v215,v215,v61
v_add_f32 v215,v215,v62
v_add_f32 v215,v215,v63
v_cvt_pk_bf16_f32 v152,v48,v49
v_cvt_pk_bf16_f32 v153,v50,v51
v_cvt_pk_bf16_f32 v154,v52,v53
v_cvt_pk_bf16_f32 v155,v54,v55
v_cvt_pk_bf16_f32 v156,v56,v57
v_cvt_pk_bf16_f32 v157,v58,v59
v_cvt_pk_bf16_f32 v158,v60,v61
v_cvt_pk_bf16_f32 v159,v62,v63
v_mov_b32 v219,0
ds_read_b64_tr_b16 a[208:209],v228 offset:0
ds_read_b64_tr_b16 a[210:211],v228 offset:4096
ds_read_b64_tr_b16 a[212:213],v228 offset:8192
ds_read_b64_tr_b16 a[214:215],v228 offset:12288
ds_read_b64_tr_b16 a[216:217],v229 offset:0
ds_read_b64_tr_b16 a[218:219],v229 offset:4096
ds_read_b64_tr_b16 a[220:221],v229 offset:8192
ds_read_b64_tr_b16 a[222:223],v229 offset:12288
s_waitcnt lgkmcnt(0)
M a[0:3],a[208:211],v[128:131],a[0:3]
M a[0:3],a[212:215],v[132:135],a[0:3]
M a[4:7],a[212:215],v[140:143],a[4:7]
M a[4:7],a[208:211],v[136:139],a[4:7]
M a[8:11],a[208:211],v[144:147],a[8:11]
M a[8:11],a[212:215],v[148:151],a[8:11]
M a[12:15],a[212:215],v[156:159],a[12:15]
M a[12:15],a[208:211],v[152:155],a[12:15]
M a[28:31],a[216:219],v[152:155],a[28:31]
M a[28:31],a[220:223],v[156:159],a[28:31]
M a[24:27],a[220:223],v[148:151],a[24:27]
M a[24:27],a[216:219],v[144:147],a[24:27]
M a[20:23],a[216:219],v[136:139],a[20:23]
M a[20:23],a[220:223],v[140:143],a[20:23]
M a[16:19],a[220:223],v[132:135],a[16:19]
M a[16:19],a[216:219],v[128:131],a[16:19]
ds_read_b64_tr_b16 a[208:209],v230 offset:0
ds_read_b64_tr_b16 a[210:211],v230 offset:4096
ds_read_b64_tr_b16 a[212:213],v230 offset:8192
ds_read_b64_tr_b16 a[214:215],v230 offset:12288
ds_read_b64_tr_b16 a[216:217],v231 offset:0
ds_read_b64_tr_b16 a[218:219],v231 offset:4096
ds_read_b64_tr_b16 a[220:221],v231 offset:8192
ds_read_b64_tr_b16 a[222:223],v231 offset:12288
s_waitcnt lgkmcnt(0)
M a[32:35],a[208:211],v[128:131],a[32:35]
M a[32:35],a[212:215],v[132:135],a[32:35]
M a[36:39],a[212:215],v[140:143],a[36:39]
M a[36:39],a[208:211],v[136:139],a[36:39]
M a[40:43],a[208:211],v[144:147],a[40:43]
M a[40:43],a[212:215],v[148:151],a[40:43]
M a[44:47],a[212:215],v[156:159],a[44:47]
M a[44:47],a[208:211],v[152:155],a[44:47]
M a[60:63],a[216:219],v[152:155],a[60:63]
M a[60:63],a[220:223],v[156:159],a[60:63]
M a[56:59],a[220:223],v[148:151],a[56:59]
M a[56:59],a[216:219],v[144:147],a[56:59]
M a[52:55],a[216:219],v[136:139],a[52:55]
M a[52:55],a[220:223],v[140:143],a[52:55]
M a[48:51],a[220:223],v[132:135],a[48:51]
M a[48:51],a[216:219],v[128:131],a[48:51]
ds_read_b64_tr_b16 a[208:209],v232 offset:0
ds_read_b64_tr_b16 a[210:211],v232 offset:4096
ds_read_b64_tr_b16 a[212:213],v232 offset:8192
ds_read_b64_tr_b16 a[214:215],v232 offset:12288
ds_read_b64_tr_b16 a[216:217],v233 offset:0
ds_read_b64_tr_b16 a[218:219],v233 offset:4096
ds_read_b64_tr_b16 a[220:221],v233 offset:8192
ds_read_b64_tr_b16 a[222:223],v233 offset:12288
s_waitcnt lgkmcnt(0)
M a[64:67],a[208:211],v[128:131],a[64:67]
M a[64:67],a[212:215],v[132:135],a[64:67]
M a[68:71],a[212:215],v[140:143],a[68:71]
M a[68:71],a[208:211],v[136:139],a[68:71]
M a[72:75],a[208:211],v[144:147],a[72:75]
M a[72:75],a[212:215],v[148:151],a[72:75]
M a[76:79],a[212:215],v[156:159],a[76:79]
M a[76:79],a[208:211],v[152:155],a[76:79]
M a[92:95],a[216:219],v[152:155],a[92:95]
M a[92:95],a[220:223],v[156:159],a[92:95]
M a[88:91],a[220:223],v[148:151],a[88:91]
M a[88:91],a[216:219],v[144:147],a[88:91]
M a[84:87],a[216:219],v[136:139],a[84:87]
M a[84:87],a[220:223],v[140:143],a[84:87]
M a[80:83],a[220:223],v[132:135],a[80:83]
M a[80:83],a[216:219],v[128:131],a[80:83]
ds_read_b64_tr_b16 a[208:209],v234 offset:0
ds_read_b64_tr_b16 a[210:211],v234 offset:4096
ds_read_b64_tr_b16 a[212:213],v234 offset:8192
ds_read_b64_tr_b16 a[214:215],v234 offset:12288
ds_read_b64_tr_b16 a[216:217],v235 offset:0
ds_read_b64_tr_b16 a[218:219],v235 offset:4096
ds_read_b64_tr_b16 a[220:221],v235 offset:8192
ds_read_b64_tr_b16 a[222:223],v235 offset:12288
s_waitcnt lgkmcnt(0)
M a[96:99],a[208:211],v[128:131],a[96:99]
M a[96:99],a[212:215],v[132:135],a[96:99]
M a[100:103],a[212:215],v[140:143],a[100:103]
M a[100:103],a[208:211],v[136:139],a[100:103]
M a[104:107],a[208:211],v[144:147],a[104:107]
M a[104:107],a[212:215],v[148:151],a[104:107]
M a[108:111],a[212:215],v[156:159],a[108:111]
M a[108:111],a[208:211],v[152:155],a[108:111]
M a[124:127],a[216:219],v[152:155],a[124:127]
M a[124:127],a[220:223],v[156:159],a[124:127]
M a[120:123],a[220:223],v[148:151],a[120:123]
M a[120:123],a[216:219],v[144:147],a[120:123]
M a[116:119],a[216:219],v[136:139],a[116:119]
M a[116:119],a[220:223],v[140:143],a[116:119]
M a[112:115],a[220:223],v[132:135],a[112:115]
M a[112:115],a[216:219],v[128:131],a[112:115]
s_barrier
s_sub_u32 s65,s65,1
s_cmp_lg_u32 s65,0
s_cbranch_scc1 L_exact_loop
v_mov_b32 v218,v212
s_nop 1
v_permlane32_swap_b32 v212,v218
v_add_f32 v212,v212,v218
v_mov_b32 v218,v212
s_nop 1
v_permlane16_swap_b32 v212,v218
v_add_f32 v212,v212,v218
v_rcp_f32 v192,v212
v_mov_b32 v218,v213
s_nop 1
v_permlane32_swap_b32 v213,v218
v_add_f32 v213,v213,v218
v_mov_b32 v218,v213
s_nop 1
v_permlane16_swap_b32 v213,v218
v_add_f32 v213,v213,v218
v_rcp_f32 v196,v213
v_mov_b32 v218,v214
s_nop 1
v_permlane32_swap_b32 v214,v218
v_add_f32 v214,v214,v218
v_mov_b32 v218,v214
s_nop 1
v_permlane16_swap_b32 v214,v218
v_add_f32 v214,v214,v218
v_rcp_f32 v200,v214
v_mov_b32 v218,v215
s_nop 1
v_permlane32_swap_b32 v215,v218
v_add_f32 v215,v215,v218
v_mov_b32 v218,v215
s_nop 1
v_permlane16_swap_b32 v215,v218
v_add_f32 v215,v215,v218
v_rcp_f32 v204,v215
s_nop 7
v_accvgpr_read_b32 v64,a0
v_accvgpr_read_b32 v65,a1
v_accvgpr_read_b32 v66,a2
v_accvgpr_read_b32 v67,a3
v_accvgpr_read_b32 v68,a16
v_accvgpr_read_b32 v69,a17
v_accvgpr_read_b32 v70,a18
v_accvgpr_read_b32 v71,a19
v_mul_f32 v64,v64,v192
v_mul_f32 v65,v65,v192
v_mul_f32 v66,v66,v192
v_mul_f32 v67,v67,v192
v_mul_f32 v68,v68,v192
v_mul_f32 v69,v69,v192
v_mul_f32 v70,v70,v192
v_mul_f32 v71,v71,v192
v_cvt_pk_bf16_f32 v96,v64,v65
v_cvt_pk_bf16_f32 v97,v66,v67
v_cvt_pk_bf16_f32 v98,v68,v69
v_cvt_pk_bf16_f32 v99,v70,v71
s_nop 0
buffer_store_dwordx4 v[96:99],v243,s[32:35],s49 offen offset:0 sc1
v_accvgpr_read_b32 v72,a4
v_accvgpr_read_b32 v73,a5
v_accvgpr_read_b32 v74,a6
v_accvgpr_read_b32 v75,a7
v_accvgpr_read_b32 v76,a20
v_accvgpr_read_b32 v77,a21
v_accvgpr_read_b32 v78,a22
v_accvgpr_read_b32 v79,a23
v_mul_f32 v72,v72,v196
v_mul_f32 v73,v73,v196
v_mul_f32 v74,v74,v196
v_mul_f32 v75,v75,v196
v_mul_f32 v76,v76,v196
v_mul_f32 v77,v77,v196
v_mul_f32 v78,v78,v196
v_mul_f32 v79,v79,v196
v_cvt_pk_bf16_f32 v100,v72,v73
v_cvt_pk_bf16_f32 v101,v74,v75
v_cvt_pk_bf16_f32 v102,v76,v77
v_cvt_pk_bf16_f32 v103,v78,v79
s_nop 0
buffer_store_dwordx4 v[100:103],v243,s[32:35],s49 offen offset:1024 sc1
v_accvgpr_read_b32 v80,a8
v_accvgpr_read_b32 v81,a9
v_accvgpr_read_b32 v82,a10
v_accvgpr_read_b32 v83,a11
v_accvgpr_read_b32 v84,a24
v_accvgpr_read_b32 v85,a25
v_accvgpr_read_b32 v86,a26
v_accvgpr_read_b32 v87,a27
v_mul_f32 v80,v80,v200
v_mul_f32 v81,v81,v200
v_mul_f32 v82,v82,v200
v_mul_f32 v83,v83,v200
v_mul_f32 v84,v84,v200
v_mul_f32 v85,v85,v200
v_mul_f32 v86,v86,v200
v_mul_f32 v87,v87,v200
v_cvt_pk_bf16_f32 v104,v80,v81
v_cvt_pk_bf16_f32 v105,v82,v83
v_cvt_pk_bf16_f32 v106,v84,v85
v_cvt_pk_bf16_f32 v107,v86,v87
s_nop 0
buffer_store_dwordx4 v[104:107],v243,s[32:35],s49 offen offset:2048 sc1
v_accvgpr_read_b32 v88,a12
v_accvgpr_read_b32 v89,a13
v_accvgpr_read_b32 v90,a14
v_accvgpr_read_b32 v91,a15
v_accvgpr_read_b32 v92,a28
v_accvgpr_read_b32 v93,a29
v_accvgpr_read_b32 v94,a30
v_accvgpr_read_b32 v95,a31
v_mul_f32 v88,v88,v204
v_mul_f32 v89,v89,v204
v_mul_f32 v90,v90,v204
v_mul_f32 v91,v91,v204
v_mul_f32 v92,v92,v204
v_mul_f32 v93,v93,v204
v_mul_f32 v94,v94,v204
v_mul_f32 v95,v95,v204
v_cvt_pk_bf16_f32 v108,v88,v89
v_cvt_pk_bf16_f32 v109,v90,v91
v_cvt_pk_bf16_f32 v110,v92,v93
v_cvt_pk_bf16_f32 v111,v94,v95
s_nop 0
buffer_store_dwordx4 v[108:111],v243,s[32:35],s49 offen offset:3072 sc1
s_add_u32 s49,s49,4096
v_accvgpr_read_b32 v64,a32
v_accvgpr_read_b32 v65,a33
v_accvgpr_read_b32 v66,a34
v_accvgpr_read_b32 v67,a35
v_accvgpr_read_b32 v68,a48
v_accvgpr_read_b32 v69,a49
v_accvgpr_read_b32 v70,a50
v_accvgpr_read_b32 v71,a51
v_mul_f32 v64,v64,v192
v_mul_f32 v65,v65,v192
v_mul_f32 v66,v66,v192
v_mul_f32 v67,v67,v192
v_mul_f32 v68,v68,v192
v_mul_f32 v69,v69,v192
v_mul_f32 v70,v70,v192
v_mul_f32 v71,v71,v192
v_cvt_pk_bf16_f32 v112,v64,v65
v_cvt_pk_bf16_f32 v113,v66,v67
v_cvt_pk_bf16_f32 v114,v68,v69
v_cvt_pk_bf16_f32 v115,v70,v71
s_nop 0
buffer_store_dwordx4 v[112:115],v243,s[32:35],s49 offen offset:0 sc1
v_accvgpr_read_b32 v72,a36
v_accvgpr_read_b32 v73,a37
v_accvgpr_read_b32 v74,a38
v_accvgpr_read_b32 v75,a39
v_accvgpr_read_b32 v76,a52
v_accvgpr_read_b32 v77,a53
v_accvgpr_read_b32 v78,a54
v_accvgpr_read_b32 v79,a55
v_mul_f32 v72,v72,v196
v_mul_f32 v73,v73,v196
v_mul_f32 v74,v74,v196
v_mul_f32 v75,v75,v196
v_mul_f32 v76,v76,v196
v_mul_f32 v77,v77,v196
v_mul_f32 v78,v78,v196
v_mul_f32 v79,v79,v196
v_cvt_pk_bf16_f32 v116,v72,v73
v_cvt_pk_bf16_f32 v117,v74,v75
v_cvt_pk_bf16_f32 v118,v76,v77
v_cvt_pk_bf16_f32 v119,v78,v79
s_nop 0
buffer_store_dwordx4 v[116:119],v243,s[32:35],s49 offen offset:1024 sc1
v_accvgpr_read_b32 v80,a40
v_accvgpr_read_b32 v81,a41
v_accvgpr_read_b32 v82,a42
v_accvgpr_read_b32 v83,a43
v_accvgpr_read_b32 v84,a56
v_accvgpr_read_b32 v85,a57
v_accvgpr_read_b32 v86,a58
v_accvgpr_read_b32 v87,a59
v_mul_f32 v80,v80,v200
v_mul_f32 v81,v81,v200
v_mul_f32 v82,v82,v200
v_mul_f32 v83,v83,v200
v_mul_f32 v84,v84,v200
v_mul_f32 v85,v85,v200
v_mul_f32 v86,v86,v200
v_mul_f32 v87,v87,v200
v_cvt_pk_bf16_f32 v120,v80,v81
v_cvt_pk_bf16_f32 v121,v82,v83
v_cvt_pk_bf16_f32 v122,v84,v85
v_cvt_pk_bf16_f32 v123,v86,v87
s_nop 0
buffer_store_dwordx4 v[120:123],v243,s[32:35],s49 offen offset:2048 sc1
v_accvgpr_read_b32 v88,a44
v_accvgpr_read_b32 v89,a45
v_accvgpr_read_b32 v90,a46
v_accvgpr_read_b32 v91,a47
v_accvgpr_read_b32 v92,a60
v_accvgpr_read_b32 v93,a61
v_accvgpr_read_b32 v94,a62
v_accvgpr_read_b32 v95,a63
v_mul_f32 v88,v88,v204
v_mul_f32 v89,v89,v204
v_mul_f32 v90,v90,v204
v_mul_f32 v91,v91,v204
v_mul_f32 v92,v92,v204
v_mul_f32 v93,v93,v204
v_mul_f32 v94,v94,v204
v_mul_f32 v95,v95,v204
v_cvt_pk_bf16_f32 v124,v88,v89
v_cvt_pk_bf16_f32 v125,v90,v91
v_cvt_pk_bf16_f32 v126,v92,v93
v_cvt_pk_bf16_f32 v127,v94,v95
s_nop 0
buffer_store_dwordx4 v[124:127],v243,s[32:35],s49 offen offset:3072 sc1
s_add_u32 s49,s49,4096
v_accvgpr_read_b32 v64,a64
v_accvgpr_read_b32 v65,a65
v_accvgpr_read_b32 v66,a66
v_accvgpr_read_b32 v67,a67
v_accvgpr_read_b32 v68,a80
v_accvgpr_read_b32 v69,a81
v_accvgpr_read_b32 v70,a82
v_accvgpr_read_b32 v71,a83
v_mul_f32 v64,v64,v192
v_mul_f32 v65,v65,v192
v_mul_f32 v66,v66,v192
v_mul_f32 v67,v67,v192
v_mul_f32 v68,v68,v192
v_mul_f32 v69,v69,v192
v_mul_f32 v70,v70,v192
v_mul_f32 v71,v71,v192
v_cvt_pk_bf16_f32 v96,v64,v65
v_cvt_pk_bf16_f32 v97,v66,v67
v_cvt_pk_bf16_f32 v98,v68,v69
v_cvt_pk_bf16_f32 v99,v70,v71
s_nop 0
buffer_store_dwordx4 v[96:99],v243,s[32:35],s49 offen offset:0 sc1
v_accvgpr_read_b32 v72,a68
v_accvgpr_read_b32 v73,a69
v_accvgpr_read_b32 v74,a70
v_accvgpr_read_b32 v75,a71
v_accvgpr_read_b32 v76,a84
v_accvgpr_read_b32 v77,a85
v_accvgpr_read_b32 v78,a86
v_accvgpr_read_b32 v79,a87
v_mul_f32 v72,v72,v196
v_mul_f32 v73,v73,v196
v_mul_f32 v74,v74,v196
v_mul_f32 v75,v75,v196
v_mul_f32 v76,v76,v196
v_mul_f32 v77,v77,v196
v_mul_f32 v78,v78,v196
v_mul_f32 v79,v79,v196
v_cvt_pk_bf16_f32 v100,v72,v73
v_cvt_pk_bf16_f32 v101,v74,v75
v_cvt_pk_bf16_f32 v102,v76,v77
v_cvt_pk_bf16_f32 v103,v78,v79
s_nop 0
buffer_store_dwordx4 v[100:103],v243,s[32:35],s49 offen offset:1024 sc1
v_accvgpr_read_b32 v80,a72
v_accvgpr_read_b32 v81,a73
v_accvgpr_read_b32 v82,a74
v_accvgpr_read_b32 v83,a75
v_accvgpr_read_b32 v84,a88
v_accvgpr_read_b32 v85,a89
v_accvgpr_read_b32 v86,a90
v_accvgpr_read_b32 v87,a91
v_mul_f32 v80,v80,v200
v_mul_f32 v81,v81,v200
v_mul_f32 v82,v82,v200
v_mul_f32 v83,v83,v200
v_mul_f32 v84,v84,v200
v_mul_f32 v85,v85,v200
v_mul_f32 v86,v86,v200
v_mul_f32 v87,v87,v200
v_cvt_pk_bf16_f32 v104,v80,v81
v_cvt_pk_bf16_f32 v105,v82,v83
v_cvt_pk_bf16_f32 v106,v84,v85
v_cvt_pk_bf16_f32 v107,v86,v87
s_nop 0
buffer_store_dwordx4 v[104:107],v243,s[32:35],s49 offen offset:2048 sc1
v_accvgpr_read_b32 v88,a76
v_accvgpr_read_b32 v89,a77
v_accvgpr_read_b32 v90,a78
v_accvgpr_read_b32 v91,a79
v_accvgpr_read_b32 v92,a92
v_accvgpr_read_b32 v93,a93
v_accvgpr_read_b32 v94,a94
v_accvgpr_read_b32 v95,a95
v_mul_f32 v88,v88,v204
v_mul_f32 v89,v89,v204
v_mul_f32 v90,v90,v204
v_mul_f32 v91,v91,v204
v_mul_f32 v92,v92,v204
v_mul_f32 v93,v93,v204
v_mul_f32 v94,v94,v204
v_mul_f32 v95,v95,v204
v_cvt_pk_bf16_f32 v108,v88,v89
v_cvt_pk_bf16_f32 v109,v90,v91
v_cvt_pk_bf16_f32 v110,v92,v93
v_cvt_pk_bf16_f32 v111,v94,v95
s_nop 0
buffer_store_dwordx4 v[108:111],v243,s[32:35],s49 offen offset:3072 sc1
s_add_u32 s49,s49,4096
v_accvgpr_read_b32 v64,a96
v_accvgpr_read_b32 v65,a97
v_accvgpr_read_b32 v66,a98
v_accvgpr_read_b32 v67,a99
v_accvgpr_read_b32 v68,a112
v_accvgpr_read_b32 v69,a113
v_accvgpr_read_b32 v70,a114
v_accvgpr_read_b32 v71,a115
v_mul_f32 v64,v64,v192
v_mul_f32 v65,v65,v192
v_mul_f32 v66,v66,v192
v_mul_f32 v67,v67,v192
v_mul_f32 v68,v68,v192
v_mul_f32 v69,v69,v192
v_mul_f32 v70,v70,v192
v_mul_f32 v71,v71,v192
v_cvt_pk_bf16_f32 v112,v64,v65
v_cvt_pk_bf16_f32 v113,v66,v67
v_cvt_pk_bf16_f32 v114,v68,v69
v_cvt_pk_bf16_f32 v115,v70,v71
s_nop 0
buffer_store_dwordx4 v[112:115],v243,s[32:35],s49 offen offset:0 sc1
v_accvgpr_read_b32 v72,a100
v_accvgpr_read_b32 v73,a101
v_accvgpr_read_b32 v74,a102
v_accvgpr_read_b32 v75,a103
v_accvgpr_read_b32 v76,a116
v_accvgpr_read_b32 v77,a117
v_accvgpr_read_b32 v78,a118
v_accvgpr_read_b32 v79,a119
v_mul_f32 v72,v72,v196
v_mul_f32 v73,v73,v196
v_mul_f32 v74,v74,v196
v_mul_f32 v75,v75,v196
v_mul_f32 v76,v76,v196
v_mul_f32 v77,v77,v196
v_mul_f32 v78,v78,v196
v_mul_f32 v79,v79,v196
v_cvt_pk_bf16_f32 v116,v72,v73
v_cvt_pk_bf16_f32 v117,v74,v75
v_cvt_pk_bf16_f32 v118,v76,v77
v_cvt_pk_bf16_f32 v119,v78,v79
s_nop 0
buffer_store_dwordx4 v[116:119],v243,s[32:35],s49 offen offset:1024 sc1
v_accvgpr_read_b32 v80,a104
v_accvgpr_read_b32 v81,a105
v_accvgpr_read_b32 v82,a106
v_accvgpr_read_b32 v83,a107
v_accvgpr_read_b32 v84,a120
v_accvgpr_read_b32 v85,a121
v_accvgpr_read_b32 v86,a122
v_accvgpr_read_b32 v87,a123
v_mul_f32 v80,v80,v200
v_mul_f32 v81,v81,v200
v_mul_f32 v82,v82,v200
v_mul_f32 v83,v83,v200
v_mul_f32 v84,v84,v200
v_mul_f32 v85,v85,v200
v_mul_f32 v86,v86,v200
v_mul_f32 v87,v87,v200
v_cvt_pk_bf16_f32 v120,v80,v81
v_cvt_pk_bf16_f32 v121,v82,v83
v_cvt_pk_bf16_f32 v122,v84,v85
v_cvt_pk_bf16_f32 v123,v86,v87
s_nop 0
buffer_store_dwordx4 v[120:123],v243,s[32:35],s49 offen offset:2048 sc1
v_accvgpr_read_b32 v88,a108
v_accvgpr_read_b32 v89,a109
v_accvgpr_read_b32 v90,a110
v_accvgpr_read_b32 v91,a111
v_accvgpr_read_b32 v92,a124
v_accvgpr_read_b32 v93,a125
v_accvgpr_read_b32 v94,a126
v_accvgpr_read_b32 v95,a127
v_mul_f32 v88,v88,v204
v_mul_f32 v89,v89,v204
v_mul_f32 v90,v90,v204
v_mul_f32 v91,v91,v204
v_mul_f32 v92,v92,v204
v_mul_f32 v93,v93,v204
v_mul_f32 v94,v94,v204
v_mul_f32 v95,v95,v204
v_cvt_pk_bf16_f32 v124,v88,v89
v_cvt_pk_bf16_f32 v125,v90,v91
v_cvt_pk_bf16_f32 v126,v92,v93
v_cvt_pk_bf16_f32 v127,v94,v95
s_nop 0
buffer_store_dwordx4 v[124:127],v243,s[32:35],s49 offen offset:3072 sc1
s_add_u32 s49,s49,4096
s_waitcnt vmcnt(0) lgkmcnt(0)
s_add_u32 m0,s48,131072
s_add_u32 s47,s68,45056
buffer_load_dwordx4 v243,s[32:35],s47 offen offset:0 sc1 lds
buffer_load_dwordx4 v243,s[32:35],s47 offen offset:1024 sc1 lds
buffer_load_dwordx4 v243,s[32:35],s47 offen offset:2048 sc1 lds
buffer_load_dwordx4 v243,s[32:35],s47 offen offset:3072 sc1 lds
s_add_u32 m0,s48,16384
s_add_u32 s47,s68,49152
buffer_load_dwordx4 v243,s[32:35],s47 offen offset:0 sc1 lds
buffer_load_dwordx4 v243,s[32:35],s47 offen offset:1024 sc1 lds
buffer_load_dwordx4 v243,s[32:35],s47 offen offset:2048 sc1 lds
buffer_load_dwordx4 v243,s[32:35],s47 offen offset:3072 sc1 lds
s_add_u32 m0,s48,81920
s_add_u32 s47,s68,53248
buffer_load_dwordx4 v243,s[32:35],s47 offen offset:0 sc1 lds
buffer_load_dwordx4 v243,s[32:35],s47 offen offset:1024 sc1 lds
buffer_load_dwordx4 v243,s[32:35],s47 offen offset:2048 sc1 lds
buffer_load_dwordx4 v243,s[32:35],s47 offen offset:3072 sc1 lds
s_add_u32 m0,s48,49152
s_add_u32 s47,s68,57344
buffer_load_dwordx4 v243,s[32:35],s47 offen offset:0 sc1 lds
buffer_load_dwordx4 v243,s[32:35],s47 offen offset:1024 sc1 lds
buffer_load_dwordx4 v243,s[32:35],s47 offen offset:2048 sc1 lds
buffer_load_dwordx4 v243,s[32:35],s47 offen offset:3072 sc1 lds
s_add_u32 m0,s48,32768
s_add_u32 s47,s68,61440
buffer_load_dwordx4 v243,s[32:35],s47 offen offset:0 sc1 lds
buffer_load_dwordx4 v243,s[32:35],s47 offen offset:1024 sc1 lds
buffer_load_dwordx4 v243,s[32:35],s47 offen offset:2048 sc1 lds
buffer_load_dwordx4 v243,s[32:35],s47 offen offset:3072 sc1 lds
s_add_u32 m0,s48,0
s_add_u32 s47,s68,65536
buffer_load_dwordx4 v243,s[32:35],s47 offen offset:0 sc1 lds
buffer_load_dwordx4 v243,s[32:35],s47 offen offset:1024 sc1 lds
buffer_load_dwordx4 v243,s[32:35],s47 offen offset:2048 sc1 lds
buffer_load_dwordx4 v243,s[32:35],s47 offen offset:3072 sc1 lds
s_add_u32 m0,s48,114688
s_add_u32 s47,s68,69632
buffer_load_dwordx4 v243,s[32:35],s47 offen offset:0 sc1 lds
buffer_load_dwordx4 v243,s[32:35],s47 offen offset:1024 sc1 lds
buffer_load_dwordx4 v243,s[32:35],s47 offen offset:2048 sc1 lds
buffer_load_dwordx4 v243,s[32:35],s47 offen offset:3072 sc1 lds
s_add_u32 m0,s48,147456
s_add_u32 s47,s68,73728
buffer_load_dwordx4 v243,s[32:35],s47 offen offset:0 sc1 lds
buffer_load_dwordx4 v243,s[32:35],s47 offen offset:1024 sc1 lds
buffer_load_dwordx4 v243,s[32:35],s47 offen offset:2048 sc1 lds
buffer_load_dwordx4 v243,s[32:35],s47 offen offset:3072 sc1 lds
s_waitcnt vmcnt(0) lgkmcnt(0)
s_add_u32 s51,s46,0
buffer_load_dwordx4 v[0:3],v243,s[32:35],s51 offen offset:0 sc1
buffer_load_dwordx4 v[4:7],v243,s[32:35],s51 offen offset:1024 sc1
buffer_load_dwordx4 v[8:11],v243,s[32:35],s51 offen offset:2048 sc1
buffer_load_dwordx4 v[12:15],v243,s[32:35],s51 offen offset:3072 sc1
s_add_u32 s51,s46,4096
buffer_load_dwordx4 v[16:19],v243,s[32:35],s51 offen offset:0 sc1
buffer_load_dwordx4 v[20:23],v243,s[32:35],s51 offen offset:1024 sc1
buffer_load_dwordx4 v[24:27],v243,s[32:35],s51 offen offset:2048 sc1
buffer_load_dwordx4 v[28:31],v243,s[32:35],s51 offen offset:3072 sc1
s_add_u32 s51,s46,8192
buffer_load_dwordx4 v[32:35],v243,s[32:35],s51 offen offset:0 sc1
buffer_load_dwordx4 v[36:39],v243,s[32:35],s51 offen offset:1024 sc1
buffer_load_dwordx4 v[40:43],v243,s[32:35],s51 offen offset:2048 sc1
buffer_load_dwordx4 v[44:47],v243,s[32:35],s51 offen offset:3072 sc1
s_add_u32 s51,s46,12288
buffer_load_dwordx4 v[48:51],v243,s[32:35],s51 offen offset:0 sc1
buffer_load_dwordx4 v[52:55],v243,s[32:35],s51 offen offset:1024 sc1
buffer_load_dwordx4 v[56:59],v243,s[32:35],s51 offen offset:2048 sc1
buffer_load_dwordx4 v[60:63],v243,s[32:35],s51 offen offset:3072 sc1
s_add_u32 s51,s46,16384
buffer_load_dwordx4 a[160:163],v243,s[32:35],s51 offen offset:0 sc1
buffer_load_dwordx4 a[164:167],v243,s[32:35],s51 offen offset:1024 sc1
buffer_load_dwordx4 a[168:171],v243,s[32:35],s51 offen offset:2048 sc1
buffer_load_dwordx4 a[172:175],v243,s[32:35],s51 offen offset:3072 sc1
s_add_u32 s51,s46,20480
buffer_load_dwordx4 a[176:179],v243,s[32:35],s51 offen offset:0 sc1
buffer_load_dwordx4 a[180:183],v243,s[32:35],s51 offen offset:1024 sc1
buffer_load_dwordx4 a[184:187],v243,s[32:35],s51 offen offset:2048 sc1
buffer_load_dwordx4 a[188:191],v243,s[32:35],s51 offen offset:3072 sc1
s_waitcnt vmcnt(0) lgkmcnt(0)
s_branch L_decided
.section .rodata,"a"
.p2align 6
.amdhsa_kernel recurrent_scan__mha_block_cached__moe_arch_mod__prompt_kernel
  .amdhsa_next_free_vgpr 512
  .amdhsa_next_free_sgpr 102
  .amdhsa_accum_offset 256
  .amdhsa_group_segment_fixed_size 0
  .amdhsa_kernarg_size 104
  .amdhsa_user_sgpr_count 2
  .amdhsa_user_sgpr_kernarg_segment_ptr 1
  .amdhsa_system_sgpr_workgroup_id_x 1
  .amdhsa_float_denorm_mode_32 3
.end_amdhsa_kernel
```
